```python
import torch

def _softmax(x, axis=-1):
    return torch.softmax(x, dim=axis)
def _gelu(x):
    return torch.nn.functional.gelu(x, approximate="tanh")
def _silu(x):
    return torch.nn.functional.silu(x)
def _sigmoid(x):
    return torch.sigmoid(x)
def _layernorm(x, axis=-1, eps=1e-5):
    m = x.mean(dim=axis, keepdim=True)
    v = x.var(dim=axis, keepdim=True, unbiased=False)
    return (x - m) / torch.sqrt(v + eps)
def _scatter_add(tgt, idx, src, axis=0):
    return tgt.clone().index_add_(axis, idx, src)
def _segment_sum(src, seg, n):
    out = torch.zeros((n,) + src.shape[1:], dtype=src.dtype)
    return out.index_add_(0, seg, src)
def _pad(x, pw):
    flat = tuple(v for pair in reversed(pw) for v in pair)
    return torch.nn.functional.pad(x, flat)

kernel_name = 'standalone__gqa_block_cached__near_ridge'

def setup_inputs():

    _w = (lambda a: (lambda t: t.to(torch.bfloat16) if t.is_floating_point() else t)(torch.as_tensor(a)))
    B, Sq, D = 8, 288, 512
    Hq, Hkv, Sk, Dh = 32, 32, 1024, 128
    assert Hq % Hkv == 0, (Hq, Hkv)
    return {
        "x": _w((lambda *s: torch.randn(*s, dtype=torch.bfloat16) * 0.8)(B, Sq, D)),
        "k_cache": _w((lambda *s: torch.randn(*s, dtype=torch.bfloat16) * 0.8)(B, Hkv, Sk, Dh)),
        "v_cache": _w((lambda *s: torch.randn(*s, dtype=torch.bfloat16) * 0.05)(B, Hkv, Sk, Dh)),
        "wq": _w((lambda *s: torch.randn(*s, dtype=torch.bfloat16) * 0.8)(D, Hq * Dh) * (D ** -0.5)),
        "wo": _w((lambda *s: torch.randn(*s, dtype=torch.bfloat16) * 0.05)(Hq * Dh, D) * ((Hq * Dh) ** -0.5)),
    }

def reference(x, k_cache, v_cache, wq, wo):
    B, Sq, D = x.shape
    Hq, Dh = 32, 128
    Hkv = k_cache.shape[1]
    rep = Hq // Hkv
    q = (lambda x, *d: x.permute(*d))((x @ wq).reshape(B, Sq, Hq, Dh), 0, 2, 1, 3)
    k = (lambda x, n, axis: torch.repeat_interleave(x, n, dim=axis))(k_cache, rep, axis=1)
    v = (lambda x, n, axis: torch.repeat_interleave(x, n, dim=axis))(v_cache, rep, axis=1)
    scores = torch.einsum("bhqd,bhkd->bhqk", q, k) * (Dh ** -0.5)
    p = _softmax(scores, axis=-1)
    o = torch.einsum("bhqk,bhkd->bhqd", p, v)
    return (lambda x, *d: x.permute(*d))(o, 0, 2, 1, 3).reshape(B, Sq, Hq * Dh) @ wo
```

```asm
; @launch grid=(256,1,1) block=(256,1,1) lds=163840
.amdgcn_target "amdgcn-amd-amdhsa--gfx950"
.text
.globl standalone__gqa_block_cached__near_ridge_kernel
.p2align 8
.type standalone__gqa_block_cached__near_ridge_kernel,@function
standalone__gqa_block_cached__near_ridge_kernel:
    s_cmp_ge_u32 s2, 256
    s_cbranch_scc1 L_end
    v_lshrrev_b32 v1, 6, v0
    v_and_b32 v0, 63, v0
    v_readfirstlane_b32 s24, v1
    s_mov_b32 s91, 0
L_restart:
    s_load_dwordx16 s[44:59], s[0:1], 0
    s_getpc_b64 s[42:43]
L_pc:
    s_lshr_b32 s41, s2, 3
    s_lshl_b32 s41, s41, 11
    v_and_b32 v1, 15, v0
    v_lshlrev_b32 v1, 7, v1
    v_add_u32 v1, s41, v1
    v_min_u32 v1, L_hot_end-L_pc, v1
    global_load_dword v255, v1, s[42:43]
    s_and_b32 s40, s2, 7
    s_lshr_b32 s41, s2, 3
    s_and_b32 s42, s40, 1
    s_lshl_b32 s42, s42, 2
    s_and_b32 s43, s41, 3
    s_add_u32 s26, s42, s43
    s_lshr_b32 s42, s40, 1
    s_lshl_b32 s42, s42, 3
    s_lshr_b32 s40, s41, 2
    s_add_u32 s27, s42, s40
    s_add_u32 s40, s40, s43
    s_lshl_b32 s40, s40, 2
    s_and_b32 s28, s40, 15
    s_and_b32 s25, s24, 1
    v_and_b32 v2, 15, v0
    v_lshrrev_b32 v3, 4, v0
    v_and_b32 v6, 3, v0
    v_bfe_u32 v4, v0, 3, 1
    v_bfe_u32 v8, v0, 4, 1
    v_xor_b32 v8, v8, v4
    v_lshlrev_b32 v8, 2, v8
    v_lshl_add_u32 v8, v4, 3, v8
    v_lshrrev_b32 v9, 5, v0
    v_lshl_add_u32 v8, v9, 4, v8
    v_lshlrev_b32 v8, 10, v8
    v_and_b32 v9, 7, v0
    v_lshl_add_u32 v8, v9, 4, v8
    s_lshl_b32 s40, s24, 16
    v_add_u32 v208, s40, v8
    v_add_u32 v209, 0x8000, v208
    s_lshl_b32 s40, s24, 10
    s_add_u32 s40, s40, 262144
    v_add_u32 v210, s40, v8
    s_lshr_b32 s42, s24, 1
    s_lshr_b32 s3, s28, 1
    v_bfe_u32 v8, v0, 4, 1
    v_lshlrev_b32 v8, 2, v8
    v_lshrrev_b32 v9, 5, v0
    v_lshl_add_u32 v8, v9, 4, v8
    s_lshl_b32 s41, s25, 1
    s_lshl_b32 s43, s42, 3
    s_add_u32 s41, s41, s43
    v_add_u32 v8, s41, v8
    v_lshlrev_b32 v8, 13, v8
    v_lshl_add_u32 v213, v2, 4, v8
    v_add_u32 v214, 0x2000, v213
    s_mul_i32 s31, s24, 8448
    s_mul_i32 s32, s24, 2112
    s_add_u32 s32, s32, 114048
    s_mul_i32 s101, s24, 1056
    s_waitcnt lgkmcnt(0)
    s_mul_i32 s40, s26, 294912
    s_add_u32 s4, s44, s40
    s_addc_u32 s5, s45, 0
    s_mov_b32 s6, 294912
    s_mov_b32 s7, 0x20000
    s_lshl_b32 s40, s27, 8
    s_add_u32 s16, s50, s40
    s_addc_u32 s17, s51, 0
    s_mov_b32 s18, 4186368
    s_mov_b32 s19, 0x20000
    s_lshl_b32 s30, s28, 18
    s_add_u32 s28, s28, 1
    s_add_u32 m0, s32, 0
    s_nop 0
    buffer_load_dwordx4 v213, s[16:19], s30 offen lds
    s_and_b32 s28, s28, 15
    s_add_u32 m0, s32, 1056
    s_nop 0
    buffer_load_dwordx4 v214, s[16:19], s30 offen lds
    s_lshl_b32 s30, s28, 18
    s_add_u32 s28, s28, 1
    s_add_u32 m0, s32, 8448
    s_nop 0
    buffer_load_dwordx4 v213, s[16:19], s30 offen lds
    s_and_b32 s28, s28, 15
    s_add_u32 m0, s32, 9504
    s_nop 0
    buffer_load_dwordx4 v214, s[16:19], s30 offen lds
    s_lshl_b32 s29, s3, 7
    s_add_u32 s3, s3, 1
    s_add_u32 m0, s101, 71808
    s_nop 0
    buffer_load_dwordx4 v210, s[4:7], s29 offen lds
    s_and_b32 s3, s3, 7
    s_add_u32 m0, s31, 38016
    s_nop 0
    buffer_load_dwordx4 v208, s[4:7], s29 offen offset:0 lds
    s_add_u32 m0, s31, 38048
    s_nop 0
    buffer_load_dwordx4 v208, s[4:7], s29 offen offset:1024 lds
    s_add_u32 m0, s31, 38080
    s_nop 0
    buffer_load_dwordx4 v208, s[4:7], s29 offen offset:2048 lds
    s_add_u32 m0, s31, 38112
    s_nop 0
    buffer_load_dwordx4 v208, s[4:7], s29 offen offset:3072 lds
    s_add_u32 m0, s31, 42240
    s_nop 0
    buffer_load_dwordx4 v209, s[4:7], s29 offen offset:0 lds
    s_add_u32 m0, s31, 42272
    s_nop 0
    buffer_load_dwordx4 v209, s[4:7], s29 offen offset:1024 lds
    s_add_u32 m0, s31, 42304
    s_nop 0
    buffer_load_dwordx4 v209, s[4:7], s29 offen offset:2048 lds
    s_add_u32 m0, s31, 42336
    s_nop 0
    buffer_load_dwordx4 v209, s[4:7], s29 offen offset:3072 lds
    s_mov_b32 s96, s58
    s_mov_b32 s97, s59
    s_mov_b32 s98, 67108864
    s_mov_b32 s99, 0x20000
    s_lshl_b32 s40, s26, 5
    s_add_u32 s40, s40, s27
    s_lshl_b32 s41, s40, 7
    s_add_u32 s41, s41, 41943040
    s_lshl_b32 s42, s2, 9
    s_add_u32 s42, s42, 42008448
    v_lshlrev_b32 v8, 7, v0
    v_add_u32 v8, s42, v8
    v_mov_b32 v9, s41
    v_cmp_eq_u32 vcc, 0, v0
    s_nop 1
    v_cndmask_b32 v8, v8, v9, vcc
    s_lshl_b32 s42, s24, 6
    v_add_u32 v9, s42, v0
    v_cmp_gt_u32 vcc, 5, v9
    v_mov_b32 v9, 0x7ffffff0
    s_nop 0
    v_cndmask_b32 v8, v9, v8, vcc
    v_mov_b32 v9, 0
    buffer_store_dword v9, v8, s[96:99], 0 offen sc1
    s_lshl_b32 s40, s40, 18
    s_add_u32 s8, s46, s40
    s_addc_u32 s9, s47, 0
    s_mov_b32 s10, 262144
    s_mov_b32 s11, 0x20000
    s_add_u32 s12, s48, s40
    s_addc_u32 s13, s49, 0
    s_mov_b32 s14, 262144
    s_mov_b32 s15, 0x20000
    s_mul_i32 s40, s26, 2359296
    s_lshl_b32 s41, s27, 12
    s_add_u32 s40, s40, s41
    s_add_u32 s20, s58, s40
    s_addc_u32 s21, s59, 0
    s_mov_b32 s22, 2359296
    s_mov_b32 s23, 0x20000
    s_mov_b32 s92, s52
    s_mov_b32 s93, s53
    s_mov_b32 s94, 4194304
    s_mov_b32 s95, 0x20000
    v_bfe_u32 v5, v0, 2, 1
    v_bfe_u32 v7, v0, 2, 2
    s_lshr_b32 s42, s24, 1
    v_lshlrev_b32 v8, 4, v2
    v_lshl_add_u32 v9, v3, 12, v8
    s_lshl_b32 s41, s24, 10
    v_add_u32 v234, s41, v9
    v_lshl_add_u32 v9, v3, 11, v8
    s_lshl_b32 s41, s42, 13
    s_lshl_b32 s43, s25, 10
    s_add_u32 s41, s41, s43
    v_add_u32 v235, s41, v9
    s_mul_i32 s33, s24, 4160
    s_mul_i32 s34, s24, 4224
    s_add_u32 s34, s34, 16640
    s_mov_b32 s38, 0x3e0293ee
    s_mov_b32 s39, 0x3e0293ee
    s_mov_b32 s100, 33536
    v_mov_b32 v239, 0
    v_xor_b32 v8, v4, v5
    v_lshl_add_u32 v8, v8, 1, v4
    v_lshlrev_b32 v8, 7, v8
    v_mul_u32_u24 v9, 1056, v6
    v_add_u32 v8, v8, v9
    v_lshl_add_u32 v8, v3, 4, v8
    s_add_u32 s40, s31, 38016
    v_add_u32 v215, s40, v8
    s_lshl_b32 s40, s42, 9
    s_add_u32 s40, s40, 71808
    v_add_u32 v212, s40, v8
    v_and_b32 v8, 1, v3
    v_lshl_add_u32 v8, v8, 2, v7
    v_mul_u32_u24 v8, 1056, v8
    v_lshrrev_b32 v9, 1, v3
    v_lshl_add_u32 v8, v9, 9, v8
    v_lshl_add_u32 v8, v6, 3, v8
    s_lshl_b32 s40, s25, 7
    s_add_u32 s41, s40, 114048
    v_add_u32 v216, s41, v8
    s_sub_u32 s41, 114176, s40
    v_add_u32 v217, s41, v8
    v_xor_b32 v8, v4, v5
    v_lshl_add_u32 v8, v6, 1, v8
    v_lshl_add_u32 v8, v4, 3, v8
    v_mul_u32_u24 v8, 1040, v8
    v_and_b32 v10, 1, v3
    v_lshl_add_u32 v10, v10, 1, v9
    v_lshl_add_u32 v8, v10, 4, v8
    s_mul_i32 s40, s25, 640
    v_add_u32 v228, s40, v8
    s_sub_u32 s40, 640, s40
    v_add_u32 v231, s40, v8
    s_mul_i32 s40, s25, 384
    s_add_u32 s41, s40, 128
    v_add_u32 v229, s41, v8
    s_sub_u32 s40, 512, s40
    v_add_u32 v230, s40, v8
    v_and_b32 v10, 1, v3
    v_xor_b32 v10, v10, v9
    v_lshl_add_u32 v10, v7, 1, v10
    v_mul_u32_u24 v10, 1056, v10
    v_lshl_add_u32 v10, v9, 8, v10
    v_lshl_add_u32 v10, v6, 3, v10
    s_mul_i32 s40, s25, 8448
    s_add_u32 s41, s40, 16640
    v_add_u32 v232, s41, v10
    s_sub_u32 s41, 25088, s40
    v_add_u32 v233, s41, v10
    v_mov_b32 v8, 0x3f803f80
    v_and_b32 v9, 1, v0
    v_mul_u32_u24 v9, 0xaaaa, v9
    v_add_u32 v9, 0x4444, v9
    v_lshl_or_b32 v1, v9, 16, v9
    v_accvgpr_write_b32 a228, v8
    v_accvgpr_write_b32 a229, v8
    v_accvgpr_write_b32 a230, v8
    v_accvgpr_write_b32 a231, v8
    s_bfe_u32 s84, s2, 0x10001
    s_lshr_b32 s41, s2, 3
    s_lshr_b32 s85, s41, 2
    s_and_b32 s40, s41, 3
    s_lshl_b32 s40, s40, 1
    s_add_u32 s40, s40, s85
    s_lshl_b32 s40, s40, 1
    s_and_b32 s86, s40, 15
    s_and_b32 s40, s2, 1
    s_xor_b32 s40, s40, 1
    s_lshl_b32 s40, s40, 2
    s_bfe_u32 s42, s2, 0x10002
    s_lshl_b32 s42, s42, 1
    s_add_u32 s40, s40, s42
    s_and_b32 s42, s41, 1
    s_add_u32 s88, s40, s42
    s_bfe_u32 s42, s41, 0x10001
    s_mul_i32 s42, s42, 9
    s_mul_i32 s43, s84, 5
    s_add_u32 s90, s42, s43
    s_add_u32 s42, s42, 5
    s_sub_u32 s89, s42, s43
    s_mul_i32 s87, s24, 4192
    v_lshlrev_b32 v248, 4, v0
    v_lshlrev_b32 v8, 2, v4
    v_lshl_add_u32 v8, v3, 3, v8
    v_lshlrev_b32 v8, 10, v8
    v_and_b32 v9, 7, v0
    s_lshl_b32 s40, s84, 1
    s_xor_b32 s40, s40, s24
    s_lshl_b32 s40, s40, 1
    v_xor_b32 v9, s40, v9
    v_lshl_add_u32 v8, v9, 4, v8
    s_lshl_b32 s40, s84, 21
    s_lshl_b32 s41, s24, 19
    s_add_u32 s40, s40, s41
    s_lshl_b32 s41, s85, 7
    s_add_u32 s40, s40, s41
    v_add_u32 v244, s40, v8
    v_mul_u32_u24 v8, 1056, v7
    v_lshl_add_u32 v8, v3, 7, v8
    v_lshl_add_u32 v8, v6, 3, v8
    v_add_u32 v245, s87, v8
    v_add_u32 v246, 67072, v245
    v_add_u32 v247, 134400, v245
    s_lshl_b32 s40, s84, 16
    s_lshl_b32 s41, s24, 14
    s_add_u32 s40, s40, s41
    v_add_u32 v240, s40, v248
    v_mov_b32 v16, 0
    v_mov_b32 v17, 0
    v_mov_b32 v18, 0
    v_mov_b32 v19, 0
    v_mov_b32 v20, 0
    v_mov_b32 v21, 0
    v_mov_b32 v22, 0
    v_mov_b32 v23, 0
    v_mov_b32 v24, 0
    v_mov_b32 v25, 0
    v_mov_b32 v26, 0
    v_mov_b32 v27, 0
    v_mov_b32 v28, 0
    v_mov_b32 v29, 0
    v_mov_b32 v30, 0
    v_mov_b32 v31, 0
    v_mov_b32 v32, 0
    v_mov_b32 v33, 0
    v_mov_b32 v34, 0
    v_mov_b32 v35, 0
    v_mov_b32 v36, 0
    v_mov_b32 v37, 0
    v_mov_b32 v38, 0
    v_mov_b32 v39, 0
    v_mov_b32 v40, 0
    v_mov_b32 v41, 0
    v_mov_b32 v42, 0
    v_mov_b32 v43, 0
    v_mov_b32 v44, 0
    v_mov_b32 v45, 0
    v_mov_b32 v46, 0
    v_mov_b32 v47, 0
    v_mov_b32 v48, 0
    v_mov_b32 v49, 0
    v_mov_b32 v50, 0
    v_mov_b32 v51, 0
    v_mov_b32 v52, 0
    v_mov_b32 v53, 0
    v_mov_b32 v54, 0
    v_mov_b32 v55, 0
    v_mov_b32 v56, 0
    v_mov_b32 v57, 0
    v_mov_b32 v58, 0
    v_mov_b32 v59, 0
    v_mov_b32 v60, 0
    v_mov_b32 v61, 0
    v_mov_b32 v62, 0
    v_mov_b32 v63, 0
    v_mov_b32 v64, 0
    v_mov_b32 v65, 0
    v_mov_b32 v66, 0
    v_mov_b32 v67, 0
    v_mov_b32 v68, 0
    v_mov_b32 v69, 0
    v_mov_b32 v70, 0
    v_mov_b32 v71, 0
    v_mov_b32 v72, 0
    v_mov_b32 v73, 0
    v_mov_b32 v74, 0
    v_mov_b32 v75, 0
    v_mov_b32 v76, 0
    v_mov_b32 v77, 0
    v_mov_b32 v78, 0
    v_mov_b32 v79, 0
    v_mov_b32 v80, 0
    v_mov_b32 v81, 0
    v_mov_b32 v82, 0
    v_mov_b32 v83, 0
    v_mov_b32 v84, 0
    v_mov_b32 v85, 0
    v_mov_b32 v86, 0
    v_mov_b32 v87, 0
    v_mov_b32 v88, 0
    v_mov_b32 v89, 0
    v_mov_b32 v90, 0
    v_mov_b32 v91, 0
    v_mov_b32 v92, 0
    v_mov_b32 v93, 0
    v_mov_b32 v94, 0
    v_mov_b32 v95, 0
    v_mov_b32 v96, 0
    v_mov_b32 v97, 0
    v_mov_b32 v98, 0
    v_mov_b32 v99, 0
    v_mov_b32 v100, 0
    v_mov_b32 v101, 0
    v_mov_b32 v102, 0
    v_mov_b32 v103, 0
    v_mov_b32 v104, 0
    v_mov_b32 v105, 0
    v_mov_b32 v106, 0
    v_mov_b32 v107, 0
    v_mov_b32 v108, 0
    v_mov_b32 v109, 0
    v_mov_b32 v110, 0
    v_mov_b32 v111, 0
    v_mov_b32 v112, 0
    v_mov_b32 v113, 0
    v_mov_b32 v114, 0
    v_mov_b32 v115, 0
    v_mov_b32 v116, 0
    v_mov_b32 v117, 0
    v_mov_b32 v118, 0
    v_mov_b32 v119, 0
    v_mov_b32 v120, 0
    v_mov_b32 v121, 0
    v_mov_b32 v122, 0
    v_mov_b32 v123, 0
    v_mov_b32 v124, 0
    v_mov_b32 v125, 0
    v_mov_b32 v126, 0
    v_mov_b32 v127, 0
    v_mov_b32 v128, 0
    v_mov_b32 v129, 0
    v_mov_b32 v130, 0
    v_mov_b32 v131, 0
    v_mov_b32 v132, 0
    v_mov_b32 v133, 0
    v_mov_b32 v134, 0
    v_mov_b32 v135, 0
    v_mov_b32 v136, 0
    v_mov_b32 v137, 0
    v_mov_b32 v138, 0
    v_mov_b32 v139, 0
    v_mov_b32 v140, 0
    v_mov_b32 v141, 0
    v_mov_b32 v142, 0
    v_mov_b32 v143, 0
    v_mov_b32 v144, 0
    v_mov_b32 v145, 0
    v_mov_b32 v146, 0
    v_mov_b32 v147, 0
    v_mov_b32 v148, 0
    v_mov_b32 v149, 0
    v_mov_b32 v150, 0
    v_mov_b32 v151, 0
    v_mov_b32 v152, 0
    v_mov_b32 v153, 0
    v_mov_b32 v154, 0
    v_mov_b32 v155, 0
    v_mov_b32 v156, 0
    v_mov_b32 v157, 0
    v_mov_b32 v158, 0
    v_mov_b32 v159, 0
    s_mov_b32 s80, s56
    s_mov_b32 s81, s57
    s_mov_b32 s82, 256
    s_mov_b32 s83, 0x20000
    s_lshl_b32 s40, s24, 6
    v_add_u32 v14, s40, v0
    v_lshlrev_b32 v14, 8, v14
    v_mov_b32 v15, 1
    s_lshl_b32 s40, s24, 11
    s_add_u32 s41, s40, 149248
    v_add_u32 v9, s41, v248
    s_xor_b32 s40, s40, 2048
    s_add_u32 s41, s40, 149248
    v_add_u32 v10, s41, v248
    s_lshl_b32 s30, s28, 18
    s_add_u32 s28, s28, 1
    s_add_u32 m0, s32, 16896
    s_nop 0
    buffer_load_dwordx4 v213, s[16:19], s30 offen lds
    s_and_b32 s28, s28, 15
    s_add_u32 m0, s32, 17952
    s_nop 0
    buffer_load_dwordx4 v214, s[16:19], s30 offen lds
    s_lshl_b32 s30, s28, 18
    s_add_u32 s28, s28, 1
    s_add_u32 m0, s32, 25344
    s_nop 0
    buffer_load_dwordx4 v213, s[16:19], s30 offen lds
    s_and_b32 s28, s28, 15
    s_add_u32 m0, s32, 26400
    s_nop 0
    buffer_load_dwordx4 v214, s[16:19], s30 offen lds
    s_lshl_b32 s29, s3, 7
    s_add_u32 s3, s3, 1
    s_add_u32 m0, s101, 109824
    s_nop 0
    buffer_load_dwordx4 v210, s[4:7], s29 offen lds
    s_and_b32 s3, s3, 7
    s_add_u32 m0, s31, 76032
    s_nop 0
    buffer_load_dwordx4 v208, s[4:7], s29 offen offset:0 lds
    s_add_u32 m0, s31, 76064
    s_nop 0
    buffer_load_dwordx4 v208, s[4:7], s29 offen offset:1024 lds
    s_add_u32 m0, s31, 76096
    s_nop 0
    buffer_load_dwordx4 v208, s[4:7], s29 offen offset:2048 lds
    s_add_u32 m0, s31, 76128
    s_nop 0
    buffer_load_dwordx4 v208, s[4:7], s29 offen offset:3072 lds
    s_add_u32 m0, s31, 80256
    s_nop 0
    buffer_load_dwordx4 v209, s[4:7], s29 offen offset:0 lds
    s_add_u32 m0, s31, 80288
    s_nop 0
    buffer_load_dwordx4 v209, s[4:7], s29 offen offset:1024 lds
    s_add_u32 m0, s31, 80320
    s_nop 0
    buffer_load_dwordx4 v209, s[4:7], s29 offen offset:2048 lds
    s_add_u32 m0, s31, 80352
    s_nop 0
    buffer_load_dwordx4 v209, s[4:7], s29 offen offset:3072 lds
    s_lshl_b32 s40, s2, 14
    s_lshl_b32 s41, s24, 12
    s_add_u32 s40, s40, s41
    v_and_b32 v13, 31, v0
    v_lshlrev_b32 v13, 7, v13
    v_add_u32 v13, s40, v13
    s_waitcnt vmcnt(14)
    s_barrier
    s_mov_b32 s35, 0
    ds_read_b128 a[80:83], v212 offset:0
    ds_read_b128 a[100:103], v212 offset:64
    ds_read_b128 a[64:67], v215 offset:0
    ds_read_b128 a[84:87], v215 offset:64
    ds_read_b64_tr_b16 a[0:1], v216 offset:0
    ds_read_b64_tr_b16 a[2:3], v216 offset:256
    ds_read_b64_tr_b16 a[32:33], v216 offset:8448
    ds_read_b64_tr_b16 a[34:35], v216 offset:8704
    ds_read_b64_tr_b16 a[4:5], v216 offset:32
    ds_read_b64_tr_b16 a[6:7], v216 offset:288
    ds_read_b64_tr_b16 a[36:37], v216 offset:8480
    ds_read_b64_tr_b16 a[38:39], v216 offset:8736
    ds_read_b64_tr_b16 a[8:9], v216 offset:64
    ds_read_b64_tr_b16 a[10:11], v216 offset:320
    s_lshl_b32 s29, s3, 7
    s_add_u32 s3, s3, 1
    s_add_u32 m0, s101, 33792
    s_nop 0
    buffer_load_dwordx4 v210, s[4:7], s29 offen lds
    s_and_b32 s3, s3, 7
    s_add_u32 m0, s31, 0
    s_nop 0
    buffer_load_dwordx4 v208, s[4:7], s29 offen offset:0 lds
    s_waitcnt lgkmcnt(6)
    v_mfma_f32_16x16x32_bf16 v[144:147], a[0:3], a[80:83], v[144:147]
    ds_read_b64_tr_b16 a[40:41], v216 offset:8512
    ds_read_b64_tr_b16 a[42:43], v216 offset:8768
    s_add_u32 m0, s31, 32
    v_mfma_f32_16x16x32_bf16 v[144:147], a[32:35], a[100:103], v[144:147]
    buffer_load_dwordx4 v208, s[4:7], s29 offen offset:1024 lds
    ds_read_b64_tr_b16 a[12:13], v216 offset:96
    s_waitcnt lgkmcnt(5)
    v_mfma_f32_16x16x32_bf16 v[148:151], a[36:39], a[100:103], v[148:151]
    ds_read_b64_tr_b16 a[14:15], v216 offset:352
    ds_read_b64_tr_b16 a[44:45], v216 offset:8544
    s_add_u32 m0, s31, 64
    v_mfma_f32_16x16x32_bf16 v[148:151], a[4:7], a[80:83], v[148:151]
    buffer_load_dwordx4 v208, s[4:7], s29 offen offset:2048 lds
    ds_read_b64_tr_b16 a[46:47], v216 offset:8800
    s_waitcnt lgkmcnt(4)
    v_mfma_f32_16x16x32_bf16 v[152:155], a[8:11], a[80:83], v[152:155]
    ds_read_b64_tr_b16 a[16:17], v217 offset:0
    ds_read_b64_tr_b16 a[18:19], v217 offset:256
    s_add_u32 m0, s31, 96
    v_mfma_f32_16x16x32_bf16 v[152:155], a[40:43], a[100:103], v[152:155]
    buffer_load_dwordx4 v208, s[4:7], s29 offen offset:3072 lds
    ds_read_b64_tr_b16 a[48:49], v217 offset:8448
    s_waitcnt lgkmcnt(3)
    v_mfma_f32_16x16x32_bf16 v[156:159], a[44:47], a[100:103], v[156:159]
    ds_read_b64_tr_b16 a[50:51], v217 offset:8704
    ds_read_b64_tr_b16 a[20:21], v217 offset:32
    s_add_u32 m0, s31, 4224
    v_mfma_f32_16x16x32_bf16 v[156:159], a[12:15], a[80:83], v[156:159]
    buffer_load_dwordx4 v209, s[4:7], s29 offen offset:0 lds
    ds_read_b64_tr_b16 a[22:23], v217 offset:288
    v_mfma_f32_16x16x32_bf16 v[16:19], a[0:3], a[64:67], v[16:19]
    ds_read_b64_tr_b16 a[52:53], v217 offset:8480
    ds_read_b64_tr_b16 a[54:55], v217 offset:8736
    s_add_u32 m0, s31, 4256
    v_mfma_f32_16x16x32_bf16 v[16:19], a[32:35], a[84:87], v[16:19]
    buffer_load_dwordx4 v209, s[4:7], s29 offen offset:1024 lds
    ds_read_b64_tr_b16 a[24:25], v217 offset:64
    v_mfma_f32_16x16x32_bf16 v[20:23], a[36:39], a[84:87], v[20:23]
    ds_read_b64_tr_b16 a[26:27], v217 offset:320
    ds_read_b64_tr_b16 a[56:57], v217 offset:8512
    s_add_u32 m0, s31, 4288
    v_mfma_f32_16x16x32_bf16 v[20:23], a[4:7], a[64:67], v[20:23]
    buffer_load_dwordx4 v209, s[4:7], s29 offen offset:2048 lds
    ds_read_b64_tr_b16 a[58:59], v217 offset:8768
    v_mfma_f32_16x16x32_bf16 v[24:27], a[8:11], a[64:67], v[24:27]
    ds_read_b64_tr_b16 a[28:29], v217 offset:96
    ds_read_b64_tr_b16 a[30:31], v217 offset:352
    s_add_u32 m0, s31, 4320
    v_mfma_f32_16x16x32_bf16 v[24:27], a[40:43], a[84:87], v[24:27]
    buffer_load_dwordx4 v209, s[4:7], s29 offen offset:3072 lds
    ds_read_b64_tr_b16 a[60:61], v217 offset:8544
    v_mfma_f32_16x16x32_bf16 v[28:31], a[44:47], a[84:87], v[28:31]
    ds_read_b64_tr_b16 a[62:63], v217 offset:8800
    ds_read_b128 a[68:71], v215 offset:512
    s_lshl_b32 s30, s28, 18
    s_add_u32 s28, s28, 1
    s_add_u32 m0, s32, 33792
    v_mfma_f32_16x16x32_bf16 v[28:31], a[12:15], a[64:67], v[28:31]
    buffer_load_dwordx4 v213, s[16:19], s30 offen lds
    ds_read_b128 a[88:91], v215 offset:576
    s_waitcnt lgkmcnt(14)
    v_mfma_f32_16x16x32_bf16 v[32:35], a[16:19], a[64:67], v[32:35]
    ds_read_b128 a[72:75], v215 offset:4224
    ds_read_b128 a[92:95], v215 offset:4288
    s_and_b32 s28, s28, 15
    s_add_u32 m0, s32, 34848
    v_mfma_f32_16x16x32_bf16 v[32:35], a[48:51], a[84:87], v[32:35]
    buffer_load_dwordx4 v214, s[16:19], s30 offen lds
    ds_read_b128 a[76:79], v215 offset:4736
    s_waitcnt lgkmcnt(13)
    v_mfma_f32_16x16x32_bf16 v[36:39], a[52:55], a[84:87], v[36:39]
    ds_read_b128 a[96:99], v215 offset:4800
    v_add_u32 v215, 0x9480, v215
    v_add_u32 v212, 0x9480, v212
    v_mfma_f32_16x16x32_bf16 v[36:39], a[20:23], a[64:67], v[36:39]
    s_waitcnt lgkmcnt(10)
    v_mfma_f32_16x16x32_bf16 v[40:43], a[24:27], a[64:67], v[40:43]
    v_mfma_f32_16x16x32_bf16 v[40:43], a[56:59], a[84:87], v[40:43]
    s_waitcnt lgkmcnt(6)
    v_mfma_f32_16x16x32_bf16 v[44:47], a[60:63], a[84:87], v[44:47]
    v_mfma_f32_16x16x32_bf16 v[44:47], a[28:31], a[64:67], v[44:47]
    s_waitcnt lgkmcnt(4)
    v_mfma_f32_16x16x32_bf16 v[48:51], a[0:3], a[68:71], v[48:51]
    v_mfma_f32_16x16x32_bf16 v[48:51], a[32:35], a[88:91], v[48:51]
    v_mfma_f32_16x16x32_bf16 v[52:55], a[36:39], a[88:91], v[52:55]
    v_mfma_f32_16x16x32_bf16 v[52:55], a[4:7], a[68:71], v[52:55]
    v_mfma_f32_16x16x32_bf16 v[56:59], a[8:11], a[68:71], v[56:59]
    v_mfma_f32_16x16x32_bf16 v[56:59], a[40:43], a[88:91], v[56:59]
    v_mfma_f32_16x16x32_bf16 v[60:63], a[44:47], a[88:91], v[60:63]
    s_waitcnt lgkmcnt(0)
    v_mfma_f32_16x16x32_bf16 v[60:63], a[12:15], a[68:71], v[60:63]
    s_waitcnt vmcnt(11)
    s_barrier
    v_mfma_f32_16x16x32_bf16 v[64:67], a[16:19], a[68:71], v[64:67]
    ds_read_b128 a[224:227], v212 offset:0
    ds_read_b128 a[248:251], v212 offset:64
    s_lshl_b32 s30, s28, 18
    v_mfma_f32_16x16x32_bf16 v[64:67], a[48:51], a[88:91], v[64:67]
    ds_read_b128 a[208:211], v215 offset:0
    ds_read_b128 a[232:235], v215 offset:64
    s_add_u32 s28, s28, 1
    s_add_u32 m0, s32, 0
    v_mfma_f32_16x16x32_bf16 v[68:71], a[52:55], a[88:91], v[68:71]
    buffer_load_dwordx4 v213, s[16:19], s30 offen lds
    ds_read_b64_tr_b16 a[112:113], v216 offset:16896
    v_mfma_f32_16x16x32_bf16 v[68:71], a[20:23], a[68:71], v[68:71]
    ds_read_b64_tr_b16 a[114:115], v216 offset:17152
    ds_read_b64_tr_b16 a[176:177], v216 offset:25344
    s_and_b32 s28, s28, 15
    s_add_u32 m0, s32, 1056
    v_mfma_f32_16x16x32_bf16 v[72:75], a[24:27], a[68:71], v[72:75]
    buffer_load_dwordx4 v214, s[16:19], s30 offen lds
    ds_read_b64_tr_b16 a[178:179], v216 offset:25600
    s_lshl_b32 s29, s3, 7
    v_mfma_f32_16x16x32_bf16 v[72:75], a[56:59], a[88:91], v[72:75]
    ds_read_b64_tr_b16 a[116:117], v216 offset:16928
    ds_read_b64_tr_b16 a[118:119], v216 offset:17184
    s_add_u32 s3, s3, 1
    s_add_u32 m0, s101, 71808
    v_mfma_f32_16x16x32_bf16 v[76:79], a[60:63], a[88:91], v[76:79]
    buffer_load_dwordx4 v210, s[4:7], s29 offen lds
    ds_read_b64_tr_b16 a[180:181], v216 offset:25376
    v_mfma_f32_16x16x32_bf16 v[76:79], a[28:31], a[68:71], v[76:79]
    ds_read_b64_tr_b16 a[182:183], v216 offset:25632
    ds_read_b64_tr_b16 a[120:121], v216 offset:16960
    s_and_b32 s3, s3, 7
    s_add_u32 m0, s31, 38016
    v_mfma_f32_16x16x32_bf16 v[80:83], a[0:3], a[72:75], v[80:83]
    buffer_load_dwordx4 v208, s[4:7], s29 offen offset:0 lds
    ds_read_b64_tr_b16 a[122:123], v216 offset:17216
    v_mfma_f32_16x16x32_bf16 v[80:83], a[32:35], a[92:95], v[80:83]
    ds_read_b64_tr_b16 a[184:185], v216 offset:25408
    ds_read_b64_tr_b16 a[186:187], v216 offset:25664
    s_add_u32 m0, s31, 38048
    v_mfma_f32_16x16x32_bf16 v[84:87], a[36:39], a[92:95], v[84:87]
    buffer_load_dwordx4 v208, s[4:7], s29 offen offset:1024 lds
    ds_read_b64_tr_b16 a[124:125], v216 offset:16992
    v_mfma_f32_16x16x32_bf16 v[84:87], a[4:7], a[72:75], v[84:87]
    ds_read_b64_tr_b16 a[126:127], v216 offset:17248
    ds_read_b64_tr_b16 a[188:189], v216 offset:25440
    s_add_u32 m0, s31, 38080
    v_mfma_f32_16x16x32_bf16 v[88:91], a[8:11], a[72:75], v[88:91]
    buffer_load_dwordx4 v208, s[4:7], s29 offen offset:2048 lds
    ds_read_b64_tr_b16 a[190:191], v216 offset:25696
    v_mfma_f32_16x16x32_bf16 v[88:91], a[40:43], a[92:95], v[88:91]
    ds_read_b64_tr_b16 a[128:129], v217 offset:16896
    ds_read_b64_tr_b16 a[130:131], v217 offset:17152
    s_add_u32 m0, s31, 38112
    v_mfma_f32_16x16x32_bf16 v[92:95], a[44:47], a[92:95], v[92:95]
    buffer_load_dwordx4 v208, s[4:7], s29 offen offset:3072 lds
    v_mfma_f32_16x16x32_bf16 v[92:95], a[12:15], a[72:75], v[92:95]
    ds_read_b64_tr_b16 a[192:193], v217 offset:25344
    ds_read_b64_tr_b16 a[194:195], v217 offset:25600
    s_add_u32 m0, s31, 42240
    v_mfma_f32_16x16x32_bf16 v[96:99], a[16:19], a[72:75], v[96:99]
    buffer_load_dwordx4 v209, s[4:7], s29 offen offset:0 lds
    v_mfma_f32_16x16x32_bf16 v[96:99], a[48:51], a[92:95], v[96:99]
    ds_read_b64_tr_b16 a[132:133], v217 offset:16928
    ds_read_b64_tr_b16 a[134:135], v217 offset:17184
    s_add_u32 m0, s31, 42272
    v_mfma_f32_16x16x32_bf16 v[100:103], a[52:55], a[92:95], v[100:103]
    buffer_load_dwordx4 v209, s[4:7], s29 offen offset:1024 lds
    v_mfma_f32_16x16x32_bf16 v[100:103], a[20:23], a[72:75], v[100:103]
    ds_read_b64_tr_b16 a[196:197], v217 offset:25376
    ds_read_b64_tr_b16 a[198:199], v217 offset:25632
    s_add_u32 m0, s31, 42304
    v_mfma_f32_16x16x32_bf16 v[104:107], a[24:27], a[72:75], v[104:107]
    buffer_load_dwordx4 v209, s[4:7], s29 offen offset:2048 lds
    v_mfma_f32_16x16x32_bf16 v[104:107], a[56:59], a[92:95], v[104:107]
    ds_read_b64_tr_b16 a[136:137], v217 offset:16960
    ds_read_b64_tr_b16 a[138:139], v217 offset:17216
    s_add_u32 m0, s31, 42336
    v_mfma_f32_16x16x32_bf16 v[108:111], a[60:63], a[92:95], v[108:111]
    buffer_load_dwordx4 v209, s[4:7], s29 offen offset:3072 lds
    s_lshl_b32 s30, s28, 18
    v_mfma_f32_16x16x32_bf16 v[108:111], a[28:31], a[72:75], v[108:111]
    ds_read_b64_tr_b16 a[200:201], v217 offset:25408
    ds_read_b64_tr_b16 a[202:203], v217 offset:25664
    s_add_u32 s28, s28, 1
    s_add_u32 m0, s32, 8448
    v_mfma_f32_16x16x32_bf16 v[112:115], a[0:3], a[76:79], v[112:115]
    buffer_load_dwordx4 v213, s[16:19], s30 offen lds
    v_mfma_f32_16x16x32_bf16 v[112:115], a[32:35], a[96:99], v[112:115]
    ds_read_b64_tr_b16 a[140:141], v217 offset:16992
    ds_read_b64_tr_b16 a[142:143], v217 offset:17248
    s_and_b32 s28, s28, 15
    s_add_u32 m0, s32, 9504
    v_mfma_f32_16x16x32_bf16 v[116:119], a[36:39], a[96:99], v[116:119]
    buffer_load_dwordx4 v214, s[16:19], s30 offen lds
    v_mfma_f32_16x16x32_bf16 v[116:119], a[4:7], a[76:79], v[116:119]
    ds_read_b64_tr_b16 a[204:205], v217 offset:25440
    ds_read_b64_tr_b16 a[206:207], v217 offset:25696
    v_mfma_f32_16x16x32_bf16 v[120:123], a[8:11], a[76:79], v[120:123]
    ds_read_b128 a[212:215], v215 offset:512
    ds_read_b128 a[236:239], v215 offset:576
    v_mfma_f32_16x16x32_bf16 v[120:123], a[40:43], a[96:99], v[120:123]
    ds_read_b128 a[216:219], v215 offset:4224
    ds_read_b128 a[240:243], v215 offset:4288
    v_mfma_f32_16x16x32_bf16 v[124:127], a[44:47], a[96:99], v[124:127]
    ds_read_b128 a[220:223], v215 offset:4736
    ds_read_b128 a[244:247], v215 offset:4800
    v_mfma_f32_16x16x32_bf16 v[124:127], a[12:15], a[76:79], v[124:127]
    v_mfma_f32_16x16x32_bf16 v[128:131], a[16:19], a[76:79], v[128:131]
    v_mfma_f32_16x16x32_bf16 v[128:131], a[48:51], a[96:99], v[128:131]
    v_mfma_f32_16x16x32_bf16 v[132:135], a[52:55], a[96:99], v[132:135]
    v_mfma_f32_16x16x32_bf16 v[132:135], a[20:23], a[76:79], v[132:135]
    v_mfma_f32_16x16x32_bf16 v[136:139], a[24:27], a[76:79], v[136:139]
    v_mfma_f32_16x16x32_bf16 v[136:139], a[56:59], a[96:99], v[136:139]
    v_mfma_f32_16x16x32_bf16 v[140:143], a[60:63], a[96:99], v[140:143]
    v_mfma_f32_16x16x32_bf16 v[140:143], a[28:31], a[76:79], v[140:143]
    s_waitcnt lgkmcnt(0)
    v_mfma_f32_16x16x32_bf16 v[144:147], a[112:115], a[224:227], v[144:147]
    v_add_u32 v215, 0xfffed700, v215
    v_add_u32 v212, 0xfffed700, v212
    v_mfma_f32_16x16x32_bf16 v[144:147], a[176:179], a[248:251], v[144:147]
    v_mfma_f32_16x16x32_bf16 v[148:151], a[180:183], a[248:251], v[148:151]
    v_mfma_f32_16x16x32_bf16 v[148:151], a[116:119], a[224:227], v[148:151]
    v_mfma_f32_16x16x32_bf16 v[152:155], a[120:123], a[224:227], v[152:155]
    v_mfma_f32_16x16x32_bf16 v[152:155], a[184:187], a[248:251], v[152:155]
    v_mfma_f32_16x16x32_bf16 v[156:159], a[188:191], a[248:251], v[156:159]
    v_mfma_f32_16x16x32_bf16 v[156:159], a[124:127], a[224:227], v[156:159]
    v_mfma_f32_16x16x32_bf16 v[16:19], a[112:115], a[208:211], v[16:19]
    v_mfma_f32_16x16x32_bf16 v[16:19], a[176:179], a[232:235], v[16:19]
    s_waitcnt vmcnt(11)
    s_barrier
    v_mfma_f32_16x16x32_bf16 v[20:23], a[180:183], a[232:235], v[20:23]
    ds_read_b128 a[80:83], v212 offset:0
    ds_read_b128 a[100:103], v212 offset:64
    s_lshl_b32 s30, s28, 18
    v_mfma_f32_16x16x32_bf16 v[20:23], a[116:119], a[208:211], v[20:23]
    ds_read_b128 a[64:67], v215 offset:0
    s_add_u32 s28, s28, 1
    s_add_u32 m0, s32, 16896
    v_mfma_f32_16x16x32_bf16 v[24:27], a[120:123], a[208:211], v[24:27]
    buffer_load_dwordx4 v213, s[16:19], s30 offen lds
    v_mfma_f32_16x16x32_bf16 v[24:27], a[184:187], a[232:235], v[24:27]
    ds_read_b128 a[84:87], v215 offset:64
    ds_read_b64_tr_b16 a[0:1], v216 offset:33792
    v_mfma_f32_16x16x32_bf16 v[28:31], a[188:191], a[232:235], v[28:31]
    ds_read_b64_tr_b16 a[2:3], v216 offset:34048
    v_mfma_f32_16x16x32_bf16 v[28:31], a[124:127], a[208:211], v[28:31]
    ds_read_b64_tr_b16 a[32:33], v216 offset:0
    s_and_b32 s28, s28, 15
    s_add_u32 m0, s32, 17952
    v_mfma_f32_16x16x32_bf16 v[32:35], a[128:131], a[208:211], v[32:35]
    buffer_load_dwordx4 v214, s[16:19], s30 offen lds
    v_mfma_f32_16x16x32_bf16 v[32:35], a[192:195], a[232:235], v[32:35]
    ds_read_b64_tr_b16 a[34:35], v216 offset:256
    v_mfma_f32_16x16x32_bf16 v[36:39], a[196:199], a[232:235], v[36:39]
    ds_read_b64_tr_b16 a[4:5], v216 offset:33824
    s_lshl_b32 s29, s3, 7
    v_mfma_f32_16x16x32_bf16 v[36:39], a[132:135], a[208:211], v[36:39]
    ds_read_b64_tr_b16 a[6:7], v216 offset:34080
    s_add_u32 s3, s3, 1
    s_add_u32 m0, s101, 109824
    v_mfma_f32_16x16x32_bf16 v[40:43], a[136:139], a[208:211], v[40:43]
    buffer_load_dwordx4 v210, s[4:7], s29 offen lds
    v_mfma_f32_16x16x32_bf16 v[40:43], a[200:203], a[232:235], v[40:43]
    ds_read_b64_tr_b16 a[36:37], v216 offset:32
    v_mfma_f32_16x16x32_bf16 v[44:47], a[204:207], a[232:235], v[44:47]
    ds_read_b64_tr_b16 a[38:39], v216 offset:288
    v_mfma_f32_16x16x32_bf16 v[44:47], a[140:143], a[208:211], v[44:47]
    ds_read_b64_tr_b16 a[8:9], v216 offset:33856
    s_and_b32 s3, s3, 7
    s_add_u32 m0, s31, 76032
    v_mfma_f32_16x16x32_bf16 v[48:51], a[112:115], a[212:215], v[48:51]
    buffer_load_dwordx4 v208, s[4:7], s29 offen offset:0 lds
    v_mfma_f32_16x16x32_bf16 v[48:51], a[176:179], a[236:239], v[48:51]
    ds_read_b64_tr_b16 a[10:11], v216 offset:34112
    v_mfma_f32_16x16x32_bf16 v[52:55], a[180:183], a[236:239], v[52:55]
    ds_read_b64_tr_b16 a[40:41], v216 offset:64
    v_mfma_f32_16x16x32_bf16 v[52:55], a[116:119], a[212:215], v[52:55]
    ds_read_b64_tr_b16 a[42:43], v216 offset:320
    s_add_u32 m0, s31, 76064
    v_mfma_f32_16x16x32_bf16 v[56:59], a[120:123], a[212:215], v[56:59]
    buffer_load_dwordx4 v208, s[4:7], s29 offen offset:1024 lds
    v_mfma_f32_16x16x32_bf16 v[56:59], a[184:187], a[236:239], v[56:59]
    ds_read_b64_tr_b16 a[12:13], v216 offset:33888
    v_mfma_f32_16x16x32_bf16 v[60:63], a[188:191], a[236:239], v[60:63]
    ds_read_b64_tr_b16 a[14:15], v216 offset:34144
    v_mfma_f32_16x16x32_bf16 v[60:63], a[124:127], a[212:215], v[60:63]
    ds_read_b64_tr_b16 a[44:45], v216 offset:96
    s_add_u32 m0, s31, 76096
    v_mfma_f32_16x16x32_bf16 v[64:67], a[128:131], a[212:215], v[64:67]
    buffer_load_dwordx4 v208, s[4:7], s29 offen offset:2048 lds
    v_mfma_f32_16x16x32_bf16 v[64:67], a[192:195], a[236:239], v[64:67]
    ds_read_b64_tr_b16 a[46:47], v216 offset:352
    v_mfma_f32_16x16x32_bf16 v[68:71], a[196:199], a[236:239], v[68:71]
    ds_read_b64_tr_b16 a[16:17], v217 offset:33792
    v_mfma_f32_16x16x32_bf16 v[68:71], a[132:135], a[212:215], v[68:71]
    ds_read_b64_tr_b16 a[18:19], v217 offset:34048
    s_add_u32 m0, s31, 76128
    v_mfma_f32_16x16x32_bf16 v[72:75], a[136:139], a[212:215], v[72:75]
    buffer_load_dwordx4 v208, s[4:7], s29 offen offset:3072 lds
    v_mfma_f32_16x16x32_bf16 v[72:75], a[200:203], a[236:239], v[72:75]
    ds_read_b64_tr_b16 a[48:49], v217 offset:0
    v_mfma_f32_16x16x32_bf16 v[76:79], a[204:207], a[236:239], v[76:79]
    ds_read_b64_tr_b16 a[50:51], v217 offset:256
    v_mfma_f32_16x16x32_bf16 v[76:79], a[140:143], a[212:215], v[76:79]
    ds_read_b64_tr_b16 a[20:21], v217 offset:33824
    s_add_u32 m0, s31, 80256
    v_mfma_f32_16x16x32_bf16 v[80:83], a[112:115], a[216:219], v[80:83]
    buffer_load_dwordx4 v209, s[4:7], s29 offen offset:0 lds
    v_mfma_f32_16x16x32_bf16 v[80:83], a[176:179], a[240:243], v[80:83]
    ds_read_b64_tr_b16 a[22:23], v217 offset:34080
    v_mfma_f32_16x16x32_bf16 v[84:87], a[180:183], a[240:243], v[84:87]
    ds_read_b64_tr_b16 a[52:53], v217 offset:32
    v_mfma_f32_16x16x32_bf16 v[84:87], a[116:119], a[216:219], v[84:87]
    ds_read_b64_tr_b16 a[54:55], v217 offset:288
    s_add_u32 m0, s31, 80288
    v_mfma_f32_16x16x32_bf16 v[88:91], a[120:123], a[216:219], v[88:91]
    buffer_load_dwordx4 v209, s[4:7], s29 offen offset:1024 lds
    v_mfma_f32_16x16x32_bf16 v[88:91], a[184:187], a[240:243], v[88:91]
    ds_read_b64_tr_b16 a[24:25], v217 offset:33856
    v_mfma_f32_16x16x32_bf16 v[92:95], a[188:191], a[240:243], v[92:95]
    ds_read_b64_tr_b16 a[26:27], v217 offset:34112
    v_mfma_f32_16x16x32_bf16 v[92:95], a[124:127], a[216:219], v[92:95]
    ds_read_b64_tr_b16 a[56:57], v217 offset:64
    s_add_u32 m0, s31, 80320
    v_mfma_f32_16x16x32_bf16 v[96:99], a[128:131], a[216:219], v[96:99]
    buffer_load_dwordx4 v209, s[4:7], s29 offen offset:2048 lds
    v_mfma_f32_16x16x32_bf16 v[96:99], a[192:195], a[240:243], v[96:99]
    ds_read_b64_tr_b16 a[58:59], v217 offset:320
    v_mfma_f32_16x16x32_bf16 v[100:103], a[196:199], a[240:243], v[100:103]
    ds_read_b64_tr_b16 a[28:29], v217 offset:33888
    v_mfma_f32_16x16x32_bf16 v[100:103], a[132:135], a[216:219], v[100:103]
    ds_read_b64_tr_b16 a[30:31], v217 offset:34144
    s_add_u32 m0, s31, 80352
    v_mfma_f32_16x16x32_bf16 v[104:107], a[136:139], a[216:219], v[104:107]
    buffer_load_dwordx4 v209, s[4:7], s29 offen offset:3072 lds
    v_mfma_f32_16x16x32_bf16 v[104:107], a[200:203], a[240:243], v[104:107]
    ds_read_b64_tr_b16 a[60:61], v217 offset:96
    v_mfma_f32_16x16x32_bf16 v[108:111], a[204:207], a[240:243], v[108:111]
    ds_read_b64_tr_b16 a[62:63], v217 offset:352
    s_lshl_b32 s30, s28, 18
    v_mfma_f32_16x16x32_bf16 v[108:111], a[140:143], a[216:219], v[108:111]
    ds_read_b128 a[68:71], v215 offset:512
    s_add_u32 s28, s28, 1
    s_add_u32 m0, s32, 25344
    v_mfma_f32_16x16x32_bf16 v[112:115], a[112:115], a[220:223], v[112:115]
    buffer_load_dwordx4 v213, s[16:19], s30 offen lds
    v_mfma_f32_16x16x32_bf16 v[112:115], a[176:179], a[244:247], v[112:115]
    ds_read_b128 a[88:91], v215 offset:576
    v_mfma_f32_16x16x32_bf16 v[116:119], a[180:183], a[244:247], v[116:119]
    ds_read_b128 a[72:75], v215 offset:4224
    v_mfma_f32_16x16x32_bf16 v[116:119], a[116:119], a[220:223], v[116:119]
    ds_read_b128 a[92:95], v215 offset:4288
    s_and_b32 s28, s28, 15
    s_add_u32 m0, s32, 26400
    v_mfma_f32_16x16x32_bf16 v[120:123], a[120:123], a[220:223], v[120:123]
    buffer_load_dwordx4 v214, s[16:19], s30 offen lds
    v_mfma_f32_16x16x32_bf16 v[120:123], a[184:187], a[244:247], v[120:123]
    ds_read_b128 a[76:79], v215 offset:4736
    v_mfma_f32_16x16x32_bf16 v[124:127], a[188:191], a[244:247], v[124:127]
    ds_read_b128 a[96:99], v215 offset:4800
    v_mfma_f32_16x16x32_bf16 v[124:127], a[124:127], a[220:223], v[124:127]
    v_mfma_f32_16x16x32_bf16 v[128:131], a[128:131], a[220:223], v[128:131]
    v_mfma_f32_16x16x32_bf16 v[128:131], a[192:195], a[244:247], v[128:131]
    v_mfma_f32_16x16x32_bf16 v[132:135], a[196:199], a[244:247], v[132:135]
    v_mfma_f32_16x16x32_bf16 v[132:135], a[132:135], a[220:223], v[132:135]
    v_mfma_f32_16x16x32_bf16 v[136:139], a[136:139], a[220:223], v[136:139]
    v_mfma_f32_16x16x32_bf16 v[136:139], a[200:203], a[244:247], v[136:139]
    v_mfma_f32_16x16x32_bf16 v[140:143], a[204:207], a[244:247], v[140:143]
    v_mfma_f32_16x16x32_bf16 v[140:143], a[140:143], a[220:223], v[140:143]
    s_waitcnt lgkmcnt(0)
    v_mfma_f32_16x16x32_bf16 v[144:147], a[0:3], a[80:83], v[144:147]
    v_add_u32 v215, 0x9480, v215
    v_add_u32 v212, 0x9480, v212
    v_mfma_f32_16x16x32_bf16 v[144:147], a[32:35], a[100:103], v[144:147]
    v_mfma_f32_16x16x32_bf16 v[148:151], a[36:39], a[100:103], v[148:151]
    v_mfma_f32_16x16x32_bf16 v[148:151], a[4:7], a[80:83], v[148:151]
    v_mfma_f32_16x16x32_bf16 v[152:155], a[8:11], a[80:83], v[152:155]
    v_mfma_f32_16x16x32_bf16 v[152:155], a[40:43], a[100:103], v[152:155]
    v_mfma_f32_16x16x32_bf16 v[156:159], a[44:47], a[100:103], v[156:159]
    v_mfma_f32_16x16x32_bf16 v[156:159], a[12:15], a[80:83], v[156:159]
    v_mfma_f32_16x16x32_bf16 v[16:19], a[0:3], a[64:67], v[16:19]
    v_mfma_f32_16x16x32_bf16 v[16:19], a[32:35], a[84:87], v[16:19]
    s_waitcnt vmcnt(11)
    s_barrier
    v_mfma_f32_16x16x32_bf16 v[20:23], a[36:39], a[84:87], v[20:23]
    ds_read_b128 a[224:227], v212 offset:0
    ds_read_b128 a[248:251], v212 offset:64
    s_lshl_b32 s30, s28, 18
    v_mfma_f32_16x16x32_bf16 v[20:23], a[4:7], a[64:67], v[20:23]
    ds_read_b128 a[208:211], v215 offset:0
    s_add_u32 s28, s28, 1
    s_add_u32 m0, s32, 33792
    v_mfma_f32_16x16x32_bf16 v[24:27], a[8:11], a[64:67], v[24:27]
    buffer_load_dwordx4 v213, s[16:19], s30 offen lds
    v_mfma_f32_16x16x32_bf16 v[24:27], a[40:43], a[84:87], v[24:27]
    ds_read_b128 a[232:235], v215 offset:64
    ds_read_b64_tr_b16 a[112:113], v216 offset:8448
    v_mfma_f32_16x16x32_bf16 v[28:31], a[44:47], a[84:87], v[28:31]
    ds_read_b64_tr_b16 a[114:115], v216 offset:8704
    v_mfma_f32_16x16x32_bf16 v[28:31], a[12:15], a[64:67], v[28:31]
    ds_read_b64_tr_b16 a[176:177], v216 offset:16896
    s_and_b32 s28, s28, 15
    s_add_u32 m0, s32, 34848
    v_mfma_f32_16x16x32_bf16 v[32:35], a[16:19], a[64:67], v[32:35]
    buffer_load_dwordx4 v214, s[16:19], s30 offen lds
    v_mfma_f32_16x16x32_bf16 v[32:35], a[48:51], a[84:87], v[32:35]
    ds_read_b64_tr_b16 a[178:179], v216 offset:17152
    v_mfma_f32_16x16x32_bf16 v[36:39], a[52:55], a[84:87], v[36:39]
    ds_read_b64_tr_b16 a[116:117], v216 offset:8480
    s_lshl_b32 s29, s3, 7
    v_mfma_f32_16x16x32_bf16 v[36:39], a[20:23], a[64:67], v[36:39]
    ds_read_b64_tr_b16 a[118:119], v216 offset:8736
    s_add_u32 s3, s3, 1
    s_add_u32 m0, s101, 33792
    v_mfma_f32_16x16x32_bf16 v[40:43], a[24:27], a[64:67], v[40:43]
    buffer_load_dwordx4 v210, s[4:7], s29 offen lds
    v_mfma_f32_16x16x32_bf16 v[40:43], a[56:59], a[84:87], v[40:43]
    ds_read_b64_tr_b16 a[180:181], v216 offset:16928
    v_mfma_f32_16x16x32_bf16 v[44:47], a[60:63], a[84:87], v[44:47]
    ds_read_b64_tr_b16 a[182:183], v216 offset:17184
    v_mfma_f32_16x16x32_bf16 v[44:47], a[28:31], a[64:67], v[44:47]
    ds_read_b64_tr_b16 a[120:121], v216 offset:8512
    s_and_b32 s3, s3, 7
    s_add_u32 m0, s31, 0
    v_mfma_f32_16x16x32_bf16 v[48:51], a[0:3], a[68:71], v[48:51]
    buffer_load_dwordx4 v208, s[4:7], s29 offen offset:0 lds
    v_mfma_f32_16x16x32_bf16 v[48:51], a[32:35], a[88:91], v[48:51]
    ds_read_b64_tr_b16 a[122:123], v216 offset:8768
    v_mfma_f32_16x16x32_bf16 v[52:55], a[36:39], a[88:91], v[52:55]
    ds_read_b64_tr_b16 a[184:185], v216 offset:16960
    v_mfma_f32_16x16x32_bf16 v[52:55], a[4:7], a[68:71], v[52:55]
    ds_read_b64_tr_b16 a[186:187], v216 offset:17216
    s_add_u32 m0, s31, 32
    v_mfma_f32_16x16x32_bf16 v[56:59], a[8:11], a[68:71], v[56:59]
    buffer_load_dwordx4 v208, s[4:7], s29 offen offset:1024 lds
    v_mfma_f32_16x16x32_bf16 v[56:59], a[40:43], a[88:91], v[56:59]
    ds_read_b64_tr_b16 a[124:125], v216 offset:8544
    v_mfma_f32_16x16x32_bf16 v[60:63], a[44:47], a[88:91], v[60:63]
    ds_read_b64_tr_b16 a[126:127], v216 offset:8800
    v_mfma_f32_16x16x32_bf16 v[60:63], a[12:15], a[68:71], v[60:63]
    ds_read_b64_tr_b16 a[188:189], v216 offset:16992
    s_add_u32 m0, s31, 64
    v_mfma_f32_16x16x32_bf16 v[64:67], a[16:19], a[68:71], v[64:67]
    buffer_load_dwordx4 v208, s[4:7], s29 offen offset:2048 lds
    v_mfma_f32_16x16x32_bf16 v[64:67], a[48:51], a[88:91], v[64:67]
    ds_read_b64_tr_b16 a[190:191], v216 offset:17248
    v_mfma_f32_16x16x32_bf16 v[68:71], a[52:55], a[88:91], v[68:71]
    ds_read_b64_tr_b16 a[128:129], v217 offset:8448
    v_mfma_f32_16x16x32_bf16 v[68:71], a[20:23], a[68:71], v[68:71]
    ds_read_b64_tr_b16 a[130:131], v217 offset:8704
    s_add_u32 m0, s31, 96
    v_mfma_f32_16x16x32_bf16 v[72:75], a[24:27], a[68:71], v[72:75]
    buffer_load_dwordx4 v208, s[4:7], s29 offen offset:3072 lds
    v_mfma_f32_16x16x32_bf16 v[72:75], a[56:59], a[88:91], v[72:75]
    ds_read_b64_tr_b16 a[192:193], v217 offset:16896
    v_mfma_f32_16x16x32_bf16 v[76:79], a[60:63], a[88:91], v[76:79]
    ds_read_b64_tr_b16 a[194:195], v217 offset:17152
    v_mfma_f32_16x16x32_bf16 v[76:79], a[28:31], a[68:71], v[76:79]
    ds_read_b64_tr_b16 a[132:133], v217 offset:8480
    s_add_u32 m0, s31, 4224
    v_mfma_f32_16x16x32_bf16 v[80:83], a[0:3], a[72:75], v[80:83]
    buffer_load_dwordx4 v209, s[4:7], s29 offen offset:0 lds
    v_mfma_f32_16x16x32_bf16 v[80:83], a[32:35], a[92:95], v[80:83]
    ds_read_b64_tr_b16 a[134:135], v217 offset:8736
    v_mfma_f32_16x16x32_bf16 v[84:87], a[36:39], a[92:95], v[84:87]
    ds_read_b64_tr_b16 a[196:197], v217 offset:16928
    v_mfma_f32_16x16x32_bf16 v[84:87], a[4:7], a[72:75], v[84:87]
    ds_read_b64_tr_b16 a[198:199], v217 offset:17184
    s_add_u32 m0, s31, 4256
    v_mfma_f32_16x16x32_bf16 v[88:91], a[8:11], a[72:75], v[88:91]
    buffer_load_dwordx4 v209, s[4:7], s29 offen offset:1024 lds
    v_mfma_f32_16x16x32_bf16 v[88:91], a[40:43], a[92:95], v[88:91]
    ds_read_b64_tr_b16 a[136:137], v217 offset:8512
    v_mfma_f32_16x16x32_bf16 v[92:95], a[44:47], a[92:95], v[92:95]
    ds_read_b64_tr_b16 a[138:139], v217 offset:8768
    v_mfma_f32_16x16x32_bf16 v[92:95], a[12:15], a[72:75], v[92:95]
    ds_read_b64_tr_b16 a[200:201], v217 offset:16960
    s_add_u32 m0, s31, 4288
    v_mfma_f32_16x16x32_bf16 v[96:99], a[16:19], a[72:75], v[96:99]
    buffer_load_dwordx4 v209, s[4:7], s29 offen offset:2048 lds
    v_mfma_f32_16x16x32_bf16 v[96:99], a[48:51], a[92:95], v[96:99]
    ds_read_b64_tr_b16 a[202:203], v217 offset:17216
    v_mfma_f32_16x16x32_bf16 v[100:103], a[52:55], a[92:95], v[100:103]
    ds_read_b64_tr_b16 a[140:141], v217 offset:8544
    v_mfma_f32_16x16x32_bf16 v[100:103], a[20:23], a[72:75], v[100:103]
    ds_read_b64_tr_b16 a[142:143], v217 offset:8800
    s_add_u32 m0, s31, 4320
    v_mfma_f32_16x16x32_bf16 v[104:107], a[24:27], a[72:75], v[104:107]
    buffer_load_dwordx4 v209, s[4:7], s29 offen offset:3072 lds
    v_mfma_f32_16x16x32_bf16 v[104:107], a[56:59], a[92:95], v[104:107]
    ds_read_b64_tr_b16 a[204:205], v217 offset:16992
    v_mfma_f32_16x16x32_bf16 v[108:111], a[60:63], a[92:95], v[108:111]
    ds_read_b64_tr_b16 a[206:207], v217 offset:17248
    s_lshl_b32 s30, s28, 18
    v_mfma_f32_16x16x32_bf16 v[108:111], a[28:31], a[72:75], v[108:111]
    ds_read_b128 a[212:215], v215 offset:512
    s_add_u32 s28, s28, 1
    s_add_u32 m0, s32, 0
    v_mfma_f32_16x16x32_bf16 v[112:115], a[0:3], a[76:79], v[112:115]
    buffer_load_dwordx4 v213, s[16:19], s30 offen lds
    v_mfma_f32_16x16x32_bf16 v[112:115], a[32:35], a[96:99], v[112:115]
    ds_read_b128 a[236:239], v215 offset:576
    v_mfma_f32_16x16x32_bf16 v[116:119], a[36:39], a[96:99], v[116:119]
    ds_read_b128 a[216:219], v215 offset:4224
    v_mfma_f32_16x16x32_bf16 v[116:119], a[4:7], a[76:79], v[116:119]
    ds_read_b128 a[240:243], v215 offset:4288
    s_and_b32 s28, s28, 15
    s_add_u32 m0, s32, 1056
    v_mfma_f32_16x16x32_bf16 v[120:123], a[8:11], a[76:79], v[120:123]
    buffer_load_dwordx4 v214, s[16:19], s30 offen lds
    v_mfma_f32_16x16x32_bf16 v[120:123], a[40:43], a[96:99], v[120:123]
    ds_read_b128 a[220:223], v215 offset:4736
    v_mfma_f32_16x16x32_bf16 v[124:127], a[44:47], a[96:99], v[124:127]
    ds_read_b128 a[244:247], v215 offset:4800
    v_mfma_f32_16x16x32_bf16 v[124:127], a[12:15], a[76:79], v[124:127]
    v_mfma_f32_16x16x32_bf16 v[128:131], a[16:19], a[76:79], v[128:131]
    v_mfma_f32_16x16x32_bf16 v[128:131], a[48:51], a[96:99], v[128:131]
    v_mfma_f32_16x16x32_bf16 v[132:135], a[52:55], a[96:99], v[132:135]
    v_mfma_f32_16x16x32_bf16 v[132:135], a[20:23], a[76:79], v[132:135]
    v_mfma_f32_16x16x32_bf16 v[136:139], a[24:27], a[76:79], v[136:139]
    v_mfma_f32_16x16x32_bf16 v[136:139], a[56:59], a[96:99], v[136:139]
    v_mfma_f32_16x16x32_bf16 v[140:143], a[60:63], a[96:99], v[140:143]
    v_mfma_f32_16x16x32_bf16 v[140:143], a[28:31], a[76:79], v[140:143]
    s_waitcnt lgkmcnt(0)
    v_mfma_f32_16x16x32_bf16 v[144:147], a[112:115], a[224:227], v[144:147]
    v_add_u32 v215, 0x9480, v215
    v_add_u32 v212, 0x9480, v212
    v_mfma_f32_16x16x32_bf16 v[144:147], a[176:179], a[248:251], v[144:147]
    v_mfma_f32_16x16x32_bf16 v[148:151], a[180:183], a[248:251], v[148:151]
    v_mfma_f32_16x16x32_bf16 v[148:151], a[116:119], a[224:227], v[148:151]
    v_mfma_f32_16x16x32_bf16 v[152:155], a[120:123], a[224:227], v[152:155]
    v_mfma_f32_16x16x32_bf16 v[152:155], a[184:187], a[248:251], v[152:155]
    v_mfma_f32_16x16x32_bf16 v[156:159], a[188:191], a[248:251], v[156:159]
    v_mfma_f32_16x16x32_bf16 v[156:159], a[124:127], a[224:227], v[156:159]
    v_mfma_f32_16x16x32_bf16 v[16:19], a[112:115], a[208:211], v[16:19]
    v_mfma_f32_16x16x32_bf16 v[16:19], a[176:179], a[232:235], v[16:19]
    s_waitcnt vmcnt(11)
    s_barrier
    v_mfma_f32_16x16x32_bf16 v[20:23], a[180:183], a[232:235], v[20:23]
    ds_read_b128 a[80:83], v212 offset:0
    ds_read_b128 a[100:103], v212 offset:64
    s_lshl_b32 s30, s28, 18
    v_mfma_f32_16x16x32_bf16 v[20:23], a[116:119], a[208:211], v[20:23]
    ds_read_b128 a[64:67], v215 offset:0
    s_add_u32 s28, s28, 1
    s_add_u32 m0, s32, 8448
    v_mfma_f32_16x16x32_bf16 v[24:27], a[120:123], a[208:211], v[24:27]
    buffer_load_dwordx4 v213, s[16:19], s30 offen lds
    v_mfma_f32_16x16x32_bf16 v[24:27], a[184:187], a[232:235], v[24:27]
    ds_read_b128 a[84:87], v215 offset:64
    ds_read_b64_tr_b16 a[0:1], v216 offset:25344
    v_mfma_f32_16x16x32_bf16 v[28:31], a[188:191], a[232:235], v[28:31]
    ds_read_b64_tr_b16 a[2:3], v216 offset:25600
    v_mfma_f32_16x16x32_bf16 v[28:31], a[124:127], a[208:211], v[28:31]
    ds_read_b64_tr_b16 a[32:33], v216 offset:33792
    s_and_b32 s28, s28, 15
    s_add_u32 m0, s32, 9504
    v_mfma_f32_16x16x32_bf16 v[32:35], a[128:131], a[208:211], v[32:35]
    buffer_load_dwordx4 v214, s[16:19], s30 offen lds
    v_mfma_f32_16x16x32_bf16 v[32:35], a[192:195], a[232:235], v[32:35]
    ds_read_b64_tr_b16 a[34:35], v216 offset:34048
    v_mfma_f32_16x16x32_bf16 v[36:39], a[196:199], a[232:235], v[36:39]
    ds_read_b64_tr_b16 a[4:5], v216 offset:25376
    s_lshl_b32 s29, s3, 7
    v_mfma_f32_16x16x32_bf16 v[36:39], a[132:135], a[208:211], v[36:39]
    ds_read_b64_tr_b16 a[6:7], v216 offset:25632
    s_add_u32 s3, s3, 1
    s_add_u32 m0, s101, 71808
    v_mfma_f32_16x16x32_bf16 v[40:43], a[136:139], a[208:211], v[40:43]
    buffer_load_dwordx4 v210, s[4:7], s29 offen lds
    v_mfma_f32_16x16x32_bf16 v[40:43], a[200:203], a[232:235], v[40:43]
    ds_read_b64_tr_b16 a[36:37], v216 offset:33824
    v_mfma_f32_16x16x32_bf16 v[44:47], a[204:207], a[232:235], v[44:47]
    ds_read_b64_tr_b16 a[38:39], v216 offset:34080
    v_mfma_f32_16x16x32_bf16 v[44:47], a[140:143], a[208:211], v[44:47]
    ds_read_b64_tr_b16 a[8:9], v216 offset:25408
    s_and_b32 s3, s3, 7
    s_add_u32 m0, s31, 38016
    v_mfma_f32_16x16x32_bf16 v[48:51], a[112:115], a[212:215], v[48:51]
    buffer_load_dwordx4 v208, s[4:7], s29 offen offset:0 lds
    v_mfma_f32_16x16x32_bf16 v[48:51], a[176:179], a[236:239], v[48:51]
    ds_read_b64_tr_b16 a[10:11], v216 offset:25664
    v_mfma_f32_16x16x32_bf16 v[52:55], a[180:183], a[236:239], v[52:55]
    ds_read_b64_tr_b16 a[40:41], v216 offset:33856
    v_mfma_f32_16x16x32_bf16 v[52:55], a[116:119], a[212:215], v[52:55]
    ds_read_b64_tr_b16 a[42:43], v216 offset:34112
    s_add_u32 m0, s31, 38048
    v_mfma_f32_16x16x32_bf16 v[56:59], a[120:123], a[212:215], v[56:59]
    buffer_load_dwordx4 v208, s[4:7], s29 offen offset:1024 lds
    v_mfma_f32_16x16x32_bf16 v[56:59], a[184:187], a[236:239], v[56:59]
    ds_read_b64_tr_b16 a[12:13], v216 offset:25440
    v_mfma_f32_16x16x32_bf16 v[60:63], a[188:191], a[236:239], v[60:63]
    ds_read_b64_tr_b16 a[14:15], v216 offset:25696
    v_mfma_f32_16x16x32_bf16 v[60:63], a[124:127], a[212:215], v[60:63]
    ds_read_b64_tr_b16 a[44:45], v216 offset:33888
    s_add_u32 m0, s31, 38080
    v_mfma_f32_16x16x32_bf16 v[64:67], a[128:131], a[212:215], v[64:67]
    buffer_load_dwordx4 v208, s[4:7], s29 offen offset:2048 lds
    v_mfma_f32_16x16x32_bf16 v[64:67], a[192:195], a[236:239], v[64:67]
    ds_read_b64_tr_b16 a[46:47], v216 offset:34144
    v_mfma_f32_16x16x32_bf16 v[68:71], a[196:199], a[236:239], v[68:71]
    ds_read_b64_tr_b16 a[16:17], v217 offset:25344
    v_mfma_f32_16x16x32_bf16 v[68:71], a[132:135], a[212:215], v[68:71]
    ds_read_b64_tr_b16 a[18:19], v217 offset:25600
    s_add_u32 m0, s31, 38112
    v_mfma_f32_16x16x32_bf16 v[72:75], a[136:139], a[212:215], v[72:75]
    buffer_load_dwordx4 v208, s[4:7], s29 offen offset:3072 lds
    v_mfma_f32_16x16x32_bf16 v[72:75], a[200:203], a[236:239], v[72:75]
    ds_read_b64_tr_b16 a[48:49], v217 offset:33792
    v_mfma_f32_16x16x32_bf16 v[76:79], a[204:207], a[236:239], v[76:79]
    ds_read_b64_tr_b16 a[50:51], v217 offset:34048
    v_mfma_f32_16x16x32_bf16 v[76:79], a[140:143], a[212:215], v[76:79]
    ds_read_b64_tr_b16 a[20:21], v217 offset:25376
    s_add_u32 m0, s31, 42240
    v_mfma_f32_16x16x32_bf16 v[80:83], a[112:115], a[216:219], v[80:83]
    buffer_load_dwordx4 v209, s[4:7], s29 offen offset:0 lds
    v_mfma_f32_16x16x32_bf16 v[80:83], a[176:179], a[240:243], v[80:83]
    ds_read_b64_tr_b16 a[22:23], v217 offset:25632
    v_mfma_f32_16x16x32_bf16 v[84:87], a[180:183], a[240:243], v[84:87]
    ds_read_b64_tr_b16 a[52:53], v217 offset:33824
    v_mfma_f32_16x16x32_bf16 v[84:87], a[116:119], a[216:219], v[84:87]
    ds_read_b64_tr_b16 a[54:55], v217 offset:34080
    s_add_u32 m0, s31, 42272
    v_mfma_f32_16x16x32_bf16 v[88:91], a[120:123], a[216:219], v[88:91]
    buffer_load_dwordx4 v209, s[4:7], s29 offen offset:1024 lds
    v_mfma_f32_16x16x32_bf16 v[88:91], a[184:187], a[240:243], v[88:91]
    ds_read_b64_tr_b16 a[24:25], v217 offset:25408
    v_mfma_f32_16x16x32_bf16 v[92:95], a[188:191], a[240:243], v[92:95]
    ds_read_b64_tr_b16 a[26:27], v217 offset:25664
    v_mfma_f32_16x16x32_bf16 v[92:95], a[124:127], a[216:219], v[92:95]
    ds_read_b64_tr_b16 a[56:57], v217 offset:33856
    s_add_u32 m0, s31, 42304
    v_mfma_f32_16x16x32_bf16 v[96:99], a[128:131], a[216:219], v[96:99]
    buffer_load_dwordx4 v209, s[4:7], s29 offen offset:2048 lds
    v_mfma_f32_16x16x32_bf16 v[96:99], a[192:195], a[240:243], v[96:99]
    ds_read_b64_tr_b16 a[58:59], v217 offset:34112
    v_mfma_f32_16x16x32_bf16 v[100:103], a[196:199], a[240:243], v[100:103]
    ds_read_b64_tr_b16 a[28:29], v217 offset:25440
    v_mfma_f32_16x16x32_bf16 v[100:103], a[132:135], a[216:219], v[100:103]
    ds_read_b64_tr_b16 a[30:31], v217 offset:25696
    s_add_u32 m0, s31, 42336
    v_mfma_f32_16x16x32_bf16 v[104:107], a[136:139], a[216:219], v[104:107]
    buffer_load_dwordx4 v209, s[4:7], s29 offen offset:3072 lds
    v_mfma_f32_16x16x32_bf16 v[104:107], a[200:203], a[240:243], v[104:107]
    ds_read_b64_tr_b16 a[60:61], v217 offset:33888
    v_mfma_f32_16x16x32_bf16 v[108:111], a[204:207], a[240:243], v[108:111]
    ds_read_b64_tr_b16 a[62:63], v217 offset:34144
    s_lshl_b32 s30, s28, 18
    v_mfma_f32_16x16x32_bf16 v[108:111], a[140:143], a[216:219], v[108:111]
    ds_read_b128 a[68:71], v215 offset:512
    s_add_u32 s28, s28, 1
    s_add_u32 m0, s32, 16896
    v_mfma_f32_16x16x32_bf16 v[112:115], a[112:115], a[220:223], v[112:115]
    buffer_load_dwordx4 v213, s[16:19], s30 offen lds
    v_mfma_f32_16x16x32_bf16 v[112:115], a[176:179], a[244:247], v[112:115]
    ds_read_b128 a[88:91], v215 offset:576
    v_mfma_f32_16x16x32_bf16 v[116:119], a[180:183], a[244:247], v[116:119]
    ds_read_b128 a[72:75], v215 offset:4224
    v_mfma_f32_16x16x32_bf16 v[116:119], a[116:119], a[220:223], v[116:119]
    ds_read_b128 a[92:95], v215 offset:4288
    s_and_b32 s28, s28, 15
    s_add_u32 m0, s32, 17952
    v_mfma_f32_16x16x32_bf16 v[120:123], a[120:123], a[220:223], v[120:123]
    buffer_load_dwordx4 v214, s[16:19], s30 offen lds
    v_mfma_f32_16x16x32_bf16 v[120:123], a[184:187], a[244:247], v[120:123]
    ds_read_b128 a[76:79], v215 offset:4736
    v_mfma_f32_16x16x32_bf16 v[124:127], a[188:191], a[244:247], v[124:127]
    ds_read_b128 a[96:99], v215 offset:4800
    v_mfma_f32_16x16x32_bf16 v[124:127], a[124:127], a[220:223], v[124:127]
    v_mfma_f32_16x16x32_bf16 v[128:131], a[128:131], a[220:223], v[128:131]
    v_mfma_f32_16x16x32_bf16 v[128:131], a[192:195], a[244:247], v[128:131]
    v_mfma_f32_16x16x32_bf16 v[132:135], a[196:199], a[244:247], v[132:135]
    v_mfma_f32_16x16x32_bf16 v[132:135], a[132:135], a[220:223], v[132:135]
    v_mfma_f32_16x16x32_bf16 v[136:139], a[136:139], a[220:223], v[136:139]
    v_mfma_f32_16x16x32_bf16 v[136:139], a[200:203], a[244:247], v[136:139]
    v_mfma_f32_16x16x32_bf16 v[140:143], a[204:207], a[244:247], v[140:143]
    v_mfma_f32_16x16x32_bf16 v[140:143], a[140:143], a[220:223], v[140:143]
    s_waitcnt lgkmcnt(0)
    v_mfma_f32_16x16x32_bf16 v[144:147], a[0:3], a[80:83], v[144:147]
    v_add_u32 v215, 0xfffed700, v215
    v_add_u32 v212, 0xfffed700, v212
    v_mfma_f32_16x16x32_bf16 v[144:147], a[32:35], a[100:103], v[144:147]
    v_mfma_f32_16x16x32_bf16 v[148:151], a[36:39], a[100:103], v[148:151]
    v_mfma_f32_16x16x32_bf16 v[148:151], a[4:7], a[80:83], v[148:151]
    v_mfma_f32_16x16x32_bf16 v[152:155], a[8:11], a[80:83], v[152:155]
    v_mfma_f32_16x16x32_bf16 v[152:155], a[40:43], a[100:103], v[152:155]
    v_mfma_f32_16x16x32_bf16 v[156:159], a[44:47], a[100:103], v[156:159]
    v_mfma_f32_16x16x32_bf16 v[156:159], a[12:15], a[80:83], v[156:159]
    v_mfma_f32_16x16x32_bf16 v[16:19], a[0:3], a[64:67], v[16:19]
    v_mfma_f32_16x16x32_bf16 v[16:19], a[32:35], a[84:87], v[16:19]
    s_waitcnt vmcnt(11)
    s_barrier
    v_mfma_f32_16x16x32_bf16 v[20:23], a[36:39], a[84:87], v[20:23]
    ds_read_b128 a[224:227], v212 offset:0
    ds_read_b128 a[248:251], v212 offset:64
    s_lshl_b32 s30, s28, 18
    v_mfma_f32_16x16x32_bf16 v[20:23], a[4:7], a[64:67], v[20:23]
    ds_read_b128 a[208:211], v215 offset:0
    s_add_u32 s28, s28, 1
    s_add_u32 m0, s32, 25344
    v_mfma_f32_16x16x32_bf16 v[24:27], a[8:11], a[64:67], v[24:27]
    buffer_load_dwordx4 v213, s[16:19], s30 offen lds
    v_mfma_f32_16x16x32_bf16 v[24:27], a[40:43], a[84:87], v[24:27]
    ds_read_b128 a[232:235], v215 offset:64
    ds_read_b64_tr_b16 a[112:113], v216 offset:0
    v_mfma_f32_16x16x32_bf16 v[28:31], a[44:47], a[84:87], v[28:31]
    ds_read_b64_tr_b16 a[114:115], v216 offset:256
    v_mfma_f32_16x16x32_bf16 v[28:31], a[12:15], a[64:67], v[28:31]
    ds_read_b64_tr_b16 a[176:177], v216 offset:8448
    s_and_b32 s28, s28, 15
    s_add_u32 m0, s32, 26400
    v_mfma_f32_16x16x32_bf16 v[32:35], a[16:19], a[64:67], v[32:35]
    buffer_load_dwordx4 v214, s[16:19], s30 offen lds
    v_mfma_f32_16x16x32_bf16 v[32:35], a[48:51], a[84:87], v[32:35]
    ds_read_b64_tr_b16 a[178:179], v216 offset:8704
    v_mfma_f32_16x16x32_bf16 v[36:39], a[52:55], a[84:87], v[36:39]
    ds_read_b64_tr_b16 a[116:117], v216 offset:32
    s_lshl_b32 s29, s3, 7
    v_mfma_f32_16x16x32_bf16 v[36:39], a[20:23], a[64:67], v[36:39]
    ds_read_b64_tr_b16 a[118:119], v216 offset:288
    s_add_u32 s3, s3, 1
    s_add_u32 m0, s101, 109824
    v_mfma_f32_16x16x32_bf16 v[40:43], a[24:27], a[64:67], v[40:43]
    buffer_load_dwordx4 v210, s[4:7], s29 offen lds
    v_mfma_f32_16x16x32_bf16 v[40:43], a[56:59], a[84:87], v[40:43]
    ds_read_b64_tr_b16 a[180:181], v216 offset:8480
    v_mfma_f32_16x16x32_bf16 v[44:47], a[60:63], a[84:87], v[44:47]
    ds_read_b64_tr_b16 a[182:183], v216 offset:8736
    v_mfma_f32_16x16x32_bf16 v[44:47], a[28:31], a[64:67], v[44:47]
    ds_read_b64_tr_b16 a[120:121], v216 offset:64
    s_and_b32 s3, s3, 7
    s_add_u32 m0, s31, 76032
    v_mfma_f32_16x16x32_bf16 v[48:51], a[0:3], a[68:71], v[48:51]
    buffer_load_dwordx4 v208, s[4:7], s29 offen offset:0 lds
    v_mfma_f32_16x16x32_bf16 v[48:51], a[32:35], a[88:91], v[48:51]
    ds_read_b64_tr_b16 a[122:123], v216 offset:320
    v_mfma_f32_16x16x32_bf16 v[52:55], a[36:39], a[88:91], v[52:55]
    ds_read_b64_tr_b16 a[184:185], v216 offset:8512
    v_mfma_f32_16x16x32_bf16 v[52:55], a[4:7], a[68:71], v[52:55]
    ds_read_b64_tr_b16 a[186:187], v216 offset:8768
    s_add_u32 m0, s31, 76064
    v_mfma_f32_16x16x32_bf16 v[56:59], a[8:11], a[68:71], v[56:59]
    buffer_load_dwordx4 v208, s[4:7], s29 offen offset:1024 lds
    v_mfma_f32_16x16x32_bf16 v[56:59], a[40:43], a[88:91], v[56:59]
    ds_read_b64_tr_b16 a[124:125], v216 offset:96
    v_mfma_f32_16x16x32_bf16 v[60:63], a[44:47], a[88:91], v[60:63]
    ds_read_b64_tr_b16 a[126:127], v216 offset:352
    v_mfma_f32_16x16x32_bf16 v[60:63], a[12:15], a[68:71], v[60:63]
    ds_read_b64_tr_b16 a[188:189], v216 offset:8544
    s_add_u32 m0, s31, 76096
    v_mfma_f32_16x16x32_bf16 v[64:67], a[16:19], a[68:71], v[64:67]
    buffer_load_dwordx4 v208, s[4:7], s29 offen offset:2048 lds
    v_mfma_f32_16x16x32_bf16 v[64:67], a[48:51], a[88:91], v[64:67]
    ds_read_b64_tr_b16 a[190:191], v216 offset:8800
    v_mfma_f32_16x16x32_bf16 v[68:71], a[52:55], a[88:91], v[68:71]
    ds_read_b64_tr_b16 a[128:129], v217 offset:0
    v_mfma_f32_16x16x32_bf16 v[68:71], a[20:23], a[68:71], v[68:71]
    ds_read_b64_tr_b16 a[130:131], v217 offset:256
    s_add_u32 m0, s31, 76128
    v_mfma_f32_16x16x32_bf16 v[72:75], a[24:27], a[68:71], v[72:75]
    buffer_load_dwordx4 v208, s[4:7], s29 offen offset:3072 lds
    v_mfma_f32_16x16x32_bf16 v[72:75], a[56:59], a[88:91], v[72:75]
    ds_read_b64_tr_b16 a[192:193], v217 offset:8448
    v_mfma_f32_16x16x32_bf16 v[76:79], a[60:63], a[88:91], v[76:79]
    ds_read_b64_tr_b16 a[194:195], v217 offset:8704
    v_mfma_f32_16x16x32_bf16 v[76:79], a[28:31], a[68:71], v[76:79]
    ds_read_b64_tr_b16 a[132:133], v217 offset:32
    s_add_u32 m0, s31, 80256
    v_mfma_f32_16x16x32_bf16 v[80:83], a[0:3], a[72:75], v[80:83]
    buffer_load_dwordx4 v209, s[4:7], s29 offen offset:0 lds
    v_mfma_f32_16x16x32_bf16 v[80:83], a[32:35], a[92:95], v[80:83]
    ds_read_b64_tr_b16 a[134:135], v217 offset:288
    v_mfma_f32_16x16x32_bf16 v[84:87], a[36:39], a[92:95], v[84:87]
    ds_read_b64_tr_b16 a[196:197], v217 offset:8480
    v_mfma_f32_16x16x32_bf16 v[84:87], a[4:7], a[72:75], v[84:87]
    ds_read_b64_tr_b16 a[198:199], v217 offset:8736
    s_add_u32 m0, s31, 80288
    v_mfma_f32_16x16x32_bf16 v[88:91], a[8:11], a[72:75], v[88:91]
    buffer_load_dwordx4 v209, s[4:7], s29 offen offset:1024 lds
    v_mfma_f32_16x16x32_bf16 v[88:91], a[40:43], a[92:95], v[88:91]
    ds_read_b64_tr_b16 a[136:137], v217 offset:64
    v_mfma_f32_16x16x32_bf16 v[92:95], a[44:47], a[92:95], v[92:95]
    ds_read_b64_tr_b16 a[138:139], v217 offset:320
    v_mfma_f32_16x16x32_bf16 v[92:95], a[12:15], a[72:75], v[92:95]
    ds_read_b64_tr_b16 a[200:201], v217 offset:8512
    s_add_u32 m0, s31, 80320
    v_mfma_f32_16x16x32_bf16 v[96:99], a[16:19], a[72:75], v[96:99]
    buffer_load_dwordx4 v209, s[4:7], s29 offen offset:2048 lds
    v_mfma_f32_16x16x32_bf16 v[96:99], a[48:51], a[92:95], v[96:99]
    ds_read_b64_tr_b16 a[202:203], v217 offset:8768
    v_mfma_f32_16x16x32_bf16 v[100:103], a[52:55], a[92:95], v[100:103]
    ds_read_b64_tr_b16 a[140:141], v217 offset:96
    v_mfma_f32_16x16x32_bf16 v[100:103], a[20:23], a[72:75], v[100:103]
    ds_read_b64_tr_b16 a[142:143], v217 offset:352
    s_add_u32 m0, s31, 80352
    v_mfma_f32_16x16x32_bf16 v[104:107], a[24:27], a[72:75], v[104:107]
    buffer_load_dwordx4 v209, s[4:7], s29 offen offset:3072 lds
    v_mfma_f32_16x16x32_bf16 v[104:107], a[56:59], a[92:95], v[104:107]
    ds_read_b64_tr_b16 a[204:205], v217 offset:8544
    v_mfma_f32_16x16x32_bf16 v[108:111], a[60:63], a[92:95], v[108:111]
    ds_read_b64_tr_b16 a[206:207], v217 offset:8800
    s_lshl_b32 s30, s28, 18
    v_mfma_f32_16x16x32_bf16 v[108:111], a[28:31], a[72:75], v[108:111]
    ds_read_b128 a[212:215], v215 offset:512
    s_add_u32 s28, s28, 1
    s_add_u32 m0, s32, 33792
    v_mfma_f32_16x16x32_bf16 v[112:115], a[0:3], a[76:79], v[112:115]
    buffer_load_dwordx4 v213, s[16:19], s30 offen lds
    v_mfma_f32_16x16x32_bf16 v[112:115], a[32:35], a[96:99], v[112:115]
    ds_read_b128 a[236:239], v215 offset:576
    v_mfma_f32_16x16x32_bf16 v[116:119], a[36:39], a[96:99], v[116:119]
    ds_read_b128 a[216:219], v215 offset:4224
    v_mfma_f32_16x16x32_bf16 v[116:119], a[4:7], a[76:79], v[116:119]
    ds_read_b128 a[240:243], v215 offset:4288
    s_and_b32 s28, s28, 15
    s_add_u32 m0, s32, 34848
    v_mfma_f32_16x16x32_bf16 v[120:123], a[8:11], a[76:79], v[120:123]
    buffer_load_dwordx4 v214, s[16:19], s30 offen lds
    v_mfma_f32_16x16x32_bf16 v[120:123], a[40:43], a[96:99], v[120:123]
    ds_read_b128 a[220:223], v215 offset:4736
    v_mfma_f32_16x16x32_bf16 v[124:127], a[44:47], a[96:99], v[124:127]
    ds_read_b128 a[244:247], v215 offset:4800
    v_mfma_f32_16x16x32_bf16 v[124:127], a[12:15], a[76:79], v[124:127]
    v_mfma_f32_16x16x32_bf16 v[128:131], a[16:19], a[76:79], v[128:131]
    v_mfma_f32_16x16x32_bf16 v[128:131], a[48:51], a[96:99], v[128:131]
    v_mfma_f32_16x16x32_bf16 v[132:135], a[52:55], a[96:99], v[132:135]
    v_mfma_f32_16x16x32_bf16 v[132:135], a[20:23], a[76:79], v[132:135]
    v_mfma_f32_16x16x32_bf16 v[136:139], a[24:27], a[76:79], v[136:139]
    v_mfma_f32_16x16x32_bf16 v[136:139], a[56:59], a[96:99], v[136:139]
    v_mfma_f32_16x16x32_bf16 v[140:143], a[60:63], a[96:99], v[140:143]
    v_mfma_f32_16x16x32_bf16 v[140:143], a[28:31], a[76:79], v[140:143]
    s_waitcnt lgkmcnt(0)
    v_mfma_f32_16x16x32_bf16 v[144:147], a[112:115], a[224:227], v[144:147]
    v_add_u32 v215, 0x9480, v215
    v_add_u32 v212, 0x9480, v212
    v_mfma_f32_16x16x32_bf16 v[144:147], a[176:179], a[248:251], v[144:147]
    v_mfma_f32_16x16x32_bf16 v[148:151], a[180:183], a[248:251], v[148:151]
    v_mfma_f32_16x16x32_bf16 v[148:151], a[116:119], a[224:227], v[148:151]
    v_mfma_f32_16x16x32_bf16 v[152:155], a[120:123], a[224:227], v[152:155]
    v_mfma_f32_16x16x32_bf16 v[152:155], a[184:187], a[248:251], v[152:155]
    v_mfma_f32_16x16x32_bf16 v[156:159], a[188:191], a[248:251], v[156:159]
    v_mfma_f32_16x16x32_bf16 v[156:159], a[124:127], a[224:227], v[156:159]
    v_mfma_f32_16x16x32_bf16 v[16:19], a[112:115], a[208:211], v[16:19]
    v_mfma_f32_16x16x32_bf16 v[16:19], a[176:179], a[232:235], v[16:19]
    s_waitcnt vmcnt(11)
    s_barrier
    v_mfma_f32_16x16x32_bf16 v[20:23], a[180:183], a[232:235], v[20:23]
    ds_read_b128 a[80:83], v212 offset:0
    s_lshl_b32 s30, s28, 18
    v_mfma_f32_16x16x32_bf16 v[20:23], a[116:119], a[208:211], v[20:23]
    ds_read_b128 a[100:103], v212 offset:64
    s_add_u32 s28, s28, 1
    s_add_u32 m0, s32, 0
    v_mfma_f32_16x16x32_bf16 v[24:27], a[120:123], a[208:211], v[24:27]
    buffer_load_dwordx4 v213, s[16:19], s30 offen lds
    v_mfma_f32_16x16x32_bf16 v[24:27], a[184:187], a[232:235], v[24:27]
    ds_read_b128 a[64:67], v215 offset:0
    v_mfma_f32_16x16x32_bf16 v[28:31], a[188:191], a[232:235], v[28:31]
    ds_read_b128 a[84:87], v215 offset:64
    v_mfma_f32_16x16x32_bf16 v[28:31], a[124:127], a[208:211], v[28:31]
    ds_read_b64_tr_b16 a[0:1], v216 offset:16896
    s_and_b32 s28, s28, 15
    s_add_u32 m0, s32, 1056
    v_mfma_f32_16x16x32_bf16 v[32:35], a[128:131], a[208:211], v[32:35]
    buffer_load_dwordx4 v214, s[16:19], s30 offen lds
    v_mfma_f32_16x16x32_bf16 v[32:35], a[192:195], a[232:235], v[32:35]
    ds_read_b64_tr_b16 a[2:3], v216 offset:17152
    v_mfma_f32_16x16x32_bf16 v[36:39], a[196:199], a[232:235], v[36:39]
    ds_read_b64_tr_b16 a[32:33], v216 offset:25344
    v_mfma_f32_16x16x32_bf16 v[36:39], a[132:135], a[208:211], v[36:39]
    ds_read_b64_tr_b16 a[34:35], v216 offset:25600
    s_add_u32 m0, s33, 0
    v_mfma_f32_16x16x32_bf16 v[40:43], a[136:139], a[208:211], v[40:43]
    buffer_load_dwordx4 v234, s[8:11], s35 offen offset:0 nt lds
    v_mfma_f32_16x16x32_bf16 v[40:43], a[200:203], a[232:235], v[40:43]
    ds_read_b64_tr_b16 a[4:5], v216 offset:16928
    v_mfma_f32_16x16x32_bf16 v[44:47], a[204:207], a[232:235], v[44:47]
    ds_read_b64_tr_b16 a[6:7], v216 offset:17184
    v_mfma_f32_16x16x32_bf16 v[44:47], a[140:143], a[208:211], v[44:47]
    ds_read_b64_tr_b16 a[36:37], v216 offset:25376
    s_add_u32 m0, s33, 784
    v_mfma_f32_16x16x32_bf16 v[48:51], a[112:115], a[212:215], v[48:51]
    buffer_load_dwordx4 v234, s[8:11], s35 offen offset:256 nt lds
    v_mfma_f32_16x16x32_bf16 v[48:51], a[176:179], a[236:239], v[48:51]
    ds_read_b64_tr_b16 a[38:39], v216 offset:25632
    v_mfma_f32_16x16x32_bf16 v[52:55], a[180:183], a[236:239], v[52:55]
    ds_read_b64_tr_b16 a[8:9], v216 offset:16960
    v_mfma_f32_16x16x32_bf16 v[52:55], a[116:119], a[212:215], v[52:55]
    ds_read_b64_tr_b16 a[10:11], v216 offset:17216
    s_add_u32 m0, s33, 1568
    v_mfma_f32_16x16x32_bf16 v[56:59], a[120:123], a[212:215], v[56:59]
    buffer_load_dwordx4 v234, s[8:11], s35 offen offset:512 nt lds
    v_mfma_f32_16x16x32_bf16 v[56:59], a[184:187], a[236:239], v[56:59]
    ds_read_b64_tr_b16 a[40:41], v216 offset:25408
    v_mfma_f32_16x16x32_bf16 v[60:63], a[188:191], a[236:239], v[60:63]
    ds_read_b64_tr_b16 a[42:43], v216 offset:25664
    v_mfma_f32_16x16x32_bf16 v[60:63], a[124:127], a[212:215], v[60:63]
    ds_read_b64_tr_b16 a[12:13], v216 offset:16992
    s_add_u32 m0, s33, 2352
    v_mfma_f32_16x16x32_bf16 v[64:67], a[128:131], a[212:215], v[64:67]
    buffer_load_dwordx4 v234, s[8:11], s35 offen offset:768 nt lds
    v_mfma_f32_16x16x32_bf16 v[64:67], a[192:195], a[236:239], v[64:67]
    ds_read_b64_tr_b16 a[14:15], v216 offset:17248
    v_mfma_f32_16x16x32_bf16 v[68:71], a[196:199], a[236:239], v[68:71]
    ds_read_b64_tr_b16 a[44:45], v216 offset:25440
    v_mfma_f32_16x16x32_bf16 v[68:71], a[132:135], a[212:215], v[68:71]
    ds_read_b64_tr_b16 a[46:47], v216 offset:25696
    s_add_u32 m0, s34, 0
    v_mfma_f32_16x16x32_bf16 v[72:75], a[136:139], a[212:215], v[72:75]
    buffer_load_dwordx4 v235, s[12:15], s35 offen offset:0 nt lds
    v_mfma_f32_16x16x32_bf16 v[72:75], a[200:203], a[236:239], v[72:75]
    ds_read_b64_tr_b16 a[16:17], v217 offset:16896
    v_mfma_f32_16x16x32_bf16 v[76:79], a[204:207], a[236:239], v[76:79]
    ds_read_b64_tr_b16 a[18:19], v217 offset:17152
    v_mfma_f32_16x16x32_bf16 v[76:79], a[140:143], a[212:215], v[76:79]
    ds_read_b64_tr_b16 a[48:49], v217 offset:25344
    s_add_u32 m0, s34, 800
    v_mfma_f32_16x16x32_bf16 v[80:83], a[112:115], a[216:219], v[80:83]
    buffer_load_dwordx4 v235, s[12:15], s35 offen offset:256 nt lds
    v_mfma_f32_16x16x32_bf16 v[80:83], a[176:179], a[240:243], v[80:83]
    ds_read_b64_tr_b16 a[50:51], v217 offset:25600
    v_mfma_f32_16x16x32_bf16 v[84:87], a[180:183], a[240:243], v[84:87]
    ds_read_b64_tr_b16 a[20:21], v217 offset:16928
    v_mfma_f32_16x16x32_bf16 v[84:87], a[116:119], a[216:219], v[84:87]
    ds_read_b64_tr_b16 a[22:23], v217 offset:17184
    s_add_u32 m0, s34, 1600
    v_mfma_f32_16x16x32_bf16 v[88:91], a[120:123], a[216:219], v[88:91]
    buffer_load_dwordx4 v235, s[12:15], s35 offen offset:512 nt lds
    v_mfma_f32_16x16x32_bf16 v[88:91], a[184:187], a[240:243], v[88:91]
    ds_read_b64_tr_b16 a[52:53], v217 offset:25376
    v_mfma_f32_16x16x32_bf16 v[92:95], a[188:191], a[240:243], v[92:95]
    ds_read_b64_tr_b16 a[54:55], v217 offset:25632
    v_mfma_f32_16x16x32_bf16 v[92:95], a[124:127], a[216:219], v[92:95]
    ds_read_b64_tr_b16 a[24:25], v217 offset:16960
    s_add_u32 m0, s34, 2400
    v_mfma_f32_16x16x32_bf16 v[96:99], a[128:131], a[216:219], v[96:99]
    buffer_load_dwordx4 v235, s[12:15], s35 offen offset:768 nt lds
    v_mfma_f32_16x16x32_bf16 v[96:99], a[192:195], a[240:243], v[96:99]
    ds_read_b64_tr_b16 a[26:27], v217 offset:17216
    v_mfma_f32_16x16x32_bf16 v[100:103], a[196:199], a[240:243], v[100:103]
    ds_read_b64_tr_b16 a[56:57], v217 offset:25408
    v_mfma_f32_16x16x32_bf16 v[100:103], a[132:135], a[216:219], v[100:103]
    ds_read_b64_tr_b16 a[58:59], v217 offset:25664
    v_mfma_f32_16x16x32_bf16 v[104:107], a[136:139], a[216:219], v[104:107]
    ds_read_b64_tr_b16 a[28:29], v217 offset:16992
    v_mfma_f32_16x16x32_bf16 v[104:107], a[200:203], a[240:243], v[104:107]
    ds_read_b64_tr_b16 a[30:31], v217 offset:17248
    v_mfma_f32_16x16x32_bf16 v[108:111], a[204:207], a[240:243], v[108:111]
    ds_read_b64_tr_b16 a[60:61], v217 offset:25440
    v_mfma_f32_16x16x32_bf16 v[108:111], a[140:143], a[216:219], v[108:111]
    ds_read_b64_tr_b16 a[62:63], v217 offset:25696
    v_mfma_f32_16x16x32_bf16 v[112:115], a[112:115], a[220:223], v[112:115]
    ds_read_b128 a[68:71], v215 offset:512
    v_mfma_f32_16x16x32_bf16 v[112:115], a[176:179], a[244:247], v[112:115]
    ds_read_b128 a[88:91], v215 offset:576
    v_mfma_f32_16x16x32_bf16 v[116:119], a[180:183], a[244:247], v[116:119]
    ds_read_b128 a[72:75], v215 offset:4224
    v_mfma_f32_16x16x32_bf16 v[116:119], a[116:119], a[220:223], v[116:119]
    ds_read_b128 a[92:95], v215 offset:4288
    v_mfma_f32_16x16x32_bf16 v[120:123], a[120:123], a[220:223], v[120:123]
    ds_read_b128 a[76:79], v215 offset:4736
    v_mfma_f32_16x16x32_bf16 v[120:123], a[184:187], a[244:247], v[120:123]
    ds_read_b128 a[96:99], v215 offset:4800
    v_mfma_f32_16x16x32_bf16 v[124:127], a[188:191], a[244:247], v[124:127]
    v_mfma_f32_16x16x32_bf16 v[124:127], a[124:127], a[220:223], v[124:127]
    v_mfma_f32_16x16x32_bf16 v[128:131], a[128:131], a[220:223], v[128:131]
    v_mfma_f32_16x16x32_bf16 v[128:131], a[192:195], a[244:247], v[128:131]
    v_mfma_f32_16x16x32_bf16 v[132:135], a[196:199], a[244:247], v[132:135]
    v_mfma_f32_16x16x32_bf16 v[132:135], a[132:135], a[220:223], v[132:135]
    v_mfma_f32_16x16x32_bf16 v[136:139], a[136:139], a[220:223], v[136:139]
    v_mfma_f32_16x16x32_bf16 v[136:139], a[200:203], a[244:247], v[136:139]
    v_mfma_f32_16x16x32_bf16 v[140:143], a[204:207], a[244:247], v[140:143]
    v_mfma_f32_16x16x32_bf16 v[140:143], a[140:143], a[220:223], v[140:143]
    s_waitcnt lgkmcnt(0)
    v_mfma_f32_16x16x32_bf16 v[144:147], a[0:3], a[80:83], v[144:147]
    v_add_u32 v215, 0x9480, v215
    v_add_u32 v212, 0x9480, v212
    v_mfma_f32_16x16x32_bf16 v[144:147], a[32:35], a[100:103], v[144:147]
    v_mfma_f32_16x16x32_bf16 v[148:151], a[36:39], a[100:103], v[148:151]
    v_mfma_f32_16x16x32_bf16 v[148:151], a[4:7], a[80:83], v[148:151]
    v_mfma_f32_16x16x32_bf16 v[152:155], a[8:11], a[80:83], v[152:155]
    v_mfma_f32_16x16x32_bf16 v[152:155], a[40:43], a[100:103], v[152:155]
    v_mfma_f32_16x16x32_bf16 v[156:159], a[44:47], a[100:103], v[156:159]
    v_mfma_f32_16x16x32_bf16 v[156:159], a[12:15], a[80:83], v[156:159]
    v_mfma_f32_16x16x32_bf16 v[16:19], a[0:3], a[64:67], v[16:19]
    v_mfma_f32_16x16x32_bf16 v[16:19], a[32:35], a[84:87], v[16:19]
    s_waitcnt vmcnt(8)
    s_barrier
    v_mfma_f32_16x16x32_bf16 v[20:23], a[36:39], a[84:87], v[20:23]
    ds_read_b128 a[224:227], v212 offset:0
    s_mov_b32 s35, 16384
    s_add_u32 s40, s33, 33536
    v_mfma_f32_16x16x32_bf16 v[20:23], a[4:7], a[64:67], v[20:23]
    ds_read_b128 a[248:251], v212 offset:64
    s_add_u32 s42, s34, 33536
    s_add_u32 m0, s40, 0
    v_mfma_f32_16x16x32_bf16 v[24:27], a[8:11], a[64:67], v[24:27]
    buffer_load_dwordx4 v234, s[8:11], s35 offen offset:0 nt lds
    v_mfma_f32_16x16x32_bf16 v[24:27], a[40:43], a[84:87], v[24:27]
    ds_read_b128 a[208:211], v215 offset:0
    v_mfma_f32_16x16x32_bf16 v[28:31], a[44:47], a[84:87], v[28:31]
    ds_read_b128 a[232:235], v215 offset:64
    v_mfma_f32_16x16x32_bf16 v[28:31], a[12:15], a[64:67], v[28:31]
    ds_read_b64_tr_b16 a[112:113], v216 offset:33792
    s_add_u32 m0, s40, 784
    v_mfma_f32_16x16x32_bf16 v[32:35], a[16:19], a[64:67], v[32:35]
    buffer_load_dwordx4 v234, s[8:11], s35 offen offset:256 nt lds
    v_mfma_f32_16x16x32_bf16 v[32:35], a[48:51], a[84:87], v[32:35]
    ds_read_b64_tr_b16 a[114:115], v216 offset:34048
    v_mfma_f32_16x16x32_bf16 v[36:39], a[52:55], a[84:87], v[36:39]
    ds_read_b64_tr_b16 a[176:177], v216 offset:0
    v_mfma_f32_16x16x32_bf16 v[36:39], a[20:23], a[64:67], v[36:39]
    ds_read_b64_tr_b16 a[178:179], v216 offset:256
    s_add_u32 m0, s40, 1568
    v_mfma_f32_16x16x32_bf16 v[40:43], a[24:27], a[64:67], v[40:43]
    buffer_load_dwordx4 v234, s[8:11], s35 offen offset:512 nt lds
    v_mfma_f32_16x16x32_bf16 v[40:43], a[56:59], a[84:87], v[40:43]
    ds_read_b64_tr_b16 a[116:117], v216 offset:33824
    v_mfma_f32_16x16x32_bf16 v[44:47], a[60:63], a[84:87], v[44:47]
    ds_read_b64_tr_b16 a[118:119], v216 offset:34080
    v_mfma_f32_16x16x32_bf16 v[44:47], a[28:31], a[64:67], v[44:47]
    ds_read_b64_tr_b16 a[180:181], v216 offset:32
    s_add_u32 m0, s40, 2352
    v_mfma_f32_16x16x32_bf16 v[48:51], a[0:3], a[68:71], v[48:51]
    buffer_load_dwordx4 v234, s[8:11], s35 offen offset:768 nt lds
    v_mfma_f32_16x16x32_bf16 v[48:51], a[32:35], a[88:91], v[48:51]
    ds_read_b64_tr_b16 a[182:183], v216 offset:288
    v_mfma_f32_16x16x32_bf16 v[52:55], a[36:39], a[88:91], v[52:55]
    ds_read_b64_tr_b16 a[120:121], v216 offset:33856
    v_mfma_f32_16x16x32_bf16 v[52:55], a[4:7], a[68:71], v[52:55]
    ds_read_b64_tr_b16 a[122:123], v216 offset:34112
    s_add_u32 m0, s42, 0
    v_mfma_f32_16x16x32_bf16 v[56:59], a[8:11], a[68:71], v[56:59]
    buffer_load_dwordx4 v235, s[12:15], s35 offen offset:0 nt lds
    v_mfma_f32_16x16x32_bf16 v[56:59], a[40:43], a[88:91], v[56:59]
    ds_read_b64_tr_b16 a[184:185], v216 offset:64
    v_mfma_f32_16x16x32_bf16 v[60:63], a[44:47], a[88:91], v[60:63]
    ds_read_b64_tr_b16 a[186:187], v216 offset:320
    v_mfma_f32_16x16x32_bf16 v[60:63], a[12:15], a[68:71], v[60:63]
    ds_read_b64_tr_b16 a[124:125], v216 offset:33888
    s_add_u32 m0, s42, 800
    v_mfma_f32_16x16x32_bf16 v[64:67], a[16:19], a[68:71], v[64:67]
    buffer_load_dwordx4 v235, s[12:15], s35 offen offset:256 nt lds
    v_mfma_f32_16x16x32_bf16 v[64:67], a[48:51], a[88:91], v[64:67]
    ds_read_b64_tr_b16 a[126:127], v216 offset:34144
    v_mfma_f32_16x16x32_bf16 v[68:71], a[52:55], a[88:91], v[68:71]
    ds_read_b64_tr_b16 a[188:189], v216 offset:96
    v_mfma_f32_16x16x32_bf16 v[68:71], a[20:23], a[68:71], v[68:71]
    ds_read_b64_tr_b16 a[190:191], v216 offset:352
    s_add_u32 m0, s42, 1600
    v_mfma_f32_16x16x32_bf16 v[72:75], a[24:27], a[68:71], v[72:75]
    buffer_load_dwordx4 v235, s[12:15], s35 offen offset:512 nt lds
    v_mfma_f32_16x16x32_bf16 v[72:75], a[56:59], a[88:91], v[72:75]
    ds_read_b64_tr_b16 a[128:129], v217 offset:33792
    v_mfma_f32_16x16x32_bf16 v[76:79], a[60:63], a[88:91], v[76:79]
    ds_read_b64_tr_b16 a[130:131], v217 offset:34048
    v_mfma_f32_16x16x32_bf16 v[76:79], a[28:31], a[68:71], v[76:79]
    ds_read_b64_tr_b16 a[192:193], v217 offset:0
    s_add_u32 m0, s42, 2400
    v_mfma_f32_16x16x32_bf16 v[80:83], a[0:3], a[72:75], v[80:83]
    buffer_load_dwordx4 v235, s[12:15], s35 offen offset:768 nt lds
    v_mfma_f32_16x16x32_bf16 v[80:83], a[32:35], a[92:95], v[80:83]
    ds_read_b64_tr_b16 a[194:195], v217 offset:256
    v_mfma_f32_16x16x32_bf16 v[84:87], a[36:39], a[92:95], v[84:87]
    ds_read_b64_tr_b16 a[132:133], v217 offset:33824
    v_mfma_f32_16x16x32_bf16 v[84:87], a[4:7], a[72:75], v[84:87]
    ds_read_b64_tr_b16 a[134:135], v217 offset:34080
    v_mfma_f32_16x16x32_bf16 v[88:91], a[8:11], a[72:75], v[88:91]
    buffer_load_dword v250, v13, s[92:95], 0 offen
    v_mfma_f32_16x16x32_bf16 v[88:91], a[40:43], a[92:95], v[88:91]
    ds_read_b64_tr_b16 a[196:197], v217 offset:32
    v_mfma_f32_16x16x32_bf16 v[92:95], a[44:47], a[92:95], v[92:95]
    ds_read_b64_tr_b16 a[198:199], v217 offset:288
    v_mfma_f32_16x16x32_bf16 v[92:95], a[12:15], a[72:75], v[92:95]
    ds_read_b64_tr_b16 a[136:137], v217 offset:33856
    v_mfma_f32_16x16x32_bf16 v[96:99], a[16:19], a[72:75], v[96:99]
    ds_read_b64_tr_b16 a[138:139], v217 offset:34112
    v_mfma_f32_16x16x32_bf16 v[96:99], a[48:51], a[92:95], v[96:99]
    ds_read_b64_tr_b16 a[200:201], v217 offset:64
    v_mfma_f32_16x16x32_bf16 v[100:103], a[52:55], a[92:95], v[100:103]
    ds_read_b64_tr_b16 a[202:203], v217 offset:320
    v_mfma_f32_16x16x32_bf16 v[100:103], a[20:23], a[72:75], v[100:103]
    ds_read_b64_tr_b16 a[140:141], v217 offset:33888
    v_mfma_f32_16x16x32_bf16 v[104:107], a[24:27], a[72:75], v[104:107]
    ds_read_b64_tr_b16 a[142:143], v217 offset:34144
    v_mfma_f32_16x16x32_bf16 v[104:107], a[56:59], a[92:95], v[104:107]
    ds_read_b64_tr_b16 a[204:205], v217 offset:96
    v_mfma_f32_16x16x32_bf16 v[108:111], a[60:63], a[92:95], v[108:111]
    ds_read_b64_tr_b16 a[206:207], v217 offset:352
    v_mfma_f32_16x16x32_bf16 v[108:111], a[28:31], a[72:75], v[108:111]
    ds_read_b128 a[212:215], v215 offset:512
    v_mfma_f32_16x16x32_bf16 v[112:115], a[0:3], a[76:79], v[112:115]
    ds_read_b128 a[236:239], v215 offset:576
    v_mfma_f32_16x16x32_bf16 v[112:115], a[32:35], a[96:99], v[112:115]
    ds_read_b128 a[216:219], v215 offset:4224
    v_mfma_f32_16x16x32_bf16 v[116:119], a[36:39], a[96:99], v[116:119]
    ds_read_b128 a[240:243], v215 offset:4288
    v_mfma_f32_16x16x32_bf16 v[116:119], a[4:7], a[76:79], v[116:119]
    ds_read_b128 a[220:223], v215 offset:4736
    v_mfma_f32_16x16x32_bf16 v[120:123], a[8:11], a[76:79], v[120:123]
    ds_read_b128 a[244:247], v215 offset:4800
    v_mfma_f32_16x16x32_bf16 v[120:123], a[40:43], a[96:99], v[120:123]
    v_mfma_f32_16x16x32_bf16 v[124:127], a[44:47], a[96:99], v[124:127]
    v_mfma_f32_16x16x32_bf16 v[124:127], a[12:15], a[76:79], v[124:127]
    v_mfma_f32_16x16x32_bf16 v[128:131], a[16:19], a[76:79], v[128:131]
    v_mfma_f32_16x16x32_bf16 v[128:131], a[48:51], a[96:99], v[128:131]
    v_mfma_f32_16x16x32_bf16 v[132:135], a[52:55], a[96:99], v[132:135]
    v_mfma_f32_16x16x32_bf16 v[132:135], a[20:23], a[76:79], v[132:135]
    v_mfma_f32_16x16x32_bf16 v[136:139], a[24:27], a[76:79], v[136:139]
    v_mfma_f32_16x16x32_bf16 v[136:139], a[56:59], a[96:99], v[136:139]
    v_mfma_f32_16x16x32_bf16 v[140:143], a[60:63], a[96:99], v[140:143]
    v_mfma_f32_16x16x32_bf16 v[140:143], a[28:31], a[76:79], v[140:143]
    s_waitcnt lgkmcnt(0)
    s_waitcnt vmcnt(9)
    s_barrier
    v_mfma_f32_16x16x32_bf16 v[144:147], a[112:115], a[224:227], v[144:147]
    ds_read_b128 a[80:83], v228 offset:0
    ds_read_b128 a[84:87], v228 offset:64
    v_mfma_f32_16x16x32_bf16 v[144:147], a[176:179], a[248:251], v[144:147]
    ds_read_b128 a[88:91], v229 offset:0
    ds_read_b128 a[92:95], v229 offset:64
    v_mfma_f32_16x16x32_bf16 v[148:151], a[180:183], a[248:251], v[148:151]
    ds_read_b128 a[96:99], v228 offset:256
    ds_read_b128 a[100:103], v228 offset:320
    v_mfma_f32_16x16x32_bf16 v[148:151], a[116:119], a[224:227], v[148:151]
    ds_read_b128 a[104:107], v229 offset:256
    ds_read_b128 a[108:111], v229 offset:320
    v_mfma_f32_16x16x32_bf16 v[152:155], a[120:123], a[224:227], v[152:155]
    ds_read_b64_tr_b16 a[144:145], v232 offset:0
    ds_read_b64_tr_b16 a[146:147], v232 offset:512
    v_mfma_f32_16x16x32_bf16 v[152:155], a[184:187], a[248:251], v[152:155]
    ds_read_b64_tr_b16 a[148:149], v232 offset:32
    ds_read_b64_tr_b16 a[150:151], v232 offset:544
    v_mfma_f32_16x16x32_bf16 v[156:159], a[188:191], a[248:251], v[156:159]
    ds_read_b64_tr_b16 a[152:153], v232 offset:64
    ds_read_b64_tr_b16 a[154:155], v232 offset:576
    v_mfma_f32_16x16x32_bf16 v[156:159], a[124:127], a[224:227], v[156:159]
    ds_read_b64_tr_b16 a[156:157], v232 offset:96
    ds_read_b64_tr_b16 a[158:159], v232 offset:608
    v_mfma_f32_16x16x32_bf16 v[16:19], a[112:115], a[208:211], v[16:19]
    ds_read_b64_tr_b16 a[160:161], v232 offset:128
    ds_read_b64_tr_b16 a[162:163], v232 offset:640
    v_mfma_f32_16x16x32_bf16 v[16:19], a[176:179], a[232:235], v[16:19]
    ds_read_b64_tr_b16 a[164:165], v232 offset:160
    ds_read_b64_tr_b16 a[166:167], v232 offset:672
    v_mfma_f32_16x16x32_bf16 v[20:23], a[180:183], a[232:235], v[20:23]
    ds_read_b64_tr_b16 a[168:169], v232 offset:192
    ds_read_b64_tr_b16 a[170:171], v232 offset:704
    v_mfma_f32_16x16x32_bf16 v[20:23], a[116:119], a[208:211], v[20:23]
    ds_read_b64_tr_b16 a[172:173], v232 offset:224
    ds_read_b64_tr_b16 a[174:175], v232 offset:736
    v_mfma_f32_16x16x32_bf16 v[24:27], a[120:123], a[208:211], v[24:27]
    v_mul_f32 v144, s38, v144
    v_mul_f32 v145, s38, v145
    v_mfma_f32_16x16x32_bf16 v[24:27], a[184:187], a[232:235], v[24:27]
    v_mul_f32 v146, s38, v146
    v_mul_f32 v147, s38, v147
    v_mfma_f32_16x16x32_bf16 v[28:31], a[188:191], a[232:235], v[28:31]
    v_mul_f32 v148, s38, v148
    v_mul_f32 v149, s38, v149
    v_mfma_f32_16x16x32_bf16 v[28:31], a[124:127], a[208:211], v[28:31]
    v_mul_f32 v150, s38, v150
    v_mul_f32 v151, s38, v151
    v_mfma_f32_16x16x32_bf16 v[32:35], a[128:131], a[208:211], v[32:35]
    v_cvt_pk_bf16_f32 v144, v144, v145
    v_cvt_pk_bf16_f32 v145, v146, v147
    v_mfma_f32_16x16x32_bf16 v[32:35], a[192:195], a[232:235], v[32:35]
    v_cvt_pk_bf16_f32 v146, v148, v149
    v_cvt_pk_bf16_f32 v147, v150, v151
    v_mfma_f32_16x16x32_bf16 v[36:39], a[196:199], a[232:235], v[36:39]
    v_mul_f32 v152, s38, v152
    v_mul_f32 v153, s38, v153
    v_mfma_f32_16x16x32_bf16 v[36:39], a[132:135], a[208:211], v[36:39]
    v_mul_f32 v154, s38, v154
    v_mul_f32 v155, s38, v155
    v_mfma_f32_16x16x32_bf16 v[40:43], a[136:139], a[208:211], v[40:43]
    v_mul_f32 v156, s38, v156
    v_mul_f32 v157, s38, v157
    v_mfma_f32_16x16x32_bf16 v[40:43], a[200:203], a[232:235], v[40:43]
    v_mul_f32 v158, s38, v158
    v_mul_f32 v159, s38, v159
    v_mfma_f32_16x16x32_bf16 v[44:47], a[204:207], a[232:235], v[44:47]
    v_cvt_pk_bf16_f32 v152, v152, v153
    v_cvt_pk_bf16_f32 v153, v154, v155
    v_mfma_f32_16x16x32_bf16 v[44:47], a[140:143], a[208:211], v[44:47]
    v_cvt_pk_bf16_f32 v154, v156, v157
    v_cvt_pk_bf16_f32 v155, v158, v159
    v_mfma_f32_16x16x32_bf16 v[48:51], a[112:115], a[212:215], v[48:51]
    v_permlane16_swap_b32 v144, v146
    v_permlane16_swap_b32 v145, v147
    v_mfma_f32_16x16x32_bf16 v[48:51], a[176:179], a[236:239], v[48:51]
    ds_write_b128 v9, v[144:147] offset:0
    v_accvgpr_write_b32 a64, v144
    v_mfma_f32_16x16x32_bf16 v[52:55], a[180:183], a[236:239], v[52:55]
    v_accvgpr_write_b32 a65, v145
    v_accvgpr_write_b32 a66, v146
    v_mfma_f32_16x16x32_bf16 v[52:55], a[116:119], a[212:215], v[52:55]
    v_accvgpr_write_b32 a67, v147
    v_permlane16_swap_b32 v152, v154
    v_mfma_f32_16x16x32_bf16 v[56:59], a[120:123], a[212:215], v[56:59]
    v_permlane16_swap_b32 v153, v155
    v_mfma_f32_16x16x32_bf16 v[56:59], a[184:187], a[236:239], v[56:59]
    ds_write_b128 v9, v[152:155] offset:1024
    v_accvgpr_write_b32 a68, v152
    v_mfma_f32_16x16x32_bf16 v[60:63], a[188:191], a[236:239], v[60:63]
    v_accvgpr_write_b32 a69, v153
    v_accvgpr_write_b32 a70, v154
    v_mfma_f32_16x16x32_bf16 v[60:63], a[124:127], a[212:215], v[60:63]
    v_accvgpr_write_b32 a71, v155
    v_mul_f32 v16, s38, v16
    v_mfma_f32_16x16x32_bf16 v[64:67], a[128:131], a[212:215], v[64:67]
    v_mul_f32 v17, s38, v17
    v_mul_f32 v18, s38, v18
    v_mfma_f32_16x16x32_bf16 v[64:67], a[192:195], a[236:239], v[64:67]
    v_mul_f32 v19, s38, v19
    v_mul_f32 v20, s38, v20
    v_mfma_f32_16x16x32_bf16 v[68:71], a[196:199], a[236:239], v[68:71]
    v_mul_f32 v21, s38, v21
    v_mul_f32 v22, s38, v22
    v_mfma_f32_16x16x32_bf16 v[68:71], a[132:135], a[212:215], v[68:71]
    v_mul_f32 v23, s38, v23
    v_cvt_pk_bf16_f32 v16, v16, v17
    v_mfma_f32_16x16x32_bf16 v[72:75], a[136:139], a[212:215], v[72:75]
    v_cvt_pk_bf16_f32 v17, v18, v19
    v_cvt_pk_bf16_f32 v18, v20, v21
    v_mfma_f32_16x16x32_bf16 v[72:75], a[200:203], a[236:239], v[72:75]
    v_cvt_pk_bf16_f32 v19, v22, v23
    v_mul_f32 v24, s38, v24
    v_mfma_f32_16x16x32_bf16 v[76:79], a[204:207], a[236:239], v[76:79]
    v_mul_f32 v25, s38, v25
    v_mul_f32 v26, s38, v26
    v_mfma_f32_16x16x32_bf16 v[76:79], a[140:143], a[212:215], v[76:79]
    v_mul_f32 v27, s38, v27
    v_mul_f32 v28, s38, v28
    v_mfma_f32_16x16x32_bf16 v[80:83], a[112:115], a[216:219], v[80:83]
    v_mul_f32 v29, s38, v29
    v_mul_f32 v30, s38, v30
    v_mfma_f32_16x16x32_bf16 v[80:83], a[176:179], a[240:243], v[80:83]
    v_mul_f32 v31, s38, v31
    v_cvt_pk_bf16_f32 v24, v24, v25
    v_mfma_f32_16x16x32_bf16 v[84:87], a[180:183], a[240:243], v[84:87]
    v_cvt_pk_bf16_f32 v25, v26, v27
    v_cvt_pk_bf16_f32 v26, v28, v29
    v_mfma_f32_16x16x32_bf16 v[84:87], a[116:119], a[216:219], v[84:87]
    v_cvt_pk_bf16_f32 v27, v30, v31
    v_permlane16_swap_b32 v16, v18
    v_mfma_f32_16x16x32_bf16 v[88:91], a[120:123], a[216:219], v[88:91]
    v_permlane16_swap_b32 v17, v19
    v_accvgpr_write_b32 a0, v16
    v_mfma_f32_16x16x32_bf16 v[88:91], a[184:187], a[240:243], v[88:91]
    v_accvgpr_write_b32 a1, v17
    v_accvgpr_write_b32 a2, v18
    v_mfma_f32_16x16x32_bf16 v[92:95], a[188:191], a[240:243], v[92:95]
    v_accvgpr_write_b32 a3, v19
    v_mul_f32 v32, s38, v32
    v_mfma_f32_16x16x32_bf16 v[92:95], a[124:127], a[216:219], v[92:95]
    v_mul_f32 v33, s38, v33
    v_mul_f32 v34, s38, v34
    v_mfma_f32_16x16x32_bf16 v[96:99], a[128:131], a[216:219], v[96:99]
    v_mul_f32 v35, s38, v35
    v_mul_f32 v36, s38, v36
    v_mfma_f32_16x16x32_bf16 v[96:99], a[192:195], a[240:243], v[96:99]
    v_mul_f32 v37, s38, v37
    v_mul_f32 v38, s38, v38
    v_mfma_f32_16x16x32_bf16 v[100:103], a[196:199], a[240:243], v[100:103]
    v_mul_f32 v39, s38, v39
    v_cvt_pk_bf16_f32 v32, v32, v33
    v_mfma_f32_16x16x32_bf16 v[100:103], a[132:135], a[216:219], v[100:103]
    v_cvt_pk_bf16_f32 v33, v34, v35
    v_cvt_pk_bf16_f32 v34, v36, v37
    v_mfma_f32_16x16x32_bf16 v[104:107], a[136:139], a[216:219], v[104:107]
    v_cvt_pk_bf16_f32 v35, v38, v39
    v_permlane16_swap_b32 v24, v26
    v_mfma_f32_16x16x32_bf16 v[104:107], a[200:203], a[240:243], v[104:107]
    v_permlane16_swap_b32 v25, v27
    v_accvgpr_write_b32 a4, v24
    v_mfma_f32_16x16x32_bf16 v[108:111], a[204:207], a[240:243], v[108:111]
    v_accvgpr_write_b32 a5, v25
    v_accvgpr_write_b32 a6, v26
    v_mfma_f32_16x16x32_bf16 v[108:111], a[140:143], a[216:219], v[108:111]
    v_accvgpr_write_b32 a7, v27
    v_mul_f32 v40, s38, v40
    v_mfma_f32_16x16x32_bf16 v[112:115], a[112:115], a[220:223], v[112:115]
    v_mul_f32 v41, s38, v41
    v_mul_f32 v42, s38, v42
    v_mfma_f32_16x16x32_bf16 v[112:115], a[176:179], a[244:247], v[112:115]
    v_mul_f32 v43, s38, v43
    v_mul_f32 v44, s38, v44
    v_mfma_f32_16x16x32_bf16 v[116:119], a[180:183], a[244:247], v[116:119]
    v_mul_f32 v45, s38, v45
    v_mul_f32 v46, s38, v46
    v_mfma_f32_16x16x32_bf16 v[116:119], a[116:119], a[220:223], v[116:119]
    v_mul_f32 v47, s38, v47
    v_cvt_pk_bf16_f32 v40, v40, v41
    v_mfma_f32_16x16x32_bf16 v[120:123], a[120:123], a[220:223], v[120:123]
    v_cvt_pk_bf16_f32 v41, v42, v43
    v_cvt_pk_bf16_f32 v42, v44, v45
    v_mfma_f32_16x16x32_bf16 v[120:123], a[184:187], a[244:247], v[120:123]
    v_cvt_pk_bf16_f32 v43, v46, v47
    v_permlane16_swap_b32 v32, v34
    v_mfma_f32_16x16x32_bf16 v[124:127], a[188:191], a[244:247], v[124:127]
    v_permlane16_swap_b32 v33, v35
    v_accvgpr_write_b32 a8, v32
    v_mfma_f32_16x16x32_bf16 v[124:127], a[124:127], a[220:223], v[124:127]
    v_accvgpr_write_b32 a9, v33
    v_accvgpr_write_b32 a10, v34
    v_mfma_f32_16x16x32_bf16 v[128:131], a[128:131], a[220:223], v[128:131]
    v_accvgpr_write_b32 a11, v35
    v_permlane16_swap_b32 v40, v42
    v_mfma_f32_16x16x32_bf16 v[128:131], a[192:195], a[244:247], v[128:131]
    v_permlane16_swap_b32 v41, v43
    v_accvgpr_write_b32 a12, v40
    v_mfma_f32_16x16x32_bf16 v[132:135], a[196:199], a[244:247], v[132:135]
    v_accvgpr_write_b32 a13, v41
    v_accvgpr_write_b32 a14, v42
    v_mfma_f32_16x16x32_bf16 v[132:135], a[132:135], a[220:223], v[132:135]
    v_accvgpr_write_b32 a15, v43
    v_mul_f32 v48, s38, v48
    v_mfma_f32_16x16x32_bf16 v[136:139], a[136:139], a[220:223], v[136:139]
    v_mul_f32 v49, s38, v49
    v_mul_f32 v50, s38, v50
    v_mfma_f32_16x16x32_bf16 v[136:139], a[200:203], a[244:247], v[136:139]
    v_mul_f32 v51, s38, v51
    v_mul_f32 v52, s38, v52
    v_mfma_f32_16x16x32_bf16 v[140:143], a[204:207], a[244:247], v[140:143]
    v_mul_f32 v53, s38, v53
    v_mul_f32 v54, s38, v54
    v_mfma_f32_16x16x32_bf16 v[140:143], a[140:143], a[220:223], v[140:143]
    v_mul_f32 v55, s38, v55
    v_cvt_pk_bf16_f32 v48, v48, v49
    s_waitcnt lgkmcnt(0)
    s_barrier
    ds_read_b128 a[72:75], v10
    ds_read_b128 a[76:79], v10 offset:1024
    s_cmp_lg_u32 s91, 0
    s_cbranch_scc1 L_safe2
    s_mov_b32 s35, 32768
    s_add_u32 s33, s33, 67072
    s_add_u32 s34, s34, 67072
    s_mov_b32 s37, 0
    v_mfma_f32_16x16x32_bf16 v[176:179], a[80:83], a[0:3], 0
    ds_read_b128 a[112:115], v230 offset:0
    ds_read_b128 a[116:119], v230 offset:64
    v_cvt_pk_bf16_f32 v49, v50, v51
    v_cvt_pk_bf16_f32 v50, v52, v53
    v_cvt_pk_bf16_f32 v51, v54, v55
    v_mfma_f32_16x16x32_bf16 v[176:179], a[84:87], a[4:7], v[176:179]
    ds_read_b128 a[120:123], v231 offset:0
    ds_read_b128 a[124:127], v231 offset:64
    v_mul_f32 v56, s38, v56
    v_mul_f32 v57, s38, v57
    v_mul_f32 v58, s38, v58
    v_mfma_f32_16x16x32_bf16 v[176:179], a[88:91], a[8:11], v[176:179]
    ds_read_b128 a[128:131], v230 offset:256
    ds_read_b128 a[132:135], v230 offset:320
    v_mul_f32 v59, s38, v59
    v_mul_f32 v60, s38, v60
    v_mul_f32 v61, s38, v61
    v_mfma_f32_16x16x32_bf16 v[176:179], a[92:95], a[12:15], v[176:179]
    ds_read_b128 a[136:139], v231 offset:256
    ds_read_b128 a[140:143], v231 offset:320
    v_mul_f32 v62, s38, v62
    v_mul_f32 v63, s38, v63
    v_cvt_pk_bf16_f32 v56, v56, v57
    v_mfma_f32_16x16x32_bf16 v[180:183], a[96:99], a[0:3], 0
    v_cvt_pk_bf16_f32 v57, v58, v59
    v_cvt_pk_bf16_f32 v58, v60, v61
    v_cvt_pk_bf16_f32 v59, v62, v63
    v_permlane16_swap_b32 v48, v50
    v_permlane16_swap_b32 v49, v51
    v_mfma_f32_16x16x32_bf16 v[180:183], a[100:103], a[4:7], v[180:183]
    v_accvgpr_write_b32 a16, v48
    v_accvgpr_write_b32 a17, v49
    v_accvgpr_write_b32 a18, v50
    v_accvgpr_write_b32 a19, v51
    v_mul_f32 v64, s38, v64
    v_mfma_f32_16x16x32_bf16 v[180:183], a[104:107], a[8:11], v[180:183]
    v_mul_f32 v65, s38, v65
    v_mul_f32 v66, s38, v66
    v_mul_f32 v67, s38, v67
    v_mul_f32 v68, s38, v68
    v_mul_f32 v69, s38, v69
    v_mfma_f32_16x16x32_bf16 v[180:183], a[108:111], a[12:15], v[180:183]
    v_mul_f32 v70, s38, v70
    v_mul_f32 v71, s38, v71
    v_cvt_pk_bf16_f32 v64, v64, v65
    v_cvt_pk_bf16_f32 v65, v66, v67
    s_waitcnt lgkmcnt(0)
    v_mfma_f32_16x16x32_bf16 v[184:187], a[112:115], a[0:3], 0
    ds_read_b64_tr_b16 a[176:177], v233 offset:0
    v_cvt_pk_bf16_f32 v66, v68, v69
    v_cvt_pk_bf16_f32 v67, v70, v71
    v_permlane16_swap_b32 v56, v58
    v_permlane16_swap_b32 v57, v59
    v_accvgpr_write_b32 a20, v56
    v_exp_f32 v176, v176
    v_mfma_f32_16x16x32_bf16 v[184:187], a[116:119], a[4:7], v[184:187]
    ds_read_b64_tr_b16 a[178:179], v233 offset:512
    v_accvgpr_write_b32 a21, v57
    v_accvgpr_write_b32 a22, v58
    v_accvgpr_write_b32 a23, v59
    v_mul_f32 v72, s38, v72
    v_mul_f32 v73, s38, v73
    v_exp_f32 v177, v177
    v_mfma_f32_16x16x32_bf16 v[184:187], a[120:123], a[8:11], v[184:187]
    ds_read_b64_tr_b16 a[180:181], v233 offset:32
    v_mul_f32 v74, s38, v74
    v_mul_f32 v75, s38, v75
    v_mul_f32 v76, s38, v76
    v_mul_f32 v77, s38, v77
    v_exp_f32 v178, v178
    v_cvt_pk_bf16_f32 v192, v176, v177
    v_mfma_f32_16x16x32_bf16 v[184:187], a[124:127], a[12:15], v[184:187]
    ds_read_b64_tr_b16 a[182:183], v233 offset:544
    v_mul_f32 v78, s38, v78
    v_mul_f32 v79, s38, v79
    v_cvt_pk_bf16_f32 v72, v72, v73
    v_cvt_pk_bf16_f32 v73, v74, v75
    v_exp_f32 v179, v179
    v_mfma_f32_16x16x32_bf16 v[188:191], a[128:131], a[0:3], 0
    ds_read_b64_tr_b16 a[184:185], v233 offset:64
    v_cvt_pk_bf16_f32 v74, v76, v77
    v_cvt_pk_bf16_f32 v75, v78, v79
    v_permlane16_swap_b32 v64, v66
    v_exp_f32 v180, v180
    v_cvt_pk_bf16_f32 v193, v178, v179
    v_mfma_f32_16x16x32_bf16 v[188:191], a[132:135], a[4:7], v[188:191]
    ds_read_b64_tr_b16 a[186:187], v233 offset:576
    v_permlane16_swap_b32 v65, v67
    v_accvgpr_write_b32 a24, v64
    v_accvgpr_write_b32 a25, v65
    v_accvgpr_write_b32 a26, v66
    v_exp_f32 v181, v181
    v_mfma_f32_16x16x32_bf16 v[188:191], a[136:139], a[8:11], v[188:191]
    ds_read_b64_tr_b16 a[188:189], v233 offset:96
    v_accvgpr_write_b32 a27, v67
    v_permlane16_swap_b32 v72, v74
    v_permlane16_swap_b32 v73, v75
    v_exp_f32 v182, v182
    v_cvt_pk_bf16_f32 v194, v180, v181
    v_mfma_f32_16x16x32_bf16 v[188:191], a[140:143], a[12:15], v[188:191]
    ds_read_b64_tr_b16 a[190:191], v233 offset:608
    v_accvgpr_write_b32 a28, v72
    v_accvgpr_write_b32 a29, v73
    v_accvgpr_write_b32 a30, v74
    v_accvgpr_write_b32 a31, v75
    v_exp_f32 v183, v183
    s_nop 0
    v_cvt_pk_bf16_f32 v195, v182, v183
    v_mfma_f32_16x16x32_bf16 v[176:179], a[80:83], a[16:19], 0
    ds_read_b64_tr_b16 a[192:193], v233 offset:128
    v_mul_f32 v80, s38, v80
    v_mul_f32 v81, s38, v81
    v_mul_f32 v82, s38, v82
    v_mul_f32 v83, s38, v83
    v_mul_f32 v84, s38, v84
    v_exp_f32 v184, v184
    v_mfma_f32_16x16x32_bf16 v[176:179], a[84:87], a[20:23], v[176:179]
    ds_read_b64_tr_b16 a[194:195], v233 offset:640
    v_mul_f32 v85, s38, v85
    v_mul_f32 v86, s38, v86
    v_mul_f32 v87, s38, v87
    v_cvt_pk_bf16_f32 v80, v80, v81
    v_cvt_pk_bf16_f32 v81, v82, v83
    v_exp_f32 v185, v185
    v_mfma_f32_16x16x32_bf16 v[176:179], a[88:91], a[24:27], v[176:179]
    ds_read_b64_tr_b16 a[196:197], v233 offset:160
    v_cvt_pk_bf16_f32 v82, v84, v85
    v_cvt_pk_bf16_f32 v83, v86, v87
    v_mul_f32 v88, s38, v88
    v_mul_f32 v89, s38, v89
    v_exp_f32 v186, v186
    v_cvt_pk_bf16_f32 v196, v184, v185
    v_mfma_f32_16x16x32_bf16 v[176:179], a[92:95], a[28:31], v[176:179]
    ds_read_b64_tr_b16 a[198:199], v233 offset:672
    v_mul_f32 v90, s38, v90
    v_mul_f32 v91, s38, v91
    v_mul_f32 v92, s38, v92
    v_mul_f32 v93, s38, v93
    v_mul_f32 v94, s38, v94
    v_exp_f32 v187, v187
    v_mfma_f32_16x16x32_bf16 v[180:183], a[96:99], a[16:19], 0
    ds_read_b64_tr_b16 a[200:201], v233 offset:192
    v_mul_f32 v95, s38, v95
    v_cvt_pk_bf16_f32 v88, v88, v89
    v_cvt_pk_bf16_f32 v89, v90, v91
    v_cvt_pk_bf16_f32 v90, v92, v93
    v_exp_f32 v188, v188
    v_cvt_pk_bf16_f32 v197, v186, v187
    v_mfma_f32_16x16x32_bf16 v[180:183], a[100:103], a[20:23], v[180:183]
    ds_read_b64_tr_b16 a[202:203], v233 offset:704
    v_cvt_pk_bf16_f32 v91, v94, v95
    v_permlane16_swap_b32 v80, v82
    v_permlane16_swap_b32 v81, v83
    v_accvgpr_write_b32 a32, v80
    v_accvgpr_write_b32 a33, v81
    v_exp_f32 v189, v189
    v_mfma_f32_16x16x32_bf16 v[180:183], a[104:107], a[24:27], v[180:183]
    ds_read_b64_tr_b16 a[204:205], v233 offset:224
    v_accvgpr_write_b32 a34, v82
    v_accvgpr_write_b32 a35, v83
    v_mul_f32 v96, s38, v96
    v_mul_f32 v97, s38, v97
    v_exp_f32 v190, v190
    v_cvt_pk_bf16_f32 v198, v188, v189
    v_mfma_f32_16x16x32_bf16 v[180:183], a[108:111], a[28:31], v[180:183]
    ds_read_b64_tr_b16 a[206:207], v233 offset:736
    v_mul_f32 v98, s38, v98
    v_mul_f32 v99, s38, v99
    v_mul_f32 v100, s38, v100
    v_mul_f32 v101, s38, v101
    v_exp_f32 v191, v191
    s_nop 0
    v_cvt_pk_bf16_f32 v199, v190, v191
    v_mfma_f32_16x16x32_bf16 v[184:187], a[112:115], a[16:19], 0
    v_mul_f32 v102, s38, v102
    v_mul_f32 v103, s38, v103
    v_cvt_pk_bf16_f32 v96, v96, v97
    v_exp_f32 v176, v176
    v_mfma_f32_16x16x32_bf16 v[184:187], a[116:119], a[20:23], v[184:187]
    v_cvt_pk_bf16_f32 v97, v98, v99
    v_cvt_pk_bf16_f32 v98, v100, v101
    v_cvt_pk_bf16_f32 v99, v102, v103
    v_permlane16_swap_b32 v88, v90
    v_permlane16_swap_b32 v89, v91
    v_mfma_f32_16x16x32_bf16 v[184:187], a[120:123], a[24:27], v[184:187]
    v_accvgpr_write_b32 a36, v88
    v_accvgpr_write_b32 a37, v89
    v_accvgpr_write_b32 a38, v90
    v_exp_f32 v177, v177
    v_mfma_f32_16x16x32_bf16 v[184:187], a[124:127], a[28:31], v[184:187]
    s_waitcnt lgkmcnt(0)
    v_accvgpr_write_b32 a39, v91
    v_mul_f32 v104, s38, v104
    v_mul_f32 v105, s38, v105
    v_cvt_pk_bf16_f32 v200, v176, v177
    v_mfma_f32_16x16x32_bf16 v[16:19], a[144:147], v[192:195], 0
    v_mul_f32 v106, s38, v106
    v_mul_f32 v107, s38, v107
    v_mul_f32 v108, s38, v108
    v_exp_f32 v178, v178
    v_mfma_f32_16x16x32_bf16 v[16:19], a[176:179], v[196:199], v[16:19]
    s_add_u32 m0, s33, 0
    v_mul_f32 v109, s38, v109
    v_mul_f32 v110, s38, v110
    v_mul_f32 v111, s38, v111
    v_cvt_pk_bf16_f32 v104, v104, v105
    v_mfma_f32_16x16x32_bf16 v[20:23], a[180:183], v[196:199], 0
    v_cvt_pk_bf16_f32 v105, v106, v107
    v_cvt_pk_bf16_f32 v106, v108, v109
    v_cvt_pk_bf16_f32 v107, v110, v111
    v_exp_f32 v179, v179
    v_mfma_f32_16x16x32_bf16 v[20:23], a[148:151], v[192:195], v[20:23]
    v_permlane16_swap_b32 v96, v98
    v_permlane16_swap_b32 v97, v99
    v_accvgpr_write_b32 a40, v96
    v_accvgpr_write_b32 a41, v97
    v_cvt_pk_bf16_f32 v201, v178, v179
    v_mfma_f32_16x16x32_bf16 v[24:27], a[152:155], v[192:195], 0
    v_accvgpr_write_b32 a42, v98
    v_accvgpr_write_b32 a43, v99
    v_permlane16_swap_b32 v104, v106
    v_exp_f32 v180, v180
    v_mfma_f32_16x16x32_bf16 v[24:27], a[184:187], v[196:199], v[24:27]
    buffer_load_dwordx4 v234, s[8:11], s35 offen offset:0 nt lds
    s_add_u32 m0, s33, 784
    v_permlane16_swap_b32 v105, v107
    v_accvgpr_write_b32 a44, v104
    v_accvgpr_write_b32 a45, v105
    v_mfma_f32_16x16x32_bf16 v[28:31], a[188:191], v[196:199], 0
    v_accvgpr_write_b32 a46, v106
    v_accvgpr_write_b32 a47, v107
    v_accvgpr_write_b32 a208, 0
    v_exp_f32 v181, v181
    v_mfma_f32_16x16x32_bf16 v[28:31], a[156:159], v[192:195], v[28:31]
    v_accvgpr_write_b32 a209, 0
    v_accvgpr_write_b32 a210, 0
    v_accvgpr_write_b32 a211, 0
    v_accvgpr_write_b32 a212, 0
    v_cvt_pk_bf16_f32 v202, v180, v181
    v_mfma_f32_16x16x32_bf16 v[188:191], a[128:131], a[16:19], 0
    v_accvgpr_write_b32 a213, 0
    v_accvgpr_write_b32 a214, 0
    v_accvgpr_write_b32 a215, 0
    v_exp_f32 v182, v182
    v_mfma_f32_16x16x32_bf16 v[188:191], a[132:135], a[20:23], v[188:191]
    buffer_load_dwordx4 v234, s[8:11], s35 offen offset:256 nt lds
    v_accvgpr_write_b32 a216, 0
    v_accvgpr_write_b32 a217, 0
    v_accvgpr_write_b32 a218, 0
    v_mfma_f32_16x16x32_bf16 v[188:191], a[136:139], a[24:27], v[188:191]
    v_accvgpr_write_b32 a219, 0
    v_accvgpr_write_b32 a220, 0
    v_exp_f32 v183, v183
    v_mfma_f32_16x16x32_bf16 v[188:191], a[140:143], a[28:31], v[188:191]
    v_accvgpr_write_b32 a221, 0
    v_accvgpr_write_b32 a222, 0
    v_accvgpr_write_b32 a223, 0
    v_cvt_pk_bf16_f32 v203, v182, v183
    v_mfma_f32_16x16x32_bf16 v[176:179], a[80:83], a[64:67], 0
    v_mul_f32 v112, s38, v112
    v_mul_f32 v113, s38, v113
    v_exp_f32 v184, v184
    v_mfma_f32_16x16x32_bf16 v[176:179], a[84:87], a[68:71], v[176:179]
    s_add_u32 m0, s33, 1568
    v_mul_f32 v114, s38, v114
    v_mul_f32 v115, s38, v115
    v_mul_f32 v116, s38, v116
    v_mfma_f32_16x16x32_bf16 v[176:179], a[88:91], a[72:75], v[176:179]
    v_mul_f32 v117, s38, v117
    v_mul_f32 v118, s38, v118
    v_exp_f32 v185, v185
    v_mfma_f32_16x16x32_bf16 v[176:179], a[92:95], a[76:79], v[176:179]
    v_mul_f32 v119, s38, v119
    v_cvt_pk_bf16_f32 v112, v112, v113
    v_cvt_pk_bf16_f32 v113, v114, v115
    v_cvt_pk_bf16_f32 v204, v184, v185
    v_mfma_f32_16x16x32_bf16 v[32:35], a[160:163], v[192:195], 0
    v_cvt_pk_bf16_f32 v114, v116, v117
    v_cvt_pk_bf16_f32 v115, v118, v119
    v_exp_f32 v186, v186
    v_mfma_f32_16x16x32_bf16 v[32:35], a[192:195], v[196:199], v[32:35]
    buffer_load_dwordx4 v234, s[8:11], s35 offen offset:512 nt lds
    s_add_u32 m0, s33, 2352
    v_mul_f32 v120, s38, v120
    v_mul_f32 v121, s38, v121
    v_mfma_f32_16x16x32_bf16 v[36:39], a[196:199], v[196:199], 0
    v_mul_f32 v122, s38, v122
    v_mul_f32 v123, s38, v123
    v_exp_f32 v187, v187
    v_mfma_f32_16x16x32_bf16 v[36:39], a[164:167], v[192:195], v[36:39]
    v_mul_f32 v124, s38, v124
    v_mul_f32 v125, s38, v125
    v_mul_f32 v126, s38, v126
    v_cvt_pk_bf16_f32 v205, v186, v187
    v_mfma_f32_16x16x32_bf16 v[40:43], a[168:171], v[192:195], 0
    v_mul_f32 v127, s38, v127
    v_cvt_pk_bf16_f32 v120, v120, v121
    v_exp_f32 v188, v188
    v_mfma_f32_16x16x32_bf16 v[40:43], a[200:203], v[196:199], v[40:43]
    buffer_load_dwordx4 v234, s[8:11], s35 offen offset:768 nt lds
    v_cvt_pk_bf16_f32 v121, v122, v123
    v_cvt_pk_bf16_f32 v122, v124, v125
    v_mfma_f32_16x16x32_bf16 v[44:47], a[204:207], v[196:199], 0
    v_cvt_pk_bf16_f32 v123, v126, v127
    v_exp_f32 v189, v189
    v_mfma_f32_16x16x32_bf16 v[44:47], a[172:175], v[192:195], v[44:47]
    v_permlane16_swap_b32 v112, v114
    v_permlane16_swap_b32 v113, v115
    v_cvt_pk_bf16_f32 v206, v188, v189
    v_smfmac_f32_16x16x64_bf16 a[208:211], a[228:231], v[192:199], v1
    v_accvgpr_write_b32 a48, v112
    v_exp_f32 v190, v190
    v_mfma_f32_16x16x32_bf16 v[180:183], a[96:99], a[64:67], 0
    v_accvgpr_write_b32 a49, v113
    v_accvgpr_write_b32 a50, v114
    v_accvgpr_write_b32 a51, v115
    v_mfma_f32_16x16x32_bf16 v[180:183], a[100:103], a[68:71], v[180:183]
    v_mul_f32 v128, s38, v128
    v_exp_f32 v191, v191
    v_mfma_f32_16x16x32_bf16 v[180:183], a[104:107], a[72:75], v[180:183]
    v_mul_f32 v129, s38, v129
    v_mul_f32 v130, s38, v130
    v_cvt_pk_bf16_f32 v207, v190, v191
    v_mfma_f32_16x16x32_bf16 v[180:183], a[108:111], a[76:79], v[180:183]
    v_mul_f32 v131, s38, v131
    v_mul_f32 v132, s38, v132
    v_mul_f32 v133, s38, v133
    v_mfma_f32_16x16x32_bf16 v[184:187], a[80:83], a[32:35], 0
    v_mul_f32 v134, s38, v134
    v_mul_f32 v135, s38, v135
    v_exp_f32 v176, v176
    v_mfma_f32_16x16x32_bf16 v[184:187], a[84:87], a[36:39], v[184:187]
    s_add_u32 m0, s34, 0
    v_cvt_pk_bf16_f32 v128, v128, v129
    v_cvt_pk_bf16_f32 v129, v130, v131
    v_cvt_pk_bf16_f32 v130, v132, v133
    v_mfma_f32_16x16x32_bf16 v[184:187], a[88:91], a[40:43], v[184:187]
    v_cvt_pk_bf16_f32 v131, v134, v135
    v_permlane16_swap_b32 v120, v122
    v_exp_f32 v177, v177
    v_mfma_f32_16x16x32_bf16 v[184:187], a[92:95], a[44:47], v[184:187]
    v_permlane16_swap_b32 v121, v123
    v_accvgpr_write_b32 a52, v120
    v_accvgpr_write_b32 a53, v121
    v_cvt_pk_bf16_f32 v224, v176, v177
    v_mfma_f32_16x16x32_bf16 v[48:51], a[144:147], v[200:203], 0
    v_accvgpr_write_b32 a54, v122
    v_accvgpr_write_b32 a55, v123
    v_exp_f32 v178, v178
    v_mfma_f32_16x16x32_bf16 v[48:51], a[176:179], v[204:207], v[48:51]
    buffer_load_dwordx4 v235, s[12:15], s35 offen offset:0 nt lds
    s_add_u32 m0, s34, 800
    v_mul_f32 v136, s38, v136
    v_mul_f32 v137, s38, v137
    v_mfma_f32_16x16x32_bf16 v[52:55], a[180:183], v[204:207], 0
    v_mul_f32 v138, s38, v138
    v_mul_f32 v139, s38, v139
    v_exp_f32 v179, v179
    v_mfma_f32_16x16x32_bf16 v[52:55], a[148:151], v[200:203], v[52:55]
    v_mul_f32 v140, s38, v140
    v_mul_f32 v141, s38, v141
    v_mul_f32 v142, s38, v142
    v_cvt_pk_bf16_f32 v225, v178, v179
    v_mfma_f32_16x16x32_bf16 v[56:59], a[152:155], v[200:203], 0
    v_mul_f32 v143, s38, v143
    v_cvt_pk_bf16_f32 v136, v136, v137
    v_exp_f32 v180, v180
    v_mfma_f32_16x16x32_bf16 v[56:59], a[184:187], v[204:207], v[56:59]
    buffer_load_dwordx4 v235, s[12:15], s35 offen offset:256 nt lds
    v_cvt_pk_bf16_f32 v137, v138, v139
    v_cvt_pk_bf16_f32 v138, v140, v141
    v_cvt_pk_bf16_f32 v139, v142, v143
    v_mfma_f32_16x16x32_bf16 v[60:63], a[188:191], v[204:207], 0
    v_permlane16_swap_b32 v128, v130
    v_permlane16_swap_b32 v129, v131
    v_exp_f32 v181, v181
    v_mfma_f32_16x16x32_bf16 v[60:63], a[156:159], v[200:203], v[60:63]
    v_accvgpr_write_b32 a56, v128
    v_accvgpr_write_b32 a57, v129
    v_accvgpr_write_b32 a58, v130
    v_cvt_pk_bf16_f32 v226, v180, v181
    v_mfma_f32_16x16x32_bf16 v[188:191], a[96:99], a[32:35], 0
    v_accvgpr_write_b32 a59, v131
    v_exp_f32 v182, v182
    v_mfma_f32_16x16x32_bf16 v[188:191], a[100:103], a[36:39], v[188:191]
    v_permlane16_swap_b32 v136, v138
    v_permlane16_swap_b32 v137, v139
    v_accvgpr_write_b32 a60, v136
    v_mfma_f32_16x16x32_bf16 v[188:191], a[104:107], a[40:43], v[188:191]
    v_accvgpr_write_b32 a61, v137
    v_exp_f32 v183, v183
    v_mfma_f32_16x16x32_bf16 v[188:191], a[108:111], a[44:47], v[188:191]
    v_accvgpr_write_b32 a62, v138
    v_accvgpr_write_b32 a63, v139
    v_cvt_pk_bf16_f32 v227, v182, v183
    v_mfma_f32_16x16x32_bf16 v[176:179], a[112:115], a[32:35], 0
    v_exp_f32 v184, v184
    v_mfma_f32_16x16x32_bf16 v[176:179], a[116:119], a[36:39], v[176:179]
    s_add_u32 m0, s34, 1600
    v_mfma_f32_16x16x32_bf16 v[176:179], a[120:123], a[40:43], v[176:179]
    v_exp_f32 v185, v185
    v_mfma_f32_16x16x32_bf16 v[176:179], a[124:127], a[44:47], v[176:179]
    buffer_load_dwordx4 v235, s[12:15], s35 offen offset:512 nt lds
    v_cvt_pk_bf16_f32 v208, v184, v185
    v_mfma_f32_16x16x32_bf16 v[64:67], a[160:163], v[200:203], 0
    v_exp_f32 v186, v186
    v_mfma_f32_16x16x32_bf16 v[64:67], a[192:195], v[204:207], v[64:67]
    s_add_u32 m0, s34, 2400
    v_mfma_f32_16x16x32_bf16 v[68:71], a[196:199], v[204:207], 0
    v_exp_f32 v187, v187
    v_mfma_f32_16x16x32_bf16 v[68:71], a[164:167], v[200:203], v[68:71]
    buffer_load_dwordx4 v235, s[12:15], s35 offen offset:768 nt lds
    v_cvt_pk_bf16_f32 v209, v186, v187
    v_mfma_f32_16x16x32_bf16 v[72:75], a[168:171], v[200:203], 0
    v_exp_f32 v188, v188
    v_mfma_f32_16x16x32_bf16 v[72:75], a[200:203], v[204:207], v[72:75]
    s_and_b32 s40, s37, 3
    s_cmp_eq_u32 s40, 1
    v_mfma_f32_16x16x32_bf16 v[76:79], a[204:207], v[204:207], 0
    v_exp_f32 v189, v189
    v_mfma_f32_16x16x32_bf16 v[76:79], a[172:175], v[200:203], v[76:79]
    s_cselect_b32 s36, 0xfffe7700, s100
    v_cvt_pk_bf16_f32 v210, v188, v189
    v_smfmac_f32_16x16x64_bf16 a[212:215], a[228:231], v[200:207], v1
    v_exp_f32 v190, v190
    v_mfma_f32_16x16x32_bf16 v[180:183], a[128:131], a[32:35], 0
    s_add_u32 s33, s33, s36
    s_add_u32 s34, s34, s36
    v_mfma_f32_16x16x32_bf16 v[180:183], a[132:135], a[36:39], v[180:183]
    v_exp_f32 v191, v191
    v_mfma_f32_16x16x32_bf16 v[180:183], a[136:139], a[40:43], v[180:183]
    s_add_u32 s35, s35, 16384
    v_cvt_pk_bf16_f32 v211, v190, v191
    v_mfma_f32_16x16x32_bf16 v[180:183], a[140:143], a[44:47], v[180:183]
    v_mfma_f32_16x16x32_bf16 v[184:187], a[80:83], a[48:51], 0
    v_exp_f32 v176, v176
    v_mfma_f32_16x16x32_bf16 v[184:187], a[84:87], a[52:55], v[184:187]
    s_add_u32 s37, s37, 1
    s_and_b32 s40, s37, 3
    v_mfma_f32_16x16x32_bf16 v[184:187], a[88:91], a[56:59], v[184:187]
    v_exp_f32 v177, v177
    v_mfma_f32_16x16x32_bf16 v[184:187], a[92:95], a[60:63], v[184:187]
    s_cmp_eq_u32 s40, 0
    v_cvt_pk_bf16_f32 v212, v176, v177
    v_mfma_f32_16x16x32_bf16 v[144:147], a[144:147], v[224:227], 0
    v_exp_f32 v178, v178
    v_mfma_f32_16x16x32_bf16 v[148:151], a[148:151], v[224:227], 0
    s_cselect_b32 s36, 0xfffe7700, s100
    v_add_u32 v228, s36, v228
    v_mfma_f32_16x16x32_bf16 v[152:155], a[152:155], v[224:227], 0
    v_exp_f32 v179, v179
    v_mfma_f32_16x16x32_bf16 v[156:159], a[156:159], v[224:227], 0
    v_add_u32 v229, s36, v229
    v_cvt_pk_bf16_f32 v213, v178, v179
    v_mfma_f32_16x16x32_bf16 v[160:163], a[160:163], v[224:227], 0
    v_exp_f32 v180, v180
    v_mfma_f32_16x16x32_bf16 v[164:167], a[164:167], v[224:227], 0
    v_add_u32 v232, s36, v232
    v_add_u32 v230, s36, v230
    v_mfma_f32_16x16x32_bf16 v[168:171], a[168:171], v[224:227], 0
    v_exp_f32 v181, v181
    v_mfma_f32_16x16x32_bf16 v[172:175], a[172:175], v[224:227], 0
    v_add_u32 v231, s36, v231
    v_cvt_pk_bf16_f32 v214, v180, v181
    v_mfma_f32_16x16x32_bf16 a[224:227], a[228:231], v[224:227], 0
    v_exp_f32 v182, v182
    v_mfma_f32_16x16x32_bf16 v[188:191], a[96:99], a[48:51], 0
    v_add_u32 v233, s36, v233
    v_mfma_f32_16x16x32_bf16 v[188:191], a[100:103], a[52:55], v[188:191]
    v_exp_f32 v183, v183
    v_mfma_f32_16x16x32_bf16 v[188:191], a[104:107], a[56:59], v[188:191]
    v_cvt_pk_bf16_f32 v215, v182, v183
    v_mfma_f32_16x16x32_bf16 v[188:191], a[108:111], a[60:63], v[188:191]
    s_waitcnt vmcnt(9)
    s_barrier
    v_mfma_f32_16x16x32_bf16 v[176:179], a[112:115], a[48:51], 0
    v_exp_f32 v184, v184
    v_mfma_f32_16x16x32_bf16 v[176:179], a[116:119], a[52:55], v[176:179]
    ds_read_b128 a[80:83], v228 offset:0
    ds_read_b128 a[84:87], v228 offset:64
    v_mfma_f32_16x16x32_bf16 v[176:179], a[120:123], a[56:59], v[176:179]
    v_exp_f32 v185, v185
    v_mfma_f32_16x16x32_bf16 v[176:179], a[124:127], a[60:63], v[176:179]
    ds_read_b128 a[88:91], v229 offset:0
    v_cvt_pk_bf16_f32 v216, v184, v185
    v_mfma_f32_16x16x32_bf16 v[80:83], a[144:147], v[208:211], 0
    v_exp_f32 v186, v186
    v_mfma_f32_16x16x32_bf16 v[80:83], a[176:179], v[212:215], v[80:83]
    ds_read_b128 a[92:95], v229 offset:64
    ds_read_b128 a[96:99], v228 offset:256
    v_mfma_f32_16x16x32_bf16 v[84:87], a[180:183], v[212:215], 0
    v_exp_f32 v187, v187
    v_mfma_f32_16x16x32_bf16 v[84:87], a[148:151], v[208:211], v[84:87]
    ds_read_b128 a[100:103], v228 offset:320
    v_cvt_pk_bf16_f32 v217, v186, v187
    v_mfma_f32_16x16x32_bf16 v[88:91], a[152:155], v[208:211], 0
    v_exp_f32 v188, v188
    v_mfma_f32_16x16x32_bf16 v[88:91], a[184:187], v[212:215], v[88:91]
    ds_read_b128 a[104:107], v229 offset:256
    ds_read_b128 a[108:111], v229 offset:320
    v_mfma_f32_16x16x32_bf16 v[92:95], a[188:191], v[212:215], 0
    v_exp_f32 v189, v189
    v_mfma_f32_16x16x32_bf16 v[92:95], a[156:159], v[208:211], v[92:95]
    v_cvt_pk_bf16_f32 v218, v188, v189
    v_mfma_f32_16x16x32_bf16 v[180:183], a[128:131], a[48:51], 0
    v_exp_f32 v190, v190
    v_mfma_f32_16x16x32_bf16 v[180:183], a[132:135], a[52:55], v[180:183]
    v_mfma_f32_16x16x32_bf16 v[180:183], a[136:139], a[56:59], v[180:183]
    v_exp_f32 v191, v191
    v_mfma_f32_16x16x32_bf16 v[180:183], a[140:143], a[60:63], v[180:183]
    v_cvt_pk_bf16_f32 v219, v190, v191
    s_waitcnt lgkmcnt(0)
    v_mfma_f32_16x16x32_bf16 v[184:187], a[80:83], a[0:3], 0
    v_exp_f32 v176, v176
    v_mfma_f32_16x16x32_bf16 v[184:187], a[84:87], a[4:7], v[184:187]
    buffer_atomic_add v15, v14, s[80:83], 0 offen sc1
    ds_read_b128 a[112:115], v230 offset:0
    ds_read_b128 a[116:119], v230 offset:64
    v_mfma_f32_16x16x32_bf16 v[184:187], a[88:91], a[8:11], v[184:187]
    v_exp_f32 v177, v177
    v_mfma_f32_16x16x32_bf16 v[184:187], a[92:95], a[12:15], v[184:187]
    ds_read_b128 a[120:123], v231 offset:0
    v_cvt_pk_bf16_f32 v220, v176, v177
    v_mfma_f32_16x16x32_bf16 v[96:99], a[160:163], v[208:211], 0
    v_exp_f32 v178, v178
    v_mfma_f32_16x16x32_bf16 v[96:99], a[192:195], v[212:215], v[96:99]
    ds_read_b128 a[124:127], v231 offset:64
    ds_read_b128 a[128:131], v230 offset:256
    v_mfma_f32_16x16x32_bf16 v[100:103], a[196:199], v[212:215], 0
    v_exp_f32 v179, v179
    v_mfma_f32_16x16x32_bf16 v[100:103], a[164:167], v[208:211], v[100:103]
    ds_read_b128 a[132:135], v230 offset:320
    v_cvt_pk_bf16_f32 v221, v178, v179
    v_mfma_f32_16x16x32_bf16 v[104:107], a[168:171], v[208:211], 0
    v_exp_f32 v180, v180
    v_mfma_f32_16x16x32_bf16 v[104:107], a[200:203], v[212:215], v[104:107]
    ds_read_b128 a[136:139], v231 offset:256
    ds_read_b128 a[140:143], v231 offset:320
    v_mfma_f32_16x16x32_bf16 v[108:111], a[204:207], v[212:215], 0
    v_exp_f32 v181, v181
    v_mfma_f32_16x16x32_bf16 v[108:111], a[172:175], v[208:211], v[108:111]
    s_add_u32 m0, s33, 0
    v_cvt_pk_bf16_f32 v222, v180, v181
    v_smfmac_f32_16x16x64_bf16 a[216:219], a[228:231], v[208:215], v1
    v_exp_f32 v182, v182
    v_mfma_f32_16x16x32_bf16 v[188:191], a[96:99], a[0:3], 0
    buffer_load_dwordx4 v234, s[8:11], s35 offen offset:0 nt lds
    s_add_u32 m0, s33, 784
    v_mfma_f32_16x16x32_bf16 v[188:191], a[100:103], a[4:7], v[188:191]
    v_exp_f32 v183, v183
    v_mfma_f32_16x16x32_bf16 v[188:191], a[104:107], a[8:11], v[188:191]
    buffer_load_dwordx4 v234, s[8:11], s35 offen offset:256 nt lds
    v_cvt_pk_bf16_f32 v223, v182, v183
    v_mfma_f32_16x16x32_bf16 v[188:191], a[108:111], a[12:15], v[188:191]
    s_waitcnt lgkmcnt(0)
    v_mfma_f32_16x16x32_bf16 v[176:179], a[112:115], a[0:3], 0
    v_exp_f32 v184, v184
    v_mfma_f32_16x16x32_bf16 v[176:179], a[116:119], a[4:7], v[176:179]
    s_add_u32 m0, s33, 1568
    v_mfma_f32_16x16x32_bf16 v[176:179], a[120:123], a[8:11], v[176:179]
    v_exp_f32 v185, v185
    v_mfma_f32_16x16x32_bf16 v[176:179], a[124:127], a[12:15], v[176:179]
    buffer_load_dwordx4 v234, s[8:11], s35 offen offset:512 nt lds
    v_cvt_pk_bf16_f32 v192, v184, v185
    v_mfma_f32_16x16x32_bf16 v[112:115], a[144:147], v[216:219], 0
    v_exp_f32 v186, v186
    v_mfma_f32_16x16x32_bf16 v[112:115], a[176:179], v[220:223], v[112:115]
    ds_read_b64_tr_b16 a[144:145], v232 offset:0
    ds_read_b64_tr_b16 a[146:147], v232 offset:512
    v_mfma_f32_16x16x32_bf16 v[116:119], a[180:183], v[220:223], 0
    v_exp_f32 v187, v187
    v_mfma_f32_16x16x32_bf16 v[116:119], a[148:151], v[216:219], v[116:119]
    ds_read_b64_tr_b16 a[176:177], v233 offset:0
    v_cvt_pk_bf16_f32 v193, v186, v187
    v_mfma_f32_16x16x32_bf16 v[120:123], a[152:155], v[216:219], 0
    v_exp_f32 v188, v188
    v_mfma_f32_16x16x32_bf16 v[120:123], a[184:187], v[220:223], v[120:123]
    ds_read_b64_tr_b16 a[178:179], v233 offset:512
    ds_read_b64_tr_b16 a[148:149], v232 offset:32
    v_mfma_f32_16x16x32_bf16 v[124:127], a[188:191], v[220:223], 0
    v_exp_f32 v189, v189
    v_mfma_f32_16x16x32_bf16 v[124:127], a[156:159], v[216:219], v[124:127]
    ds_read_b64_tr_b16 a[150:151], v232 offset:544
    v_cvt_pk_bf16_f32 v194, v188, v189
    v_mfma_f32_16x16x32_bf16 v[180:183], a[128:131], a[0:3], 0
    v_exp_f32 v190, v190
    v_mfma_f32_16x16x32_bf16 v[180:183], a[132:135], a[4:7], v[180:183]
    ds_read_b64_tr_b16 a[180:181], v233 offset:32
    ds_read_b64_tr_b16 a[182:183], v233 offset:544
    v_mfma_f32_16x16x32_bf16 v[180:183], a[136:139], a[8:11], v[180:183]
    v_exp_f32 v191, v191
    v_mfma_f32_16x16x32_bf16 v[180:183], a[140:143], a[12:15], v[180:183]
    ds_read_b64_tr_b16 a[152:153], v232 offset:64
    v_cvt_pk_bf16_f32 v195, v190, v191
    v_mfma_f32_16x16x32_bf16 v[184:187], a[80:83], a[16:19], 0
    v_exp_f32 v176, v176
    v_mfma_f32_16x16x32_bf16 v[184:187], a[84:87], a[20:23], v[184:187]
    ds_read_b64_tr_b16 a[154:155], v232 offset:576
    ds_read_b64_tr_b16 a[184:185], v233 offset:64
    v_mfma_f32_16x16x32_bf16 v[184:187], a[88:91], a[24:27], v[184:187]
    v_exp_f32 v177, v177
    v_mfma_f32_16x16x32_bf16 v[184:187], a[92:95], a[28:31], v[184:187]
    ds_read_b64_tr_b16 a[186:187], v233 offset:576
    v_cvt_pk_bf16_f32 v196, v176, v177
    v_mfma_f32_16x16x32_bf16 v[128:131], a[160:163], v[216:219], 0
    v_exp_f32 v178, v178
    v_mfma_f32_16x16x32_bf16 v[128:131], a[192:195], v[220:223], v[128:131]
    ds_read_b64_tr_b16 a[156:157], v232 offset:96
    ds_read_b64_tr_b16 a[158:159], v232 offset:608
    v_mfma_f32_16x16x32_bf16 v[132:135], a[196:199], v[220:223], 0
    v_exp_f32 v179, v179
    v_mfma_f32_16x16x32_bf16 v[132:135], a[164:167], v[216:219], v[132:135]
    ds_read_b64_tr_b16 a[188:189], v233 offset:96
    v_cvt_pk_bf16_f32 v197, v178, v179
    v_mfma_f32_16x16x32_bf16 v[136:139], a[168:171], v[216:219], 0
    v_exp_f32 v180, v180
    v_mfma_f32_16x16x32_bf16 v[136:139], a[200:203], v[220:223], v[136:139]
    ds_read_b64_tr_b16 a[190:191], v233 offset:608
    ds_read_b64_tr_b16 a[160:161], v232 offset:128
    v_mfma_f32_16x16x32_bf16 v[140:143], a[204:207], v[220:223], 0
    v_exp_f32 v181, v181
    v_mfma_f32_16x16x32_bf16 v[140:143], a[172:175], v[216:219], v[140:143]
    ds_read_b64_tr_b16 a[162:163], v232 offset:640
    v_cvt_pk_bf16_f32 v198, v180, v181
    v_smfmac_f32_16x16x64_bf16 a[220:223], a[228:231], v[216:223], v1
    v_exp_f32 v182, v182
    v_mfma_f32_16x16x32_bf16 v[188:191], a[96:99], a[16:19], 0
    ds_read_b64_tr_b16 a[192:193], v233 offset:128
    ds_read_b64_tr_b16 a[194:195], v233 offset:640
    v_mfma_f32_16x16x32_bf16 v[188:191], a[100:103], a[20:23], v[188:191]
    v_exp_f32 v183, v183
    v_mfma_f32_16x16x32_bf16 v[188:191], a[104:107], a[24:27], v[188:191]
    ds_read_b64_tr_b16 a[164:165], v232 offset:160
    v_cvt_pk_bf16_f32 v199, v182, v183
    v_mfma_f32_16x16x32_bf16 v[188:191], a[108:111], a[28:31], v[188:191]
    ds_read_b64_tr_b16 a[166:167], v232 offset:672
    ds_read_b64_tr_b16 a[196:197], v233 offset:160
    v_mfma_f32_16x16x32_bf16 v[176:179], a[112:115], a[16:19], 0
    v_exp_f32 v184, v184
    v_mfma_f32_16x16x32_bf16 v[176:179], a[116:119], a[20:23], v[176:179]
    ds_read_b64_tr_b16 a[198:199], v233 offset:672
    ds_read_b64_tr_b16 a[168:169], v232 offset:192
    v_mfma_f32_16x16x32_bf16 v[176:179], a[120:123], a[24:27], v[176:179]
    v_exp_f32 v185, v185
    v_mfma_f32_16x16x32_bf16 v[176:179], a[124:127], a[28:31], v[176:179]
    s_waitcnt lgkmcnt(9)
    v_cvt_pk_bf16_f32 v200, v184, v185
    v_mfma_f32_16x16x32_bf16 v[16:19], a[144:147], v[192:195], v[16:19]
    v_exp_f32 v186, v186
    v_mfma_f32_16x16x32_bf16 v[16:19], a[176:179], v[196:199], v[16:19]
    ds_read_b64_tr_b16 a[170:171], v232 offset:704
    ds_read_b64_tr_b16 a[200:201], v233 offset:192
    v_mfma_f32_16x16x32_bf16 v[20:23], a[180:183], v[196:199], v[20:23]
    v_exp_f32 v187, v187
    v_mfma_f32_16x16x32_bf16 v[20:23], a[148:151], v[192:195], v[20:23]
    ds_read_b64_tr_b16 a[202:203], v233 offset:704
    v_cvt_pk_bf16_f32 v201, v186, v187
    v_mfma_f32_16x16x32_bf16 v[24:27], a[152:155], v[192:195], v[24:27]
    v_exp_f32 v188, v188
    v_mfma_f32_16x16x32_bf16 v[24:27], a[184:187], v[196:199], v[24:27]
    ds_read_b64_tr_b16 a[172:173], v232 offset:224
    ds_read_b64_tr_b16 a[174:175], v232 offset:736
    v_mfma_f32_16x16x32_bf16 v[28:31], a[188:191], v[196:199], v[28:31]
    v_exp_f32 v189, v189
    v_mfma_f32_16x16x32_bf16 v[28:31], a[156:159], v[192:195], v[28:31]
    ds_read_b64_tr_b16 a[204:205], v233 offset:224
    v_cvt_pk_bf16_f32 v202, v188, v189
    v_mfma_f32_16x16x32_bf16 v[180:183], a[128:131], a[16:19], 0
    v_exp_f32 v190, v190
    v_mfma_f32_16x16x32_bf16 v[180:183], a[132:135], a[20:23], v[180:183]
    ds_read_b64_tr_b16 a[206:207], v233 offset:736
    v_mfma_f32_16x16x32_bf16 v[180:183], a[136:139], a[24:27], v[180:183]
    v_exp_f32 v191, v191
    v_mfma_f32_16x16x32_bf16 v[180:183], a[140:143], a[28:31], v[180:183]
    v_cvt_pk_bf16_f32 v203, v190, v191
    v_mfma_f32_16x16x32_bf16 v[184:187], a[80:83], a[64:67], 0
    v_exp_f32 v176, v176
    v_mfma_f32_16x16x32_bf16 v[184:187], a[84:87], a[68:71], v[184:187]
    s_add_u32 m0, s33, 2352
    v_mfma_f32_16x16x32_bf16 v[184:187], a[88:91], a[72:75], v[184:187]
    v_exp_f32 v177, v177
    v_mfma_f32_16x16x32_bf16 v[184:187], a[92:95], a[76:79], v[184:187]
    s_waitcnt lgkmcnt(0)
    v_cvt_pk_bf16_f32 v204, v176, v177
    v_mfma_f32_16x16x32_bf16 v[32:35], a[160:163], v[192:195], v[32:35]
    v_exp_f32 v178, v178
    v_mfma_f32_16x16x32_bf16 v[32:35], a[192:195], v[196:199], v[32:35]
    buffer_load_dwordx4 v234, s[8:11], s35 offen offset:768 nt lds
    s_add_u32 m0, s34, 0
    v_mfma_f32_16x16x32_bf16 v[36:39], a[196:199], v[196:199], v[36:39]
    v_exp_f32 v179, v179
    v_mfma_f32_16x16x32_bf16 v[36:39], a[164:167], v[192:195], v[36:39]
    v_cvt_pk_bf16_f32 v205, v178, v179
    v_mfma_f32_16x16x32_bf16 v[40:43], a[168:171], v[192:195], v[40:43]
    v_exp_f32 v180, v180
    v_mfma_f32_16x16x32_bf16 v[40:43], a[200:203], v[196:199], v[40:43]
    buffer_load_dwordx4 v235, s[12:15], s35 offen offset:0 nt lds
    v_mfma_f32_16x16x32_bf16 v[44:47], a[204:207], v[196:199], v[44:47]
    v_exp_f32 v181, v181
    v_mfma_f32_16x16x32_bf16 v[44:47], a[172:175], v[192:195], v[44:47]
    v_cvt_pk_bf16_f32 v206, v180, v181
    v_smfmac_f32_16x16x64_bf16 a[208:211], a[228:231], v[192:199], v1
    v_exp_f32 v182, v182
    v_mfma_f32_16x16x32_bf16 v[188:191], a[96:99], a[64:67], 0
    v_mfma_f32_16x16x32_bf16 v[188:191], a[100:103], a[68:71], v[188:191]
    v_exp_f32 v183, v183
    v_mfma_f32_16x16x32_bf16 v[188:191], a[104:107], a[72:75], v[188:191]
    v_cvt_pk_bf16_f32 v207, v182, v183
    v_mfma_f32_16x16x32_bf16 v[188:191], a[108:111], a[76:79], v[188:191]
    v_mfma_f32_16x16x32_bf16 v[176:179], a[80:83], a[32:35], 0
    v_exp_f32 v184, v184
    v_mfma_f32_16x16x32_bf16 v[176:179], a[84:87], a[36:39], v[176:179]
    s_add_u32 m0, s34, 800
    v_mfma_f32_16x16x32_bf16 v[176:179], a[88:91], a[40:43], v[176:179]
    v_exp_f32 v185, v185
    v_mfma_f32_16x16x32_bf16 v[176:179], a[92:95], a[44:47], v[176:179]
    v_cvt_pk_bf16_f32 v224, v184, v185
    v_mfma_f32_16x16x32_bf16 v[48:51], a[144:147], v[200:203], v[48:51]
    v_exp_f32 v186, v186
    v_mfma_f32_16x16x32_bf16 v[48:51], a[176:179], v[204:207], v[48:51]
    buffer_load_dwordx4 v235, s[12:15], s35 offen offset:256 nt lds
    s_add_u32 m0, s34, 1600
    v_mfma_f32_16x16x32_bf16 v[52:55], a[180:183], v[204:207], v[52:55]
    v_exp_f32 v187, v187
    v_mfma_f32_16x16x32_bf16 v[52:55], a[148:151], v[200:203], v[52:55]
    v_cvt_pk_bf16_f32 v225, v186, v187
    v_mfma_f32_16x16x32_bf16 v[56:59], a[152:155], v[200:203], v[56:59]
    v_exp_f32 v188, v188
    v_mfma_f32_16x16x32_bf16 v[56:59], a[184:187], v[204:207], v[56:59]
    buffer_load_dwordx4 v235, s[12:15], s35 offen offset:512 nt lds
    v_mfma_f32_16x16x32_bf16 v[60:63], a[188:191], v[204:207], v[60:63]
    v_exp_f32 v189, v189
    v_mfma_f32_16x16x32_bf16 v[60:63], a[156:159], v[200:203], v[60:63]
    v_cvt_pk_bf16_f32 v226, v188, v189
    v_mfma_f32_16x16x32_bf16 v[180:183], a[96:99], a[32:35], 0
    v_exp_f32 v190, v190
    v_mfma_f32_16x16x32_bf16 v[180:183], a[100:103], a[36:39], v[180:183]
    v_mfma_f32_16x16x32_bf16 v[180:183], a[104:107], a[40:43], v[180:183]
    v_exp_f32 v191, v191
    v_mfma_f32_16x16x32_bf16 v[180:183], a[108:111], a[44:47], v[180:183]
    v_cvt_pk_bf16_f32 v227, v190, v191
    v_mfma_f32_16x16x32_bf16 v[184:187], a[112:115], a[32:35], 0
    v_exp_f32 v176, v176
    v_mfma_f32_16x16x32_bf16 v[184:187], a[116:119], a[36:39], v[184:187]
    s_add_u32 m0, s34, 2400
    v_mfma_f32_16x16x32_bf16 v[184:187], a[120:123], a[40:43], v[184:187]
    v_exp_f32 v177, v177
    v_mfma_f32_16x16x32_bf16 v[184:187], a[124:127], a[44:47], v[184:187]
    buffer_load_dwordx4 v235, s[12:15], s35 offen offset:768 nt lds
    v_cvt_pk_bf16_f32 v208, v176, v177
    v_mfma_f32_16x16x32_bf16 v[64:67], a[160:163], v[200:203], v[64:67]
    v_exp_f32 v178, v178
    v_mfma_f32_16x16x32_bf16 v[64:67], a[192:195], v[204:207], v[64:67]
    s_and_b32 s40, s37, 3
    s_cmp_eq_u32 s40, 1
    v_mfma_f32_16x16x32_bf16 v[68:71], a[196:199], v[204:207], v[68:71]
    v_exp_f32 v179, v179
    v_mfma_f32_16x16x32_bf16 v[68:71], a[164:167], v[200:203], v[68:71]
    s_cselect_b32 s36, 0xfffe7700, s100
    v_cvt_pk_bf16_f32 v209, v178, v179
    v_mfma_f32_16x16x32_bf16 v[72:75], a[168:171], v[200:203], v[72:75]
    v_exp_f32 v180, v180
    v_mfma_f32_16x16x32_bf16 v[72:75], a[200:203], v[204:207], v[72:75]
    s_add_u32 s33, s33, s36
    s_add_u32 s34, s34, s36
    v_mfma_f32_16x16x32_bf16 v[76:79], a[204:207], v[204:207], v[76:79]
    v_exp_f32 v181, v181
    v_mfma_f32_16x16x32_bf16 v[76:79], a[172:175], v[200:203], v[76:79]
    s_add_u32 s35, s35, 16384
    v_cvt_pk_bf16_f32 v210, v180, v181
    v_smfmac_f32_16x16x64_bf16 a[212:215], a[228:231], v[200:207], v1
    v_exp_f32 v182, v182
    v_mfma_f32_16x16x32_bf16 v[188:191], a[128:131], a[32:35], 0
    v_mfma_f32_16x16x32_bf16 v[188:191], a[132:135], a[36:39], v[188:191]
    v_exp_f32 v183, v183
    v_mfma_f32_16x16x32_bf16 v[188:191], a[136:139], a[40:43], v[188:191]
    v_cvt_pk_bf16_f32 v211, v182, v183
    v_mfma_f32_16x16x32_bf16 v[188:191], a[140:143], a[44:47], v[188:191]
    v_mfma_f32_16x16x32_bf16 v[176:179], a[80:83], a[48:51], 0
    v_exp_f32 v184, v184
    v_mfma_f32_16x16x32_bf16 v[176:179], a[84:87], a[52:55], v[176:179]
    s_add_u32 s37, s37, 1
    s_and_b32 s40, s37, 3
    v_mfma_f32_16x16x32_bf16 v[176:179], a[88:91], a[56:59], v[176:179]
    v_exp_f32 v185, v185
    v_mfma_f32_16x16x32_bf16 v[176:179], a[92:95], a[60:63], v[176:179]
    s_cmp_eq_u32 s40, 0
    v_cvt_pk_bf16_f32 v212, v184, v185
    v_mfma_f32_16x16x32_bf16 v[144:147], a[144:147], v[224:227], v[144:147]
    v_exp_f32 v186, v186
    v_mfma_f32_16x16x32_bf16 v[148:151], a[148:151], v[224:227], v[148:151]
    s_cselect_b32 s36, 0xfffe7700, s100
    v_add_u32 v228, s36, v228
    v_mfma_f32_16x16x32_bf16 v[152:155], a[152:155], v[224:227], v[152:155]
    v_exp_f32 v187, v187
    v_mfma_f32_16x16x32_bf16 v[156:159], a[156:159], v[224:227], v[156:159]
    v_add_u32 v229, s36, v229
    v_cvt_pk_bf16_f32 v213, v186, v187
    v_mfma_f32_16x16x32_bf16 v[160:163], a[160:163], v[224:227], v[160:163]
    v_exp_f32 v188, v188
    v_mfma_f32_16x16x32_bf16 v[164:167], a[164:167], v[224:227], v[164:167]
    v_add_u32 v232, s36, v232
    v_add_u32 v230, s36, v230
    v_mfma_f32_16x16x32_bf16 v[168:171], a[168:171], v[224:227], v[168:171]
    v_exp_f32 v189, v189
    v_mfma_f32_16x16x32_bf16 v[172:175], a[172:175], v[224:227], v[172:175]
    v_add_u32 v231, s36, v231
    v_cvt_pk_bf16_f32 v214, v188, v189
    v_mfma_f32_16x16x32_bf16 a[224:227], a[228:231], v[224:227], a[224:227]
    v_exp_f32 v190, v190
    v_mfma_f32_16x16x32_bf16 v[180:183], a[96:99], a[48:51], 0
    v_add_u32 v233, s36, v233
    v_mfma_f32_16x16x32_bf16 v[180:183], a[100:103], a[52:55], v[180:183]
    v_exp_f32 v191, v191
    v_mfma_f32_16x16x32_bf16 v[180:183], a[104:107], a[56:59], v[180:183]
    v_cvt_pk_bf16_f32 v215, v190, v191
    v_mfma_f32_16x16x32_bf16 v[180:183], a[108:111], a[60:63], v[180:183]
    s_waitcnt vmcnt(9)
    s_barrier
    v_mfma_f32_16x16x32_bf16 v[184:187], a[112:115], a[48:51], 0
    v_exp_f32 v176, v176
    v_mfma_f32_16x16x32_bf16 v[184:187], a[116:119], a[52:55], v[184:187]
    ds_read_b128 a[80:83], v228 offset:0
    ds_read_b128 a[84:87], v228 offset:64
    v_mfma_f32_16x16x32_bf16 v[184:187], a[120:123], a[56:59], v[184:187]
    v_exp_f32 v177, v177
    v_mfma_f32_16x16x32_bf16 v[184:187], a[124:127], a[60:63], v[184:187]
    ds_read_b128 a[88:91], v229 offset:0
    v_cvt_pk_bf16_f32 v216, v176, v177
    v_mfma_f32_16x16x32_bf16 v[80:83], a[144:147], v[208:211], v[80:83]
    v_exp_f32 v178, v178
    v_mfma_f32_16x16x32_bf16 v[80:83], a[176:179], v[212:215], v[80:83]
    ds_read_b128 a[92:95], v229 offset:64
    ds_read_b128 a[96:99], v228 offset:256
    v_mfma_f32_16x16x32_bf16 v[84:87], a[180:183], v[212:215], v[84:87]
    v_exp_f32 v179, v179
    v_mfma_f32_16x16x32_bf16 v[84:87], a[148:151], v[208:211], v[84:87]
    ds_read_b128 a[100:103], v228 offset:320
    v_cvt_pk_bf16_f32 v217, v178, v179
    v_mfma_f32_16x16x32_bf16 v[88:91], a[152:155], v[208:211], v[88:91]
    v_exp_f32 v180, v180
    v_mfma_f32_16x16x32_bf16 v[88:91], a[184:187], v[212:215], v[88:91]
    ds_read_b128 a[104:107], v229 offset:256
    ds_read_b128 a[108:111], v229 offset:320
    v_mfma_f32_16x16x32_bf16 v[92:95], a[188:191], v[212:215], v[92:95]
    v_exp_f32 v181, v181
    v_mfma_f32_16x16x32_bf16 v[92:95], a[156:159], v[208:211], v[92:95]
    v_cvt_pk_bf16_f32 v218, v180, v181
    v_mfma_f32_16x16x32_bf16 v[188:191], a[128:131], a[48:51], 0
    v_exp_f32 v182, v182
    v_mfma_f32_16x16x32_bf16 v[188:191], a[132:135], a[52:55], v[188:191]
    v_mfma_f32_16x16x32_bf16 v[188:191], a[136:139], a[56:59], v[188:191]
    v_exp_f32 v183, v183
    v_mfma_f32_16x16x32_bf16 v[188:191], a[140:143], a[60:63], v[188:191]
    v_cvt_pk_bf16_f32 v219, v182, v183
    s_waitcnt lgkmcnt(0)
L_loop:
    v_mfma_f32_16x16x32_bf16 v[176:179], a[80:83], a[0:3], 0
    v_exp_f32 v184, v184
    v_mfma_f32_16x16x32_bf16 v[176:179], a[84:87], a[4:7], v[176:179]
    ds_read_b128 a[112:115], v230 offset:0
    ds_read_b128 a[116:119], v230 offset:64
    v_mfma_f32_16x16x32_bf16 v[176:179], a[88:91], a[8:11], v[176:179]
    v_exp_f32 v185, v185
    v_mfma_f32_16x16x32_bf16 v[176:179], a[92:95], a[12:15], v[176:179]
    ds_read_b128 a[120:123], v231 offset:0
    v_cvt_pk_bf16_f32 v220, v184, v185
    v_mfma_f32_16x16x32_bf16 v[96:99], a[160:163], v[208:211], v[96:99]
    v_exp_f32 v186, v186
    v_mfma_f32_16x16x32_bf16 v[96:99], a[192:195], v[212:215], v[96:99]
    ds_read_b128 a[124:127], v231 offset:64
    ds_read_b128 a[128:131], v230 offset:256
    v_mfma_f32_16x16x32_bf16 v[100:103], a[196:199], v[212:215], v[100:103]
    v_exp_f32 v187, v187
    v_mfma_f32_16x16x32_bf16 v[100:103], a[164:167], v[208:211], v[100:103]
    ds_read_b128 a[132:135], v230 offset:320
    v_cvt_pk_bf16_f32 v221, v186, v187
    v_mfma_f32_16x16x32_bf16 v[104:107], a[168:171], v[208:211], v[104:107]
    v_exp_f32 v188, v188
    v_mfma_f32_16x16x32_bf16 v[104:107], a[200:203], v[212:215], v[104:107]
    ds_read_b128 a[136:139], v231 offset:256
    ds_read_b128 a[140:143], v231 offset:320
    v_mfma_f32_16x16x32_bf16 v[108:111], a[204:207], v[212:215], v[108:111]
    v_exp_f32 v189, v189
    v_mfma_f32_16x16x32_bf16 v[108:111], a[172:175], v[208:211], v[108:111]
    s_add_u32 m0, s33, 0
    v_cvt_pk_bf16_f32 v222, v188, v189
    v_smfmac_f32_16x16x64_bf16 a[216:219], a[228:231], v[208:215], v1
    v_exp_f32 v190, v190
    v_mfma_f32_16x16x32_bf16 v[180:183], a[96:99], a[0:3], 0
    buffer_load_dwordx4 v234, s[8:11], s35 offen offset:0 nt lds
    s_add_u32 m0, s33, 784
    v_mfma_f32_16x16x32_bf16 v[180:183], a[100:103], a[4:7], v[180:183]
    v_exp_f32 v191, v191
    v_mfma_f32_16x16x32_bf16 v[180:183], a[104:107], a[8:11], v[180:183]
    buffer_load_dwordx4 v234, s[8:11], s35 offen offset:256 nt lds
    v_cvt_pk_bf16_f32 v223, v190, v191
    v_mfma_f32_16x16x32_bf16 v[180:183], a[108:111], a[12:15], v[180:183]
    s_waitcnt lgkmcnt(0)
    v_mfma_f32_16x16x32_bf16 v[184:187], a[112:115], a[0:3], 0
    v_exp_f32 v176, v176
    v_mfma_f32_16x16x32_bf16 v[184:187], a[116:119], a[4:7], v[184:187]
    s_add_u32 m0, s33, 1568
    v_mfma_f32_16x16x32_bf16 v[184:187], a[120:123], a[8:11], v[184:187]
    v_exp_f32 v177, v177
    v_mfma_f32_16x16x32_bf16 v[184:187], a[124:127], a[12:15], v[184:187]
    buffer_load_dwordx4 v234, s[8:11], s35 offen offset:512 nt lds
    v_cvt_pk_bf16_f32 v192, v176, v177
    v_mfma_f32_16x16x32_bf16 v[112:115], a[144:147], v[216:219], v[112:115]
    v_exp_f32 v178, v178
    v_mfma_f32_16x16x32_bf16 v[112:115], a[176:179], v[220:223], v[112:115]
    ds_read_b64_tr_b16 a[144:145], v232 offset:0
    ds_read_b64_tr_b16 a[146:147], v232 offset:512
    v_mfma_f32_16x16x32_bf16 v[116:119], a[180:183], v[220:223], v[116:119]
    v_exp_f32 v179, v179
    v_mfma_f32_16x16x32_bf16 v[116:119], a[148:151], v[216:219], v[116:119]
    ds_read_b64_tr_b16 a[176:177], v233 offset:0
    v_cvt_pk_bf16_f32 v193, v178, v179
    v_mfma_f32_16x16x32_bf16 v[120:123], a[152:155], v[216:219], v[120:123]
    v_exp_f32 v180, v180
    v_mfma_f32_16x16x32_bf16 v[120:123], a[184:187], v[220:223], v[120:123]
    ds_read_b64_tr_b16 a[178:179], v233 offset:512
    ds_read_b64_tr_b16 a[148:149], v232 offset:32
    v_mfma_f32_16x16x32_bf16 v[124:127], a[188:191], v[220:223], v[124:127]
    v_exp_f32 v181, v181
    v_mfma_f32_16x16x32_bf16 v[124:127], a[156:159], v[216:219], v[124:127]
    ds_read_b64_tr_b16 a[150:151], v232 offset:544
    v_cvt_pk_bf16_f32 v194, v180, v181
    v_mfma_f32_16x16x32_bf16 v[188:191], a[128:131], a[0:3], 0
    v_exp_f32 v182, v182
    v_mfma_f32_16x16x32_bf16 v[188:191], a[132:135], a[4:7], v[188:191]
    ds_read_b64_tr_b16 a[180:181], v233 offset:32
    ds_read_b64_tr_b16 a[182:183], v233 offset:544
    v_mfma_f32_16x16x32_bf16 v[188:191], a[136:139], a[8:11], v[188:191]
    v_exp_f32 v183, v183
    v_mfma_f32_16x16x32_bf16 v[188:191], a[140:143], a[12:15], v[188:191]
    ds_read_b64_tr_b16 a[152:153], v232 offset:64
    v_cvt_pk_bf16_f32 v195, v182, v183
    v_mfma_f32_16x16x32_bf16 v[176:179], a[80:83], a[16:19], 0
    v_exp_f32 v184, v184
    v_mfma_f32_16x16x32_bf16 v[176:179], a[84:87], a[20:23], v[176:179]
    ds_read_b64_tr_b16 a[154:155], v232 offset:576
    ds_read_b64_tr_b16 a[184:185], v233 offset:64
    v_mfma_f32_16x16x32_bf16 v[176:179], a[88:91], a[24:27], v[176:179]
    v_exp_f32 v185, v185
    v_mfma_f32_16x16x32_bf16 v[176:179], a[92:95], a[28:31], v[176:179]
    ds_read_b64_tr_b16 a[186:187], v233 offset:576
    v_cvt_pk_bf16_f32 v196, v184, v185
    v_mfma_f32_16x16x32_bf16 v[128:131], a[160:163], v[216:219], v[128:131]
    v_exp_f32 v186, v186
    v_mfma_f32_16x16x32_bf16 v[128:131], a[192:195], v[220:223], v[128:131]
    ds_read_b64_tr_b16 a[156:157], v232 offset:96
    ds_read_b64_tr_b16 a[158:159], v232 offset:608
    v_mfma_f32_16x16x32_bf16 v[132:135], a[196:199], v[220:223], v[132:135]
    v_exp_f32 v187, v187
    v_mfma_f32_16x16x32_bf16 v[132:135], a[164:167], v[216:219], v[132:135]
    ds_read_b64_tr_b16 a[188:189], v233 offset:96
    v_cvt_pk_bf16_f32 v197, v186, v187
    v_mfma_f32_16x16x32_bf16 v[136:139], a[168:171], v[216:219], v[136:139]
    v_exp_f32 v188, v188
    v_mfma_f32_16x16x32_bf16 v[136:139], a[200:203], v[220:223], v[136:139]
    ds_read_b64_tr_b16 a[190:191], v233 offset:608
    ds_read_b64_tr_b16 a[160:161], v232 offset:128
    v_mfma_f32_16x16x32_bf16 v[140:143], a[204:207], v[220:223], v[140:143]
    v_exp_f32 v189, v189
    v_mfma_f32_16x16x32_bf16 v[140:143], a[172:175], v[216:219], v[140:143]
    ds_read_b64_tr_b16 a[162:163], v232 offset:640
    v_cvt_pk_bf16_f32 v198, v188, v189
    v_smfmac_f32_16x16x64_bf16 a[220:223], a[228:231], v[216:223], v1
    v_exp_f32 v190, v190
    v_mfma_f32_16x16x32_bf16 v[180:183], a[96:99], a[16:19], 0
    ds_read_b64_tr_b16 a[192:193], v233 offset:128
    ds_read_b64_tr_b16 a[194:195], v233 offset:640
    v_mfma_f32_16x16x32_bf16 v[180:183], a[100:103], a[20:23], v[180:183]
    v_exp_f32 v191, v191
    v_mfma_f32_16x16x32_bf16 v[180:183], a[104:107], a[24:27], v[180:183]
    ds_read_b64_tr_b16 a[164:165], v232 offset:160
    v_cvt_pk_bf16_f32 v199, v190, v191
    v_mfma_f32_16x16x32_bf16 v[180:183], a[108:111], a[28:31], v[180:183]
    ds_read_b64_tr_b16 a[166:167], v232 offset:672
    ds_read_b64_tr_b16 a[196:197], v233 offset:160
    v_mfma_f32_16x16x32_bf16 v[184:187], a[112:115], a[16:19], 0
    v_exp_f32 v176, v176
    v_mfma_f32_16x16x32_bf16 v[184:187], a[116:119], a[20:23], v[184:187]
    ds_read_b64_tr_b16 a[198:199], v233 offset:672
    ds_read_b64_tr_b16 a[168:169], v232 offset:192
    v_mfma_f32_16x16x32_bf16 v[184:187], a[120:123], a[24:27], v[184:187]
    v_exp_f32 v177, v177
    v_mfma_f32_16x16x32_bf16 v[184:187], a[124:127], a[28:31], v[184:187]
    s_waitcnt lgkmcnt(9)
    v_cvt_pk_bf16_f32 v200, v176, v177
    v_mfma_f32_16x16x32_bf16 v[16:19], a[144:147], v[192:195], v[16:19]
    v_exp_f32 v178, v178
    v_mfma_f32_16x16x32_bf16 v[16:19], a[176:179], v[196:199], v[16:19]
    ds_read_b64_tr_b16 a[170:171], v232 offset:704
    ds_read_b64_tr_b16 a[200:201], v233 offset:192
    v_mfma_f32_16x16x32_bf16 v[20:23], a[180:183], v[196:199], v[20:23]
    v_exp_f32 v179, v179
    v_mfma_f32_16x16x32_bf16 v[20:23], a[148:151], v[192:195], v[20:23]
    ds_read_b64_tr_b16 a[202:203], v233 offset:704
    v_cvt_pk_bf16_f32 v201, v178, v179
    v_mfma_f32_16x16x32_bf16 v[24:27], a[152:155], v[192:195], v[24:27]
    v_exp_f32 v180, v180
    v_mfma_f32_16x16x32_bf16 v[24:27], a[184:187], v[196:199], v[24:27]
    ds_read_b64_tr_b16 a[172:173], v232 offset:224
    ds_read_b64_tr_b16 a[174:175], v232 offset:736
    v_mfma_f32_16x16x32_bf16 v[28:31], a[188:191], v[196:199], v[28:31]
    v_exp_f32 v181, v181
    v_mfma_f32_16x16x32_bf16 v[28:31], a[156:159], v[192:195], v[28:31]
    ds_read_b64_tr_b16 a[204:205], v233 offset:224
    v_cvt_pk_bf16_f32 v202, v180, v181
    v_mfma_f32_16x16x32_bf16 v[188:191], a[128:131], a[16:19], 0
    v_exp_f32 v182, v182
    v_mfma_f32_16x16x32_bf16 v[188:191], a[132:135], a[20:23], v[188:191]
    ds_read_b64_tr_b16 a[206:207], v233 offset:736
    v_mfma_f32_16x16x32_bf16 v[188:191], a[136:139], a[24:27], v[188:191]
    v_exp_f32 v183, v183
    v_mfma_f32_16x16x32_bf16 v[188:191], a[140:143], a[28:31], v[188:191]
    v_cvt_pk_bf16_f32 v203, v182, v183
    v_mfma_f32_16x16x32_bf16 v[176:179], a[80:83], a[64:67], 0
    v_exp_f32 v184, v184
    v_mfma_f32_16x16x32_bf16 v[176:179], a[84:87], a[68:71], v[176:179]
    s_add_u32 m0, s33, 2352
    v_mfma_f32_16x16x32_bf16 v[176:179], a[88:91], a[72:75], v[176:179]
    v_exp_f32 v185, v185
    v_mfma_f32_16x16x32_bf16 v[176:179], a[92:95], a[76:79], v[176:179]
    s_waitcnt lgkmcnt(0)
    v_cvt_pk_bf16_f32 v204, v184, v185
    v_mfma_f32_16x16x32_bf16 v[32:35], a[160:163], v[192:195], v[32:35]
    v_exp_f32 v186, v186
    v_mfma_f32_16x16x32_bf16 v[32:35], a[192:195], v[196:199], v[32:35]
    buffer_load_dwordx4 v234, s[8:11], s35 offen offset:768 nt lds
    s_add_u32 m0, s34, 0
    v_mfma_f32_16x16x32_bf16 v[36:39], a[196:199], v[196:199], v[36:39]
    v_exp_f32 v187, v187
    v_mfma_f32_16x16x32_bf16 v[36:39], a[164:167], v[192:195], v[36:39]
    v_cvt_pk_bf16_f32 v205, v186, v187
    v_mfma_f32_16x16x32_bf16 v[40:43], a[168:171], v[192:195], v[40:43]
    v_exp_f32 v188, v188
    v_mfma_f32_16x16x32_bf16 v[40:43], a[200:203], v[196:199], v[40:43]
    buffer_load_dwordx4 v235, s[12:15], s35 offen offset:0 nt lds
    v_mfma_f32_16x16x32_bf16 v[44:47], a[204:207], v[196:199], v[44:47]
    v_exp_f32 v189, v189
    v_mfma_f32_16x16x32_bf16 v[44:47], a[172:175], v[192:195], v[44:47]
    v_cvt_pk_bf16_f32 v206, v188, v189
    v_smfmac_f32_16x16x64_bf16 a[208:211], a[228:231], v[192:199], v1
    v_exp_f32 v190, v190
    v_mfma_f32_16x16x32_bf16 v[180:183], a[96:99], a[64:67], 0
    v_mfma_f32_16x16x32_bf16 v[180:183], a[100:103], a[68:71], v[180:183]
    v_exp_f32 v191, v191
    v_mfma_f32_16x16x32_bf16 v[180:183], a[104:107], a[72:75], v[180:183]
    v_cvt_pk_bf16_f32 v207, v190, v191
    v_mfma_f32_16x16x32_bf16 v[180:183], a[108:111], a[76:79], v[180:183]
    v_mfma_f32_16x16x32_bf16 v[184:187], a[80:83], a[32:35], 0
    v_exp_f32 v176, v176
    v_mfma_f32_16x16x32_bf16 v[184:187], a[84:87], a[36:39], v[184:187]
    s_add_u32 m0, s34, 800
    v_mfma_f32_16x16x32_bf16 v[184:187], a[88:91], a[40:43], v[184:187]
    v_exp_f32 v177, v177
    v_mfma_f32_16x16x32_bf16 v[184:187], a[92:95], a[44:47], v[184:187]
    v_cvt_pk_bf16_f32 v224, v176, v177
    v_mfma_f32_16x16x32_bf16 v[48:51], a[144:147], v[200:203], v[48:51]
    v_exp_f32 v178, v178
    v_mfma_f32_16x16x32_bf16 v[48:51], a[176:179], v[204:207], v[48:51]
    buffer_load_dwordx4 v235, s[12:15], s35 offen offset:256 nt lds
    s_add_u32 m0, s34, 1600
    v_mfma_f32_16x16x32_bf16 v[52:55], a[180:183], v[204:207], v[52:55]
    v_exp_f32 v179, v179
    v_mfma_f32_16x16x32_bf16 v[52:55], a[148:151], v[200:203], v[52:55]
    v_cvt_pk_bf16_f32 v225, v178, v179
    v_mfma_f32_16x16x32_bf16 v[56:59], a[152:155], v[200:203], v[56:59]
    v_exp_f32 v180, v180
    v_mfma_f32_16x16x32_bf16 v[56:59], a[184:187], v[204:207], v[56:59]
    buffer_load_dwordx4 v235, s[12:15], s35 offen offset:512 nt lds
    v_mfma_f32_16x16x32_bf16 v[60:63], a[188:191], v[204:207], v[60:63]
    v_exp_f32 v181, v181
    v_mfma_f32_16x16x32_bf16 v[60:63], a[156:159], v[200:203], v[60:63]
    v_cvt_pk_bf16_f32 v226, v180, v181
    v_mfma_f32_16x16x32_bf16 v[188:191], a[96:99], a[32:35], 0
    v_exp_f32 v182, v182
    v_mfma_f32_16x16x32_bf16 v[188:191], a[100:103], a[36:39], v[188:191]
    v_mfma_f32_16x16x32_bf16 v[188:191], a[104:107], a[40:43], v[188:191]
    v_exp_f32 v183, v183
    v_mfma_f32_16x16x32_bf16 v[188:191], a[108:111], a[44:47], v[188:191]
    v_cvt_pk_bf16_f32 v227, v182, v183
    v_mfma_f32_16x16x32_bf16 v[176:179], a[112:115], a[32:35], 0
    v_exp_f32 v184, v184
    v_mfma_f32_16x16x32_bf16 v[176:179], a[116:119], a[36:39], v[176:179]
    s_add_u32 m0, s34, 2400
    v_mfma_f32_16x16x32_bf16 v[176:179], a[120:123], a[40:43], v[176:179]
    v_exp_f32 v185, v185
    v_mfma_f32_16x16x32_bf16 v[176:179], a[124:127], a[44:47], v[176:179]
    buffer_load_dwordx4 v235, s[12:15], s35 offen offset:768 nt lds
    v_cvt_pk_bf16_f32 v208, v184, v185
    v_mfma_f32_16x16x32_bf16 v[64:67], a[160:163], v[200:203], v[64:67]
    v_exp_f32 v186, v186
    v_mfma_f32_16x16x32_bf16 v[64:67], a[192:195], v[204:207], v[64:67]
    s_and_b32 s40, s37, 3
    s_cmp_eq_u32 s40, 1
    v_mfma_f32_16x16x32_bf16 v[68:71], a[196:199], v[204:207], v[68:71]
    v_exp_f32 v187, v187
    v_mfma_f32_16x16x32_bf16 v[68:71], a[164:167], v[200:203], v[68:71]
    s_cselect_b32 s36, 0xfffe7700, s100
    v_cvt_pk_bf16_f32 v209, v186, v187
    v_mfma_f32_16x16x32_bf16 v[72:75], a[168:171], v[200:203], v[72:75]
    v_exp_f32 v188, v188
    v_mfma_f32_16x16x32_bf16 v[72:75], a[200:203], v[204:207], v[72:75]
    s_add_u32 s33, s33, s36
    s_add_u32 s34, s34, s36
    v_mfma_f32_16x16x32_bf16 v[76:79], a[204:207], v[204:207], v[76:79]
    v_exp_f32 v189, v189
    v_mfma_f32_16x16x32_bf16 v[76:79], a[172:175], v[200:203], v[76:79]
    s_add_u32 s35, s35, 16384
    v_cvt_pk_bf16_f32 v210, v188, v189
    v_smfmac_f32_16x16x64_bf16 a[212:215], a[228:231], v[200:207], v1
    v_exp_f32 v190, v190
    v_mfma_f32_16x16x32_bf16 v[180:183], a[128:131], a[32:35], 0
    v_mfma_f32_16x16x32_bf16 v[180:183], a[132:135], a[36:39], v[180:183]
    v_exp_f32 v191, v191
    v_mfma_f32_16x16x32_bf16 v[180:183], a[136:139], a[40:43], v[180:183]
    v_cvt_pk_bf16_f32 v211, v190, v191
    v_mfma_f32_16x16x32_bf16 v[180:183], a[140:143], a[44:47], v[180:183]
    v_mfma_f32_16x16x32_bf16 v[184:187], a[80:83], a[48:51], 0
    v_exp_f32 v176, v176
    v_mfma_f32_16x16x32_bf16 v[184:187], a[84:87], a[52:55], v[184:187]
    s_add_u32 s37, s37, 1
    s_and_b32 s40, s37, 3
    v_mfma_f32_16x16x32_bf16 v[184:187], a[88:91], a[56:59], v[184:187]
    v_exp_f32 v177, v177
    v_mfma_f32_16x16x32_bf16 v[184:187], a[92:95], a[60:63], v[184:187]
    s_cmp_eq_u32 s40, 0
    v_cvt_pk_bf16_f32 v212, v176, v177
    v_mfma_f32_16x16x32_bf16 v[144:147], a[144:147], v[224:227], v[144:147]
    v_exp_f32 v178, v178
    v_mfma_f32_16x16x32_bf16 v[148:151], a[148:151], v[224:227], v[148:151]
    s_cselect_b32 s36, 0xfffe7700, s100
    v_add_u32 v228, s36, v228
    v_mfma_f32_16x16x32_bf16 v[152:155], a[152:155], v[224:227], v[152:155]
    v_exp_f32 v179, v179
    v_mfma_f32_16x16x32_bf16 v[156:159], a[156:159], v[224:227], v[156:159]
    v_add_u32 v229, s36, v229
    v_cvt_pk_bf16_f32 v213, v178, v179
    v_mfma_f32_16x16x32_bf16 v[160:163], a[160:163], v[224:227], v[160:163]
    v_exp_f32 v180, v180
    v_mfma_f32_16x16x32_bf16 v[164:167], a[164:167], v[224:227], v[164:167]
    v_add_u32 v232, s36, v232
    v_add_u32 v230, s36, v230
    v_mfma_f32_16x16x32_bf16 v[168:171], a[168:171], v[224:227], v[168:171]
    v_exp_f32 v181, v181
    v_mfma_f32_16x16x32_bf16 v[172:175], a[172:175], v[224:227], v[172:175]
    v_add_u32 v231, s36, v231
    v_cvt_pk_bf16_f32 v214, v180, v181
    v_mfma_f32_16x16x32_bf16 a[224:227], a[228:231], v[224:227], a[224:227]
    v_exp_f32 v182, v182
    v_mfma_f32_16x16x32_bf16 v[188:191], a[96:99], a[48:51], 0
    v_add_u32 v233, s36, v233
    v_mfma_f32_16x16x32_bf16 v[188:191], a[100:103], a[52:55], v[188:191]
    v_exp_f32 v183, v183
    v_mfma_f32_16x16x32_bf16 v[188:191], a[104:107], a[56:59], v[188:191]
    v_cvt_pk_bf16_f32 v215, v182, v183
    v_mfma_f32_16x16x32_bf16 v[188:191], a[108:111], a[60:63], v[188:191]
    s_waitcnt vmcnt(8)
    s_barrier
    v_mfma_f32_16x16x32_bf16 v[176:179], a[112:115], a[48:51], 0
    v_exp_f32 v184, v184
    v_mfma_f32_16x16x32_bf16 v[176:179], a[116:119], a[52:55], v[176:179]
    ds_read_b128 a[80:83], v228 offset:0
    ds_read_b128 a[84:87], v228 offset:64
    v_mfma_f32_16x16x32_bf16 v[176:179], a[120:123], a[56:59], v[176:179]
    v_exp_f32 v185, v185
    v_mfma_f32_16x16x32_bf16 v[176:179], a[124:127], a[60:63], v[176:179]
    ds_read_b128 a[88:91], v229 offset:0
    v_cvt_pk_bf16_f32 v216, v184, v185
    v_mfma_f32_16x16x32_bf16 v[80:83], a[144:147], v[208:211], v[80:83]
    v_exp_f32 v186, v186
    v_mfma_f32_16x16x32_bf16 v[80:83], a[176:179], v[212:215], v[80:83]
    ds_read_b128 a[92:95], v229 offset:64
    ds_read_b128 a[96:99], v228 offset:256
    v_mfma_f32_16x16x32_bf16 v[84:87], a[180:183], v[212:215], v[84:87]
    v_exp_f32 v187, v187
    v_mfma_f32_16x16x32_bf16 v[84:87], a[148:151], v[208:211], v[84:87]
    ds_read_b128 a[100:103], v228 offset:320
    v_cvt_pk_bf16_f32 v217, v186, v187
    v_mfma_f32_16x16x32_bf16 v[88:91], a[152:155], v[208:211], v[88:91]
    v_exp_f32 v188, v188
    v_mfma_f32_16x16x32_bf16 v[88:91], a[184:187], v[212:215], v[88:91]
    ds_read_b128 a[104:107], v229 offset:256
    ds_read_b128 a[108:111], v229 offset:320
    v_mfma_f32_16x16x32_bf16 v[92:95], a[188:191], v[212:215], v[92:95]
    v_exp_f32 v189, v189
    v_mfma_f32_16x16x32_bf16 v[92:95], a[156:159], v[208:211], v[92:95]
    v_cvt_pk_bf16_f32 v218, v188, v189
    v_mfma_f32_16x16x32_bf16 v[180:183], a[128:131], a[48:51], 0
    v_exp_f32 v190, v190
    v_mfma_f32_16x16x32_bf16 v[180:183], a[132:135], a[52:55], v[180:183]
    v_mfma_f32_16x16x32_bf16 v[180:183], a[136:139], a[56:59], v[180:183]
    v_exp_f32 v191, v191
    v_mfma_f32_16x16x32_bf16 v[180:183], a[140:143], a[60:63], v[180:183]
    v_cvt_pk_bf16_f32 v219, v190, v191
    s_waitcnt lgkmcnt(0)
    v_mfma_f32_16x16x32_bf16 v[184:187], a[80:83], a[0:3], 0
    v_exp_f32 v176, v176
    v_mfma_f32_16x16x32_bf16 v[184:187], a[84:87], a[4:7], v[184:187]
    ds_read_b128 a[112:115], v230 offset:0
    ds_read_b128 a[116:119], v230 offset:64
    v_mfma_f32_16x16x32_bf16 v[184:187], a[88:91], a[8:11], v[184:187]
    v_exp_f32 v177, v177
    v_mfma_f32_16x16x32_bf16 v[184:187], a[92:95], a[12:15], v[184:187]
    ds_read_b128 a[120:123], v231 offset:0
    v_cvt_pk_bf16_f32 v220, v176, v177
    v_mfma_f32_16x16x32_bf16 v[96:99], a[160:163], v[208:211], v[96:99]
    v_exp_f32 v178, v178
    v_mfma_f32_16x16x32_bf16 v[96:99], a[192:195], v[212:215], v[96:99]
    ds_read_b128 a[124:127], v231 offset:64
    ds_read_b128 a[128:131], v230 offset:256
    v_mfma_f32_16x16x32_bf16 v[100:103], a[196:199], v[212:215], v[100:103]
    v_exp_f32 v179, v179
    v_mfma_f32_16x16x32_bf16 v[100:103], a[164:167], v[208:211], v[100:103]
    ds_read_b128 a[132:135], v230 offset:320
    v_cvt_pk_bf16_f32 v221, v178, v179
    v_mfma_f32_16x16x32_bf16 v[104:107], a[168:171], v[208:211], v[104:107]
    v_exp_f32 v180, v180
    v_mfma_f32_16x16x32_bf16 v[104:107], a[200:203], v[212:215], v[104:107]
    ds_read_b128 a[136:139], v231 offset:256
    ds_read_b128 a[140:143], v231 offset:320
    v_mfma_f32_16x16x32_bf16 v[108:111], a[204:207], v[212:215], v[108:111]
    v_exp_f32 v181, v181
    v_mfma_f32_16x16x32_bf16 v[108:111], a[172:175], v[208:211], v[108:111]
    s_add_u32 m0, s33, 0
    v_cvt_pk_bf16_f32 v222, v180, v181
    v_smfmac_f32_16x16x64_bf16 a[216:219], a[228:231], v[208:215], v1
    v_exp_f32 v182, v182
    v_mfma_f32_16x16x32_bf16 v[188:191], a[96:99], a[0:3], 0
    buffer_load_dwordx4 v234, s[8:11], s35 offen offset:0 nt lds
    s_add_u32 m0, s33, 784
    v_mfma_f32_16x16x32_bf16 v[188:191], a[100:103], a[4:7], v[188:191]
    v_exp_f32 v183, v183
    v_mfma_f32_16x16x32_bf16 v[188:191], a[104:107], a[8:11], v[188:191]
    buffer_load_dwordx4 v234, s[8:11], s35 offen offset:256 nt lds
    v_cvt_pk_bf16_f32 v223, v182, v183
    v_mfma_f32_16x16x32_bf16 v[188:191], a[108:111], a[12:15], v[188:191]
    s_waitcnt lgkmcnt(0)
    v_mfma_f32_16x16x32_bf16 v[176:179], a[112:115], a[0:3], 0
    v_exp_f32 v184, v184
    v_mfma_f32_16x16x32_bf16 v[176:179], a[116:119], a[4:7], v[176:179]
    s_add_u32 m0, s33, 1568
    v_mfma_f32_16x16x32_bf16 v[176:179], a[120:123], a[8:11], v[176:179]
    v_exp_f32 v185, v185
    v_mfma_f32_16x16x32_bf16 v[176:179], a[124:127], a[12:15], v[176:179]
    buffer_load_dwordx4 v234, s[8:11], s35 offen offset:512 nt lds
    v_cvt_pk_bf16_f32 v192, v184, v185
    v_mfma_f32_16x16x32_bf16 v[112:115], a[144:147], v[216:219], v[112:115]
    v_exp_f32 v186, v186
    v_mfma_f32_16x16x32_bf16 v[112:115], a[176:179], v[220:223], v[112:115]
    ds_read_b64_tr_b16 a[144:145], v232 offset:0
    ds_read_b64_tr_b16 a[146:147], v232 offset:512
    v_mfma_f32_16x16x32_bf16 v[116:119], a[180:183], v[220:223], v[116:119]
    v_exp_f32 v187, v187
    v_mfma_f32_16x16x32_bf16 v[116:119], a[148:151], v[216:219], v[116:119]
    ds_read_b64_tr_b16 a[176:177], v233 offset:0
    v_cvt_pk_bf16_f32 v193, v186, v187
    v_mfma_f32_16x16x32_bf16 v[120:123], a[152:155], v[216:219], v[120:123]
    v_exp_f32 v188, v188
    v_mfma_f32_16x16x32_bf16 v[120:123], a[184:187], v[220:223], v[120:123]
    ds_read_b64_tr_b16 a[178:179], v233 offset:512
    ds_read_b64_tr_b16 a[148:149], v232 offset:32
    v_mfma_f32_16x16x32_bf16 v[124:127], a[188:191], v[220:223], v[124:127]
    v_exp_f32 v189, v189
    v_mfma_f32_16x16x32_bf16 v[124:127], a[156:159], v[216:219], v[124:127]
    ds_read_b64_tr_b16 a[150:151], v232 offset:544
    v_cvt_pk_bf16_f32 v194, v188, v189
    v_mfma_f32_16x16x32_bf16 v[180:183], a[128:131], a[0:3], 0
    v_exp_f32 v190, v190
    v_mfma_f32_16x16x32_bf16 v[180:183], a[132:135], a[4:7], v[180:183]
    ds_read_b64_tr_b16 a[180:181], v233 offset:32
    ds_read_b64_tr_b16 a[182:183], v233 offset:544
    v_mfma_f32_16x16x32_bf16 v[180:183], a[136:139], a[8:11], v[180:183]
    v_exp_f32 v191, v191
    v_mfma_f32_16x16x32_bf16 v[180:183], a[140:143], a[12:15], v[180:183]
    ds_read_b64_tr_b16 a[152:153], v232 offset:64
    v_cvt_pk_bf16_f32 v195, v190, v191
    v_mfma_f32_16x16x32_bf16 v[184:187], a[80:83], a[16:19], 0
    v_exp_f32 v176, v176
    v_mfma_f32_16x16x32_bf16 v[184:187], a[84:87], a[20:23], v[184:187]
    ds_read_b64_tr_b16 a[154:155], v232 offset:576
    ds_read_b64_tr_b16 a[184:185], v233 offset:64
    v_mfma_f32_16x16x32_bf16 v[184:187], a[88:91], a[24:27], v[184:187]
    v_exp_f32 v177, v177
    v_mfma_f32_16x16x32_bf16 v[184:187], a[92:95], a[28:31], v[184:187]
    ds_read_b64_tr_b16 a[186:187], v233 offset:576
    v_cvt_pk_bf16_f32 v196, v176, v177
    v_mfma_f32_16x16x32_bf16 v[128:131], a[160:163], v[216:219], v[128:131]
    v_exp_f32 v178, v178
    v_mfma_f32_16x16x32_bf16 v[128:131], a[192:195], v[220:223], v[128:131]
    ds_read_b64_tr_b16 a[156:157], v232 offset:96
    ds_read_b64_tr_b16 a[158:159], v232 offset:608
    v_mfma_f32_16x16x32_bf16 v[132:135], a[196:199], v[220:223], v[132:135]
    v_exp_f32 v179, v179
    v_mfma_f32_16x16x32_bf16 v[132:135], a[164:167], v[216:219], v[132:135]
    ds_read_b64_tr_b16 a[188:189], v233 offset:96
    v_cvt_pk_bf16_f32 v197, v178, v179
    v_mfma_f32_16x16x32_bf16 v[136:139], a[168:171], v[216:219], v[136:139]
    v_exp_f32 v180, v180
    v_mfma_f32_16x16x32_bf16 v[136:139], a[200:203], v[220:223], v[136:139]
    ds_read_b64_tr_b16 a[190:191], v233 offset:608
    ds_read_b64_tr_b16 a[160:161], v232 offset:128
    v_mfma_f32_16x16x32_bf16 v[140:143], a[204:207], v[220:223], v[140:143]
    v_exp_f32 v181, v181
    v_mfma_f32_16x16x32_bf16 v[140:143], a[172:175], v[216:219], v[140:143]
    ds_read_b64_tr_b16 a[162:163], v232 offset:640
    v_cvt_pk_bf16_f32 v198, v180, v181
    v_smfmac_f32_16x16x64_bf16 a[220:223], a[228:231], v[216:223], v1
    v_exp_f32 v182, v182
    v_mfma_f32_16x16x32_bf16 v[188:191], a[96:99], a[16:19], 0
    ds_read_b64_tr_b16 a[192:193], v233 offset:128
    ds_read_b64_tr_b16 a[194:195], v233 offset:640
    v_mfma_f32_16x16x32_bf16 v[188:191], a[100:103], a[20:23], v[188:191]
    v_exp_f32 v183, v183
    v_mfma_f32_16x16x32_bf16 v[188:191], a[104:107], a[24:27], v[188:191]
    ds_read_b64_tr_b16 a[164:165], v232 offset:160
    v_cvt_pk_bf16_f32 v199, v182, v183
    v_mfma_f32_16x16x32_bf16 v[188:191], a[108:111], a[28:31], v[188:191]
    ds_read_b64_tr_b16 a[166:167], v232 offset:672
    ds_read_b64_tr_b16 a[196:197], v233 offset:160
    v_mfma_f32_16x16x32_bf16 v[176:179], a[112:115], a[16:19], 0
    v_exp_f32 v184, v184
    v_mfma_f32_16x16x32_bf16 v[176:179], a[116:119], a[20:23], v[176:179]
    ds_read_b64_tr_b16 a[198:199], v233 offset:672
    ds_read_b64_tr_b16 a[168:169], v232 offset:192
    v_mfma_f32_16x16x32_bf16 v[176:179], a[120:123], a[24:27], v[176:179]
    v_exp_f32 v185, v185
    v_mfma_f32_16x16x32_bf16 v[176:179], a[124:127], a[28:31], v[176:179]
    s_waitcnt lgkmcnt(9)
    v_cvt_pk_bf16_f32 v200, v184, v185
    v_mfma_f32_16x16x32_bf16 v[16:19], a[144:147], v[192:195], v[16:19]
    v_exp_f32 v186, v186
    v_mfma_f32_16x16x32_bf16 v[16:19], a[176:179], v[196:199], v[16:19]
    ds_read_b64_tr_b16 a[170:171], v232 offset:704
    ds_read_b64_tr_b16 a[200:201], v233 offset:192
    v_mfma_f32_16x16x32_bf16 v[20:23], a[180:183], v[196:199], v[20:23]
    v_exp_f32 v187, v187
    v_mfma_f32_16x16x32_bf16 v[20:23], a[148:151], v[192:195], v[20:23]
    ds_read_b64_tr_b16 a[202:203], v233 offset:704
    v_cvt_pk_bf16_f32 v201, v186, v187
    v_mfma_f32_16x16x32_bf16 v[24:27], a[152:155], v[192:195], v[24:27]
    v_exp_f32 v188, v188
    v_mfma_f32_16x16x32_bf16 v[24:27], a[184:187], v[196:199], v[24:27]
    ds_read_b64_tr_b16 a[172:173], v232 offset:224
    ds_read_b64_tr_b16 a[174:175], v232 offset:736
    v_mfma_f32_16x16x32_bf16 v[28:31], a[188:191], v[196:199], v[28:31]
    v_exp_f32 v189, v189
    v_mfma_f32_16x16x32_bf16 v[28:31], a[156:159], v[192:195], v[28:31]
    ds_read_b64_tr_b16 a[204:205], v233 offset:224
    v_cvt_pk_bf16_f32 v202, v188, v189
    v_mfma_f32_16x16x32_bf16 v[180:183], a[128:131], a[16:19], 0
    v_exp_f32 v190, v190
    v_mfma_f32_16x16x32_bf16 v[180:183], a[132:135], a[20:23], v[180:183]
    ds_read_b64_tr_b16 a[206:207], v233 offset:736
    v_mfma_f32_16x16x32_bf16 v[180:183], a[136:139], a[24:27], v[180:183]
    v_exp_f32 v191, v191
    v_mfma_f32_16x16x32_bf16 v[180:183], a[140:143], a[28:31], v[180:183]
    v_cvt_pk_bf16_f32 v203, v190, v191
    v_mfma_f32_16x16x32_bf16 v[184:187], a[80:83], a[64:67], 0
    v_exp_f32 v176, v176
    v_mfma_f32_16x16x32_bf16 v[184:187], a[84:87], a[68:71], v[184:187]
    s_add_u32 m0, s33, 2352
    v_mfma_f32_16x16x32_bf16 v[184:187], a[88:91], a[72:75], v[184:187]
    v_exp_f32 v177, v177
    v_mfma_f32_16x16x32_bf16 v[184:187], a[92:95], a[76:79], v[184:187]
    s_waitcnt lgkmcnt(0)
    v_cvt_pk_bf16_f32 v204, v176, v177
    v_mfma_f32_16x16x32_bf16 v[32:35], a[160:163], v[192:195], v[32:35]
    v_exp_f32 v178, v178
    v_mfma_f32_16x16x32_bf16 v[32:35], a[192:195], v[196:199], v[32:35]
    buffer_load_dwordx4 v234, s[8:11], s35 offen offset:768 nt lds
    s_add_u32 m0, s34, 0
    v_mfma_f32_16x16x32_bf16 v[36:39], a[196:199], v[196:199], v[36:39]
    v_exp_f32 v179, v179
    v_mfma_f32_16x16x32_bf16 v[36:39], a[164:167], v[192:195], v[36:39]
    v_cvt_pk_bf16_f32 v205, v178, v179
    v_mfma_f32_16x16x32_bf16 v[40:43], a[168:171], v[192:195], v[40:43]
    v_exp_f32 v180, v180
    v_mfma_f32_16x16x32_bf16 v[40:43], a[200:203], v[196:199], v[40:43]
    buffer_load_dwordx4 v235, s[12:15], s35 offen offset:0 nt lds
    v_mfma_f32_16x16x32_bf16 v[44:47], a[204:207], v[196:199], v[44:47]
    v_exp_f32 v181, v181
    v_mfma_f32_16x16x32_bf16 v[44:47], a[172:175], v[192:195], v[44:47]
    v_cvt_pk_bf16_f32 v206, v180, v181
    v_smfmac_f32_16x16x64_bf16 a[208:211], a[228:231], v[192:199], v1
    v_exp_f32 v182, v182
    v_mfma_f32_16x16x32_bf16 v[188:191], a[96:99], a[64:67], 0
    v_mfma_f32_16x16x32_bf16 v[188:191], a[100:103], a[68:71], v[188:191]
    v_exp_f32 v183, v183
    v_mfma_f32_16x16x32_bf16 v[188:191], a[104:107], a[72:75], v[188:191]
    v_cvt_pk_bf16_f32 v207, v182, v183
    v_mfma_f32_16x16x32_bf16 v[188:191], a[108:111], a[76:79], v[188:191]
    v_mfma_f32_16x16x32_bf16 v[176:179], a[80:83], a[32:35], 0
    v_exp_f32 v184, v184
    v_mfma_f32_16x16x32_bf16 v[176:179], a[84:87], a[36:39], v[176:179]
    s_add_u32 m0, s34, 800
    v_mfma_f32_16x16x32_bf16 v[176:179], a[88:91], a[40:43], v[176:179]
    v_exp_f32 v185, v185
    v_mfma_f32_16x16x32_bf16 v[176:179], a[92:95], a[44:47], v[176:179]
    v_cvt_pk_bf16_f32 v224, v184, v185
    v_mfma_f32_16x16x32_bf16 v[48:51], a[144:147], v[200:203], v[48:51]
    v_exp_f32 v186, v186
    v_mfma_f32_16x16x32_bf16 v[48:51], a[176:179], v[204:207], v[48:51]
    buffer_load_dwordx4 v235, s[12:15], s35 offen offset:256 nt lds
    s_add_u32 m0, s34, 1600
    v_mfma_f32_16x16x32_bf16 v[52:55], a[180:183], v[204:207], v[52:55]
    v_exp_f32 v187, v187
    v_mfma_f32_16x16x32_bf16 v[52:55], a[148:151], v[200:203], v[52:55]
    v_cvt_pk_bf16_f32 v225, v186, v187
    v_mfma_f32_16x16x32_bf16 v[56:59], a[152:155], v[200:203], v[56:59]
    v_exp_f32 v188, v188
    v_mfma_f32_16x16x32_bf16 v[56:59], a[184:187], v[204:207], v[56:59]
    buffer_load_dwordx4 v235, s[12:15], s35 offen offset:512 nt lds
    v_mfma_f32_16x16x32_bf16 v[60:63], a[188:191], v[204:207], v[60:63]
    v_exp_f32 v189, v189
    v_mfma_f32_16x16x32_bf16 v[60:63], a[156:159], v[200:203], v[60:63]
    v_cvt_pk_bf16_f32 v226, v188, v189
    v_mfma_f32_16x16x32_bf16 v[180:183], a[96:99], a[32:35], 0
    v_exp_f32 v190, v190
    v_mfma_f32_16x16x32_bf16 v[180:183], a[100:103], a[36:39], v[180:183]
    v_mfma_f32_16x16x32_bf16 v[180:183], a[104:107], a[40:43], v[180:183]
    v_exp_f32 v191, v191
    v_mfma_f32_16x16x32_bf16 v[180:183], a[108:111], a[44:47], v[180:183]
    v_cvt_pk_bf16_f32 v227, v190, v191
    v_mfma_f32_16x16x32_bf16 v[184:187], a[112:115], a[32:35], 0
    v_exp_f32 v176, v176
    v_mfma_f32_16x16x32_bf16 v[184:187], a[116:119], a[36:39], v[184:187]
    s_add_u32 m0, s34, 2400
    v_mfma_f32_16x16x32_bf16 v[184:187], a[120:123], a[40:43], v[184:187]
    v_exp_f32 v177, v177
    v_mfma_f32_16x16x32_bf16 v[184:187], a[124:127], a[44:47], v[184:187]
    buffer_load_dwordx4 v235, s[12:15], s35 offen offset:768 nt lds
    v_cvt_pk_bf16_f32 v208, v176, v177
    v_mfma_f32_16x16x32_bf16 v[64:67], a[160:163], v[200:203], v[64:67]
    v_exp_f32 v178, v178
    v_mfma_f32_16x16x32_bf16 v[64:67], a[192:195], v[204:207], v[64:67]
    s_and_b32 s40, s37, 3
    s_cmp_eq_u32 s40, 1
    v_mfma_f32_16x16x32_bf16 v[68:71], a[196:199], v[204:207], v[68:71]
    v_exp_f32 v179, v179
    v_mfma_f32_16x16x32_bf16 v[68:71], a[164:167], v[200:203], v[68:71]
    s_cselect_b32 s36, 0xfffe7700, s100
    v_cvt_pk_bf16_f32 v209, v178, v179
    v_mfma_f32_16x16x32_bf16 v[72:75], a[168:171], v[200:203], v[72:75]
    v_exp_f32 v180, v180
    v_mfma_f32_16x16x32_bf16 v[72:75], a[200:203], v[204:207], v[72:75]
    s_add_u32 s33, s33, s36
    s_add_u32 s34, s34, s36
    v_mfma_f32_16x16x32_bf16 v[76:79], a[204:207], v[204:207], v[76:79]
    v_exp_f32 v181, v181
    v_mfma_f32_16x16x32_bf16 v[76:79], a[172:175], v[200:203], v[76:79]
    s_add_u32 s35, s35, 16384
    v_cvt_pk_bf16_f32 v210, v180, v181
    v_smfmac_f32_16x16x64_bf16 a[212:215], a[228:231], v[200:207], v1
    v_exp_f32 v182, v182
    v_mfma_f32_16x16x32_bf16 v[188:191], a[128:131], a[32:35], 0
    v_mfma_f32_16x16x32_bf16 v[188:191], a[132:135], a[36:39], v[188:191]
    v_exp_f32 v183, v183
    v_mfma_f32_16x16x32_bf16 v[188:191], a[136:139], a[40:43], v[188:191]
    v_cvt_pk_bf16_f32 v211, v182, v183
    v_mfma_f32_16x16x32_bf16 v[188:191], a[140:143], a[44:47], v[188:191]
    v_mfma_f32_16x16x32_bf16 v[176:179], a[80:83], a[48:51], 0
    v_exp_f32 v184, v184
    v_mfma_f32_16x16x32_bf16 v[176:179], a[84:87], a[52:55], v[176:179]
    s_add_u32 s37, s37, 1
    s_and_b32 s40, s37, 3
    v_mfma_f32_16x16x32_bf16 v[176:179], a[88:91], a[56:59], v[176:179]
    v_exp_f32 v185, v185
    v_mfma_f32_16x16x32_bf16 v[176:179], a[92:95], a[60:63], v[176:179]
    s_cmp_eq_u32 s40, 0
    v_cvt_pk_bf16_f32 v212, v184, v185
    v_mfma_f32_16x16x32_bf16 v[144:147], a[144:147], v[224:227], v[144:147]
    v_exp_f32 v186, v186
    v_mfma_f32_16x16x32_bf16 v[148:151], a[148:151], v[224:227], v[148:151]
    s_cselect_b32 s36, 0xfffe7700, s100
    v_add_u32 v228, s36, v228
    v_mfma_f32_16x16x32_bf16 v[152:155], a[152:155], v[224:227], v[152:155]
    v_exp_f32 v187, v187
    v_mfma_f32_16x16x32_bf16 v[156:159], a[156:159], v[224:227], v[156:159]
    v_add_u32 v229, s36, v229
    v_cvt_pk_bf16_f32 v213, v186, v187
    v_mfma_f32_16x16x32_bf16 v[160:163], a[160:163], v[224:227], v[160:163]
    v_exp_f32 v188, v188
    v_mfma_f32_16x16x32_bf16 v[164:167], a[164:167], v[224:227], v[164:167]
    v_add_u32 v232, s36, v232
    v_add_u32 v230, s36, v230
    v_mfma_f32_16x16x32_bf16 v[168:171], a[168:171], v[224:227], v[168:171]
    v_exp_f32 v189, v189
    v_mfma_f32_16x16x32_bf16 v[172:175], a[172:175], v[224:227], v[172:175]
    v_add_u32 v231, s36, v231
    v_cvt_pk_bf16_f32 v214, v188, v189
    v_mfma_f32_16x16x32_bf16 a[224:227], a[228:231], v[224:227], a[224:227]
    v_exp_f32 v190, v190
    v_mfma_f32_16x16x32_bf16 v[180:183], a[96:99], a[48:51], 0
    v_add_u32 v233, s36, v233
    v_mfma_f32_16x16x32_bf16 v[180:183], a[100:103], a[52:55], v[180:183]
    v_exp_f32 v191, v191
    v_mfma_f32_16x16x32_bf16 v[180:183], a[104:107], a[56:59], v[180:183]
    v_cvt_pk_bf16_f32 v215, v190, v191
    v_mfma_f32_16x16x32_bf16 v[180:183], a[108:111], a[60:63], v[180:183]
    s_waitcnt vmcnt(8)
    s_barrier
    v_mfma_f32_16x16x32_bf16 v[184:187], a[112:115], a[48:51], 0
    v_exp_f32 v176, v176
    v_mfma_f32_16x16x32_bf16 v[184:187], a[116:119], a[52:55], v[184:187]
    ds_read_b128 a[80:83], v228 offset:0
    ds_read_b128 a[84:87], v228 offset:64
    v_mfma_f32_16x16x32_bf16 v[184:187], a[120:123], a[56:59], v[184:187]
    v_exp_f32 v177, v177
    v_mfma_f32_16x16x32_bf16 v[184:187], a[124:127], a[60:63], v[184:187]
    ds_read_b128 a[88:91], v229 offset:0
    v_cvt_pk_bf16_f32 v216, v176, v177
    v_mfma_f32_16x16x32_bf16 v[80:83], a[144:147], v[208:211], v[80:83]
    v_exp_f32 v178, v178
    v_mfma_f32_16x16x32_bf16 v[80:83], a[176:179], v[212:215], v[80:83]
    ds_read_b128 a[92:95], v229 offset:64
    ds_read_b128 a[96:99], v228 offset:256
    v_mfma_f32_16x16x32_bf16 v[84:87], a[180:183], v[212:215], v[84:87]
    v_exp_f32 v179, v179
    v_mfma_f32_16x16x32_bf16 v[84:87], a[148:151], v[208:211], v[84:87]
    ds_read_b128 a[100:103], v228 offset:320
    v_cvt_pk_bf16_f32 v217, v178, v179
    v_mfma_f32_16x16x32_bf16 v[88:91], a[152:155], v[208:211], v[88:91]
    v_exp_f32 v180, v180
    v_mfma_f32_16x16x32_bf16 v[88:91], a[184:187], v[212:215], v[88:91]
    ds_read_b128 a[104:107], v229 offset:256
    ds_read_b128 a[108:111], v229 offset:320
    v_mfma_f32_16x16x32_bf16 v[92:95], a[188:191], v[212:215], v[92:95]
    v_exp_f32 v181, v181
    v_mfma_f32_16x16x32_bf16 v[92:95], a[156:159], v[208:211], v[92:95]
    v_cvt_pk_bf16_f32 v218, v180, v181
    v_mfma_f32_16x16x32_bf16 v[188:191], a[128:131], a[48:51], 0
    v_exp_f32 v182, v182
    v_mfma_f32_16x16x32_bf16 v[188:191], a[132:135], a[52:55], v[188:191]
    v_mfma_f32_16x16x32_bf16 v[188:191], a[136:139], a[56:59], v[188:191]
    v_exp_f32 v183, v183
    v_mfma_f32_16x16x32_bf16 v[188:191], a[140:143], a[60:63], v[188:191]
    v_cvt_pk_bf16_f32 v219, v182, v183
    s_cmp_lt_u32 s37, 14
    s_waitcnt lgkmcnt(0)
    s_cbranch_scc1 L_loop
    v_mfma_f32_16x16x32_bf16 v[176:179], a[80:83], a[0:3], 0
    buffer_load_dword v249, v239, s[80:83], 0 offen sc1
    v_exp_f32 v184, v184
    v_mfma_f32_16x16x32_bf16 v[176:179], a[84:87], a[4:7], v[176:179]
    ds_read_b128 a[112:115], v230 offset:0
    ds_read_b128 a[116:119], v230 offset:64
    s_add_u32 s43, s86, 0
    v_mfma_f32_16x16x32_bf16 v[176:179], a[88:91], a[8:11], v[176:179]
    v_exp_f32 v185, v185
    v_mfma_f32_16x16x32_bf16 v[176:179], a[92:95], a[12:15], v[176:179]
    ds_read_b128 a[120:123], v231 offset:0
    v_cvt_pk_bf16_f32 v220, v184, v185
    v_mfma_f32_16x16x32_bf16 v[96:99], a[160:163], v[208:211], v[96:99]
    v_exp_f32 v186, v186
    v_mfma_f32_16x16x32_bf16 v[96:99], a[192:195], v[212:215], v[96:99]
    ds_read_b128 a[124:127], v231 offset:64
    ds_read_b128 a[128:131], v230 offset:256
    v_mfma_f32_16x16x32_bf16 v[100:103], a[196:199], v[212:215], v[100:103]
    v_exp_f32 v187, v187
    v_mfma_f32_16x16x32_bf16 v[100:103], a[164:167], v[208:211], v[100:103]
    ds_read_b128 a[132:135], v230 offset:320
    v_cvt_pk_bf16_f32 v221, v186, v187
    v_mfma_f32_16x16x32_bf16 v[104:107], a[168:171], v[208:211], v[104:107]
    v_exp_f32 v188, v188
    v_mfma_f32_16x16x32_bf16 v[104:107], a[200:203], v[212:215], v[104:107]
    ds_read_b128 a[136:139], v231 offset:256
    ds_read_b128 a[140:143], v231 offset:320
    v_mfma_f32_16x16x32_bf16 v[108:111], a[204:207], v[212:215], v[108:111]
    v_exp_f32 v189, v189
    v_mfma_f32_16x16x32_bf16 v[108:111], a[172:175], v[208:211], v[108:111]
    s_and_b32 s43, s43, 15
    v_cvt_pk_bf16_f32 v222, v188, v189
    v_smfmac_f32_16x16x64_bf16 a[216:219], a[228:231], v[208:215], v1
    v_exp_f32 v190, v190
    v_mfma_f32_16x16x32_bf16 v[180:183], a[96:99], a[0:3], 0
    s_lshl_b32 s43, s43, 15
    s_add_u32 m0, s87, 134400
    v_mfma_f32_16x16x32_bf16 v[180:183], a[100:103], a[4:7], v[180:183]
    v_exp_f32 v191, v191
    v_mfma_f32_16x16x32_bf16 v[180:183], a[104:107], a[8:11], v[180:183]
    buffer_load_dwordx4 v244, s[92:95], s43 offen offset:0 lds
    v_cvt_pk_bf16_f32 v223, v190, v191
    v_mfma_f32_16x16x32_bf16 v[180:183], a[108:111], a[12:15], v[180:183]
    s_add_u32 m0, s87, 134432
    s_nop 0
    buffer_load_dwordx4 v244, s[92:95], s43 offen offset:1024 lds
    s_waitcnt lgkmcnt(0)
    v_mfma_f32_16x16x32_bf16 v[184:187], a[112:115], a[0:3], 0
    s_add_u32 m0, s87, 134464
    v_exp_f32 v176, v176
    v_mfma_f32_16x16x32_bf16 v[184:187], a[116:119], a[4:7], v[184:187]
    buffer_load_dwordx4 v244, s[92:95], s43 offen offset:2048 lds
    v_mfma_f32_16x16x32_bf16 v[184:187], a[120:123], a[8:11], v[184:187]
    s_add_u32 m0, s87, 134496
    v_exp_f32 v177, v177
    v_mfma_f32_16x16x32_bf16 v[184:187], a[124:127], a[12:15], v[184:187]
    buffer_load_dwordx4 v244, s[92:95], s43 offen offset:3072 lds
    v_cvt_pk_bf16_f32 v192, v176, v177
    v_mfma_f32_16x16x32_bf16 v[112:115], a[144:147], v[216:219], v[112:115]
    v_exp_f32 v178, v178
    v_mfma_f32_16x16x32_bf16 v[112:115], a[176:179], v[220:223], v[112:115]
    ds_read_b64_tr_b16 a[144:145], v232 offset:0
    ds_read_b64_tr_b16 a[146:147], v232 offset:512
    v_mfma_f32_16x16x32_bf16 v[116:119], a[180:183], v[220:223], v[116:119]
    v_exp_f32 v179, v179
    v_mfma_f32_16x16x32_bf16 v[116:119], a[148:151], v[216:219], v[116:119]
    ds_read_b64_tr_b16 a[176:177], v233 offset:0
    v_cvt_pk_bf16_f32 v193, v178, v179
    v_mfma_f32_16x16x32_bf16 v[120:123], a[152:155], v[216:219], v[120:123]
    v_exp_f32 v180, v180
    v_mfma_f32_16x16x32_bf16 v[120:123], a[184:187], v[220:223], v[120:123]
    ds_read_b64_tr_b16 a[178:179], v233 offset:512
    ds_read_b64_tr_b16 a[148:149], v232 offset:32
    v_mfma_f32_16x16x32_bf16 v[124:127], a[188:191], v[220:223], v[124:127]
    v_exp_f32 v181, v181
    v_mfma_f32_16x16x32_bf16 v[124:127], a[156:159], v[216:219], v[124:127]
    ds_read_b64_tr_b16 a[150:151], v232 offset:544
    v_cvt_pk_bf16_f32 v194, v180, v181
    v_mfma_f32_16x16x32_bf16 v[188:191], a[128:131], a[0:3], 0
    v_exp_f32 v182, v182
    v_mfma_f32_16x16x32_bf16 v[188:191], a[132:135], a[4:7], v[188:191]
    ds_read_b64_tr_b16 a[180:181], v233 offset:32
    ds_read_b64_tr_b16 a[182:183], v233 offset:544
    v_mfma_f32_16x16x32_bf16 v[188:191], a[136:139], a[8:11], v[188:191]
    v_exp_f32 v183, v183
    v_mfma_f32_16x16x32_bf16 v[188:191], a[140:143], a[12:15], v[188:191]
    ds_read_b64_tr_b16 a[152:153], v232 offset:64
    v_cvt_pk_bf16_f32 v195, v182, v183
    v_mfma_f32_16x16x32_bf16 v[176:179], a[80:83], a[16:19], 0
    s_add_u32 s43, s86, 1
    v_exp_f32 v184, v184
    v_mfma_f32_16x16x32_bf16 v[176:179], a[84:87], a[20:23], v[176:179]
    ds_read_b64_tr_b16 a[154:155], v232 offset:576
    ds_read_b64_tr_b16 a[184:185], v233 offset:64
    s_and_b32 s43, s43, 15
    v_mfma_f32_16x16x32_bf16 v[176:179], a[88:91], a[24:27], v[176:179]
    s_lshl_b32 s43, s43, 15
    v_exp_f32 v185, v185
    v_mfma_f32_16x16x32_bf16 v[176:179], a[92:95], a[28:31], v[176:179]
    ds_read_b64_tr_b16 a[186:187], v233 offset:576
    s_add_u32 m0, s87, 0
    v_cvt_pk_bf16_f32 v196, v184, v185
    v_mfma_f32_16x16x32_bf16 v[128:131], a[160:163], v[216:219], v[128:131]
    buffer_load_dwordx4 v244, s[92:95], s43 offen offset:0 lds
    v_exp_f32 v186, v186
    v_mfma_f32_16x16x32_bf16 v[128:131], a[192:195], v[220:223], v[128:131]
    ds_read_b64_tr_b16 a[156:157], v232 offset:96
    ds_read_b64_tr_b16 a[158:159], v232 offset:608
    v_mfma_f32_16x16x32_bf16 v[132:135], a[196:199], v[220:223], v[132:135]
    v_exp_f32 v187, v187
    v_mfma_f32_16x16x32_bf16 v[132:135], a[164:167], v[216:219], v[132:135]
    ds_read_b64_tr_b16 a[188:189], v233 offset:96
    v_cvt_pk_bf16_f32 v197, v186, v187
    v_mfma_f32_16x16x32_bf16 v[136:139], a[168:171], v[216:219], v[136:139]
    v_exp_f32 v188, v188
    v_mfma_f32_16x16x32_bf16 v[136:139], a[200:203], v[220:223], v[136:139]
    ds_read_b64_tr_b16 a[190:191], v233 offset:608
    ds_read_b64_tr_b16 a[160:161], v232 offset:128
    v_mfma_f32_16x16x32_bf16 v[140:143], a[204:207], v[220:223], v[140:143]
    v_exp_f32 v189, v189
    v_mfma_f32_16x16x32_bf16 v[140:143], a[172:175], v[216:219], v[140:143]
    ds_read_b64_tr_b16 a[162:163], v232 offset:640
    v_cvt_pk_bf16_f32 v198, v188, v189
    v_smfmac_f32_16x16x64_bf16 a[220:223], a[228:231], v[216:223], v1
    v_exp_f32 v190, v190
    v_mfma_f32_16x16x32_bf16 v[180:183], a[96:99], a[16:19], 0
    ds_read_b64_tr_b16 a[192:193], v233 offset:128
    ds_read_b64_tr_b16 a[194:195], v233 offset:640
    v_mfma_f32_16x16x32_bf16 v[180:183], a[100:103], a[20:23], v[180:183]
    v_exp_f32 v191, v191
    v_mfma_f32_16x16x32_bf16 v[180:183], a[104:107], a[24:27], v[180:183]
    ds_read_b64_tr_b16 a[164:165], v232 offset:160
    v_cvt_pk_bf16_f32 v199, v190, v191
    v_mfma_f32_16x16x32_bf16 v[180:183], a[108:111], a[28:31], v[180:183]
    ds_read_b64_tr_b16 a[166:167], v232 offset:672
    ds_read_b64_tr_b16 a[196:197], v233 offset:160
    v_mfma_f32_16x16x32_bf16 v[184:187], a[112:115], a[16:19], 0
    s_add_u32 m0, s87, 32
    v_exp_f32 v176, v176
    v_mfma_f32_16x16x32_bf16 v[184:187], a[116:119], a[20:23], v[184:187]
    ds_read_b64_tr_b16 a[198:199], v233 offset:672
    ds_read_b64_tr_b16 a[168:169], v232 offset:192
    v_mfma_f32_16x16x32_bf16 v[184:187], a[120:123], a[24:27], v[184:187]
    buffer_load_dwordx4 v244, s[92:95], s43 offen offset:1024 lds
    v_exp_f32 v177, v177
    v_mfma_f32_16x16x32_bf16 v[184:187], a[124:127], a[28:31], v[184:187]
    s_waitcnt lgkmcnt(9)
    v_cvt_pk_bf16_f32 v200, v176, v177
    v_mfma_f32_16x16x32_bf16 v[16:19], a[144:147], v[192:195], v[16:19]
    v_exp_f32 v178, v178
    v_mfma_f32_16x16x32_bf16 v[16:19], a[176:179], v[196:199], v[16:19]
    ds_read_b64_tr_b16 a[170:171], v232 offset:704
    ds_read_b64_tr_b16 a[200:201], v233 offset:192
    v_mfma_f32_16x16x32_bf16 v[20:23], a[180:183], v[196:199], v[20:23]
    v_exp_f32 v179, v179
    v_mfma_f32_16x16x32_bf16 v[20:23], a[148:151], v[192:195], v[20:23]
    ds_read_b64_tr_b16 a[202:203], v233 offset:704
    v_cvt_pk_bf16_f32 v201, v178, v179
    v_mfma_f32_16x16x32_bf16 v[24:27], a[152:155], v[192:195], v[24:27]
    v_exp_f32 v180, v180
    v_mfma_f32_16x16x32_bf16 v[24:27], a[184:187], v[196:199], v[24:27]
    ds_read_b64_tr_b16 a[172:173], v232 offset:224
    ds_read_b64_tr_b16 a[174:175], v232 offset:736
    v_mfma_f32_16x16x32_bf16 v[28:31], a[188:191], v[196:199], v[28:31]
    v_exp_f32 v181, v181
    v_mfma_f32_16x16x32_bf16 v[28:31], a[156:159], v[192:195], v[28:31]
    ds_read_b64_tr_b16 a[204:205], v233 offset:224
    v_cvt_pk_bf16_f32 v202, v180, v181
    v_mfma_f32_16x16x32_bf16 v[188:191], a[128:131], a[16:19], 0
    v_exp_f32 v182, v182
    v_mfma_f32_16x16x32_bf16 v[188:191], a[132:135], a[20:23], v[188:191]
    ds_read_b64_tr_b16 a[206:207], v233 offset:736
    s_add_u32 m0, s87, 64
    v_mfma_f32_16x16x32_bf16 v[188:191], a[136:139], a[24:27], v[188:191]
    v_exp_f32 v183, v183
    v_mfma_f32_16x16x32_bf16 v[188:191], a[140:143], a[28:31], v[188:191]
    buffer_load_dwordx4 v244, s[92:95], s43 offen offset:2048 lds
    v_cvt_pk_bf16_f32 v203, v182, v183
    v_mfma_f32_16x16x32_bf16 v[176:179], a[80:83], a[64:67], 0
    v_exp_f32 v184, v184
    v_mfma_f32_16x16x32_bf16 v[176:179], a[84:87], a[68:71], v[176:179]
    s_add_u32 m0, s87, 96
    v_mfma_f32_16x16x32_bf16 v[176:179], a[88:91], a[72:75], v[176:179]
    v_exp_f32 v185, v185
    v_mfma_f32_16x16x32_bf16 v[176:179], a[92:95], a[76:79], v[176:179]
    s_waitcnt lgkmcnt(0)
    v_cvt_pk_bf16_f32 v204, v184, v185
    v_mfma_f32_16x16x32_bf16 v[32:35], a[160:163], v[192:195], v[32:35]
    v_exp_f32 v186, v186
    v_mfma_f32_16x16x32_bf16 v[32:35], a[192:195], v[196:199], v[32:35]
    buffer_load_dwordx4 v244, s[92:95], s43 offen offset:3072 lds
    v_mfma_f32_16x16x32_bf16 v[36:39], a[196:199], v[196:199], v[36:39]
    v_exp_f32 v187, v187
    v_mfma_f32_16x16x32_bf16 v[36:39], a[164:167], v[192:195], v[36:39]
    s_add_u32 s43, s86, 2
    v_cvt_pk_bf16_f32 v205, v186, v187
    v_mfma_f32_16x16x32_bf16 v[40:43], a[168:171], v[192:195], v[40:43]
    v_exp_f32 v188, v188
    v_mfma_f32_16x16x32_bf16 v[40:43], a[200:203], v[196:199], v[40:43]
    s_and_b32 s43, s43, 15
    s_lshl_b32 s43, s43, 15
    v_mfma_f32_16x16x32_bf16 v[44:47], a[204:207], v[196:199], v[44:47]
    v_exp_f32 v189, v189
    v_mfma_f32_16x16x32_bf16 v[44:47], a[172:175], v[192:195], v[44:47]
    s_add_u32 m0, s87, 16768
    v_cvt_pk_bf16_f32 v206, v188, v189
    v_smfmac_f32_16x16x64_bf16 a[208:211], a[228:231], v[192:199], v1
    v_exp_f32 v190, v190
    v_mfma_f32_16x16x32_bf16 v[180:183], a[96:99], a[64:67], 0
    buffer_load_dwordx4 v244, s[92:95], s43 offen offset:0 lds
    v_mfma_f32_16x16x32_bf16 v[180:183], a[100:103], a[68:71], v[180:183]
    v_exp_f32 v191, v191
    v_mfma_f32_16x16x32_bf16 v[180:183], a[104:107], a[72:75], v[180:183]
    s_add_u32 m0, s87, 16800
    v_cvt_pk_bf16_f32 v207, v190, v191
    v_mfma_f32_16x16x32_bf16 v[180:183], a[108:111], a[76:79], v[180:183]
    buffer_load_dwordx4 v244, s[92:95], s43 offen offset:1024 lds
    v_mfma_f32_16x16x32_bf16 v[184:187], a[80:83], a[32:35], 0
    v_exp_f32 v176, v176
    v_mfma_f32_16x16x32_bf16 v[184:187], a[84:87], a[36:39], v[184:187]
    s_add_u32 m0, s87, 16832
    v_mfma_f32_16x16x32_bf16 v[184:187], a[88:91], a[40:43], v[184:187]
    v_exp_f32 v177, v177
    v_mfma_f32_16x16x32_bf16 v[184:187], a[92:95], a[44:47], v[184:187]
    buffer_load_dwordx4 v244, s[92:95], s43 offen offset:2048 lds
    v_cvt_pk_bf16_f32 v224, v176, v177
    v_mfma_f32_16x16x32_bf16 v[48:51], a[144:147], v[200:203], v[48:51]
    v_exp_f32 v178, v178
    v_mfma_f32_16x16x32_bf16 v[48:51], a[176:179], v[204:207], v[48:51]
    s_add_u32 m0, s87, 16864
    v_mfma_f32_16x16x32_bf16 v[52:55], a[180:183], v[204:207], v[52:55]
    v_exp_f32 v179, v179
    v_mfma_f32_16x16x32_bf16 v[52:55], a[148:151], v[200:203], v[52:55]
    buffer_load_dwordx4 v244, s[92:95], s43 offen offset:3072 lds
    v_cvt_pk_bf16_f32 v225, v178, v179
    v_mfma_f32_16x16x32_bf16 v[56:59], a[152:155], v[200:203], v[56:59]
    v_exp_f32 v180, v180
    v_mfma_f32_16x16x32_bf16 v[56:59], a[184:187], v[204:207], v[56:59]
    s_add_u32 s43, s86, 3
    s_and_b32 s43, s43, 15
    v_mfma_f32_16x16x32_bf16 v[60:63], a[188:191], v[204:207], v[60:63]
    v_exp_f32 v181, v181
    v_mfma_f32_16x16x32_bf16 v[60:63], a[156:159], v[200:203], v[60:63]
    s_lshl_b32 s43, s43, 15
    v_cvt_pk_bf16_f32 v226, v180, v181
    v_mfma_f32_16x16x32_bf16 v[188:191], a[96:99], a[32:35], 0
    v_exp_f32 v182, v182
    v_mfma_f32_16x16x32_bf16 v[188:191], a[100:103], a[36:39], v[188:191]
    s_add_u32 m0, s87, 33536
    v_mfma_f32_16x16x32_bf16 v[188:191], a[104:107], a[40:43], v[188:191]
    v_exp_f32 v183, v183
    v_mfma_f32_16x16x32_bf16 v[188:191], a[108:111], a[44:47], v[188:191]
    buffer_load_dwordx4 v244, s[92:95], s43 offen offset:0 lds
    v_cvt_pk_bf16_f32 v227, v182, v183
    v_mfma_f32_16x16x32_bf16 v[176:179], a[112:115], a[32:35], 0
    v_exp_f32 v184, v184
    v_mfma_f32_16x16x32_bf16 v[176:179], a[116:119], a[36:39], v[176:179]
    s_add_u32 m0, s87, 33568
    v_mfma_f32_16x16x32_bf16 v[176:179], a[120:123], a[40:43], v[176:179]
    v_exp_f32 v185, v185
    v_mfma_f32_16x16x32_bf16 v[176:179], a[124:127], a[44:47], v[176:179]
    buffer_load_dwordx4 v244, s[92:95], s43 offen offset:1024 lds
    v_cvt_pk_bf16_f32 v208, v184, v185
    v_mfma_f32_16x16x32_bf16 v[64:67], a[160:163], v[200:203], v[64:67]
    v_exp_f32 v186, v186
    v_mfma_f32_16x16x32_bf16 v[64:67], a[192:195], v[204:207], v[64:67]
    s_add_u32 m0, s87, 33600
    v_mfma_f32_16x16x32_bf16 v[68:71], a[196:199], v[204:207], v[68:71]
    v_exp_f32 v187, v187
    v_mfma_f32_16x16x32_bf16 v[68:71], a[164:167], v[200:203], v[68:71]
    buffer_load_dwordx4 v244, s[92:95], s43 offen offset:2048 lds
    v_cvt_pk_bf16_f32 v209, v186, v187
    v_mfma_f32_16x16x32_bf16 v[72:75], a[168:171], v[200:203], v[72:75]
    v_exp_f32 v188, v188
    v_mfma_f32_16x16x32_bf16 v[72:75], a[200:203], v[204:207], v[72:75]
    s_add_u32 m0, s87, 33632
    v_mfma_f32_16x16x32_bf16 v[76:79], a[204:207], v[204:207], v[76:79]
    v_exp_f32 v189, v189
    v_mfma_f32_16x16x32_bf16 v[76:79], a[172:175], v[200:203], v[76:79]
    buffer_load_dwordx4 v244, s[92:95], s43 offen offset:3072 lds
    v_cvt_pk_bf16_f32 v210, v188, v189
    v_smfmac_f32_16x16x64_bf16 a[212:215], a[228:231], v[200:207], v1
    v_exp_f32 v190, v190
    v_mfma_f32_16x16x32_bf16 v[180:183], a[128:131], a[32:35], 0
    v_mfma_f32_16x16x32_bf16 v[180:183], a[132:135], a[36:39], v[180:183]
    v_exp_f32 v191, v191
    v_mfma_f32_16x16x32_bf16 v[180:183], a[136:139], a[40:43], v[180:183]
    v_cvt_pk_bf16_f32 v211, v190, v191
    v_mfma_f32_16x16x32_bf16 v[180:183], a[140:143], a[44:47], v[180:183]
    v_mfma_f32_16x16x32_bf16 v[184:187], a[80:83], a[48:51], 0
    v_exp_f32 v176, v176
    v_mfma_f32_16x16x32_bf16 v[184:187], a[84:87], a[52:55], v[184:187]
    s_add_u32 s43, s86, 4
    s_and_b32 s43, s43, 15
    v_mfma_f32_16x16x32_bf16 v[184:187], a[88:91], a[56:59], v[184:187]
    v_exp_f32 v177, v177
    v_mfma_f32_16x16x32_bf16 v[184:187], a[92:95], a[60:63], v[184:187]
    s_lshl_b32 s43, s43, 15
    v_cvt_pk_bf16_f32 v212, v176, v177
    v_mfma_f32_16x16x32_bf16 v[144:147], a[144:147], v[224:227], v[144:147]
    v_exp_f32 v178, v178
    v_mfma_f32_16x16x32_bf16 v[148:151], a[148:151], v[224:227], v[148:151]
    s_add_u32 m0, s87, 50304
    v_add_u32 v228, s100, v228
    v_mfma_f32_16x16x32_bf16 v[152:155], a[152:155], v[224:227], v[152:155]
    v_exp_f32 v179, v179
    v_mfma_f32_16x16x32_bf16 v[156:159], a[156:159], v[224:227], v[156:159]
    buffer_load_dwordx4 v244, s[92:95], s43 offen offset:0 lds
    v_cvt_pk_bf16_f32 v213, v178, v179
    v_mfma_f32_16x16x32_bf16 v[160:163], a[160:163], v[224:227], v[160:163]
    v_exp_f32 v180, v180
    v_mfma_f32_16x16x32_bf16 v[164:167], a[164:167], v[224:227], v[164:167]
    s_add_u32 m0, s87, 50336
    v_add_u32 v229, s100, v229
    v_mfma_f32_16x16x32_bf16 v[168:171], a[168:171], v[224:227], v[168:171]
    v_exp_f32 v181, v181
    v_mfma_f32_16x16x32_bf16 v[172:175], a[172:175], v[224:227], v[172:175]
    buffer_load_dwordx4 v244, s[92:95], s43 offen offset:1024 lds
    v_cvt_pk_bf16_f32 v214, v180, v181
    v_mfma_f32_16x16x32_bf16 a[224:227], a[228:231], v[224:227], a[224:227]
    v_exp_f32 v182, v182
    v_mfma_f32_16x16x32_bf16 v[188:191], a[96:99], a[48:51], 0
    v_add_u32 v232, s100, v232
    v_add_u32 v230, s100, v230
    v_mfma_f32_16x16x32_bf16 v[188:191], a[100:103], a[52:55], v[188:191]
    v_exp_f32 v183, v183
    v_mfma_f32_16x16x32_bf16 v[188:191], a[104:107], a[56:59], v[188:191]
    v_add_u32 v231, s100, v231
    v_cvt_pk_bf16_f32 v215, v182, v183
    v_mfma_f32_16x16x32_bf16 v[188:191], a[108:111], a[60:63], v[188:191]
    v_add_u32 v233, s100, v233
    s_waitcnt vmcnt(19)
    s_barrier
    v_mfma_f32_16x16x32_bf16 v[176:179], a[112:115], a[48:51], 0
    v_exp_f32 v184, v184
    v_mfma_f32_16x16x32_bf16 v[176:179], a[116:119], a[52:55], v[176:179]
    ds_read_b128 a[80:83], v228 offset:0
    ds_read_b128 a[84:87], v228 offset:64
    v_mfma_f32_16x16x32_bf16 v[176:179], a[120:123], a[56:59], v[176:179]
    v_exp_f32 v185, v185
    v_mfma_f32_16x16x32_bf16 v[176:179], a[124:127], a[60:63], v[176:179]
    ds_read_b128 a[88:91], v229 offset:0
    v_cvt_pk_bf16_f32 v216, v184, v185
    v_mfma_f32_16x16x32_bf16 v[80:83], a[144:147], v[208:211], v[80:83]
    v_exp_f32 v186, v186
    v_mfma_f32_16x16x32_bf16 v[80:83], a[176:179], v[212:215], v[80:83]
    ds_read_b128 a[92:95], v229 offset:64
    ds_read_b128 a[96:99], v228 offset:256
    v_mfma_f32_16x16x32_bf16 v[84:87], a[180:183], v[212:215], v[84:87]
    v_exp_f32 v187, v187
    v_mfma_f32_16x16x32_bf16 v[84:87], a[148:151], v[208:211], v[84:87]
    ds_read_b128 a[100:103], v228 offset:320
    v_cvt_pk_bf16_f32 v217, v186, v187
    v_mfma_f32_16x16x32_bf16 v[88:91], a[152:155], v[208:211], v[88:91]
    v_exp_f32 v188, v188
    v_mfma_f32_16x16x32_bf16 v[88:91], a[184:187], v[212:215], v[88:91]
    ds_read_b128 a[104:107], v229 offset:256
    ds_read_b128 a[108:111], v229 offset:320
    v_mfma_f32_16x16x32_bf16 v[92:95], a[188:191], v[212:215], v[92:95]
    v_exp_f32 v189, v189
    v_mfma_f32_16x16x32_bf16 v[92:95], a[156:159], v[208:211], v[92:95]
    s_add_u32 m0, s87, 50368
    v_cvt_pk_bf16_f32 v218, v188, v189
    v_mfma_f32_16x16x32_bf16 v[180:183], a[128:131], a[48:51], 0
    v_exp_f32 v190, v190
    v_mfma_f32_16x16x32_bf16 v[180:183], a[132:135], a[52:55], v[180:183]
    buffer_load_dwordx4 v244, s[92:95], s43 offen offset:2048 lds
    v_mfma_f32_16x16x32_bf16 v[180:183], a[136:139], a[56:59], v[180:183]
    s_add_u32 m0, s87, 50400
    v_exp_f32 v191, v191
    v_mfma_f32_16x16x32_bf16 v[180:183], a[140:143], a[60:63], v[180:183]
    buffer_load_dwordx4 v244, s[92:95], s43 offen offset:3072 lds
    v_cvt_pk_bf16_f32 v219, v190, v191
    s_waitcnt lgkmcnt(0)
    v_mfma_f32_16x16x32_bf16 v[184:187], a[80:83], a[64:67], 0
    s_waitcnt vmcnt(16)
    v_exp_f32 v176, v176
    v_mfma_f32_16x16x32_bf16 v[184:187], a[84:87], a[68:71], v[184:187]
    ds_read_b128 a[112:115], v230 offset:0
    ds_read_b128 a[116:119], v230 offset:64
    ds_read_b64_tr_b16 a[240:241], v247 offset:0
    v_mfma_f32_16x16x32_bf16 v[184:187], a[88:91], a[72:75], v[184:187]
    ds_read_b64_tr_b16 a[242:243], v247 offset:512
    v_exp_f32 v177, v177
    v_mfma_f32_16x16x32_bf16 v[184:187], a[92:95], a[76:79], v[184:187]
    ds_read_b128 a[120:123], v231 offset:0
    ds_read_b64_tr_b16 a[244:245], v247 offset:32
    v_cvt_pk_bf16_f32 v220, v176, v177
    v_mfma_f32_16x16x32_bf16 v[96:99], a[160:163], v[208:211], v[96:99]
    ds_read_b64_tr_b16 a[246:247], v247 offset:544
    v_exp_f32 v178, v178
    v_mfma_f32_16x16x32_bf16 v[96:99], a[192:195], v[212:215], v[96:99]
    ds_read_b128 a[124:127], v231 offset:64
    ds_read_b128 a[128:131], v230 offset:256
    ds_read_b64_tr_b16 a[248:249], v247 offset:64
    v_mfma_f32_16x16x32_bf16 v[100:103], a[196:199], v[212:215], v[100:103]
    ds_read_b64_tr_b16 a[250:251], v247 offset:576
    v_exp_f32 v179, v179
    v_mfma_f32_16x16x32_bf16 v[100:103], a[164:167], v[208:211], v[100:103]
    ds_read_b128 a[132:135], v230 offset:320
    ds_read_b64_tr_b16 a[252:253], v247 offset:96
    v_cvt_pk_bf16_f32 v221, v178, v179
    v_mfma_f32_16x16x32_bf16 v[104:107], a[168:171], v[208:211], v[104:107]
    ds_read_b64_tr_b16 a[254:255], v247 offset:608
    v_exp_f32 v180, v180
    v_mfma_f32_16x16x32_bf16 v[104:107], a[200:203], v[212:215], v[104:107]
    ds_read_b128 a[136:139], v231 offset:256
    ds_read_b128 a[140:143], v231 offset:320
    s_lshl_b32 s40, s24, 13
    v_mfma_f32_16x16x32_bf16 v[108:111], a[204:207], v[212:215], v[108:111]
    s_add_u32 s40, s40, 67072
    v_exp_f32 v181, v181
    v_mfma_f32_16x16x32_bf16 v[108:111], a[172:175], v[208:211], v[108:111]
    v_add_u32 v9, s40, v248
    v_lshlrev_b32 v10, 2, v0
    v_cvt_pk_bf16_f32 v222, v180, v181
    v_smfmac_f32_16x16x64_bf16 a[216:219], a[228:231], v[208:215], v1
    v_exp_f32 v182, v182
    v_mfma_f32_16x16x32_bf16 v[188:191], a[96:99], a[64:67], 0
    s_lshl_b32 s40, s24, 8
    s_add_u32 s40, s40, 158720
    v_mfma_f32_16x16x32_bf16 v[188:191], a[100:103], a[68:71], v[188:191]
    v_exp_f32 v183, v183
    v_mfma_f32_16x16x32_bf16 v[188:191], a[104:107], a[72:75], v[188:191]
    v_add_u32 v11, s40, v10
    v_cvt_pk_bf16_f32 v223, v182, v183
    v_mfma_f32_16x16x32_bf16 v[188:191], a[108:111], a[76:79], v[188:191]
    s_xor_b32 s40, s40, 256
    v_add_u32 v10, s40, v10
    s_waitcnt lgkmcnt(0)
    v_mfma_f32_16x16x32_bf16 v[176:179], a[80:83], a[0:3], 0
    s_add_u32 s43, s86, 5
    v_exp_f32 v184, v184
    v_mfma_f32_16x16x32_bf16 v[176:179], a[84:87], a[4:7], v[176:179]
    s_and_b32 s43, s43, 15
    s_lshl_b32 s43, s43, 15
    s_add_u32 m0, s87, 134400
    v_mfma_f32_16x16x32_bf16 v[176:179], a[88:91], a[8:11], v[176:179]
    buffer_load_dwordx4 v244, s[92:95], s43 offen offset:0 lds
    v_exp_f32 v185, v185
    v_mfma_f32_16x16x32_bf16 v[176:179], a[92:95], a[12:15], v[176:179]
    s_lshl_b32 s40, s25, 12
    v_add_u32 v12, s40, v9
    v_cvt_pk_bf16_f32 v224, v184, v185
    v_mfma_f32_16x16x32_bf16 v[112:115], a[144:147], v[216:219], v[112:115]
    s_xor_b32 s42, s24, 1
    v_exp_f32 v186, v186
    v_mfma_f32_16x16x32_bf16 v[112:115], a[176:179], v[220:223], v[112:115]
    ds_read_b64_tr_b16 a[144:145], v232 offset:0
    ds_read_b64_tr_b16 a[146:147], v232 offset:512
    s_lshl_b32 s42, s42, 13
    v_mfma_f32_16x16x32_bf16 v[116:119], a[180:183], v[220:223], v[116:119]
    s_add_u32 s40, s40, s42
    v_exp_f32 v187, v187
    v_mfma_f32_16x16x32_bf16 v[116:119], a[148:151], v[216:219], v[116:119]
    ds_read_b64_tr_b16 a[148:149], v232 offset:32
    s_add_u32 s40, s40, 67072
    v_cvt_pk_bf16_f32 v225, v186, v187
    v_mfma_f32_16x16x32_bf16 v[120:123], a[152:155], v[216:219], v[120:123]
    v_add_u32 v13, s40, v248
    v_exp_f32 v188, v188
    v_mfma_f32_16x16x32_bf16 v[120:123], a[184:187], v[220:223], v[120:123]
    ds_read_b64_tr_b16 a[150:151], v232 offset:544
    ds_read_b64_tr_b16 a[152:153], v232 offset:64
    v_mov_b32 v238, 1.0
    v_mfma_f32_16x16x32_bf16 v[124:127], a[188:191], v[220:223], v[124:127]
    v_mov_b32 v241, 1.0
    v_exp_f32 v189, v189
    v_mfma_f32_16x16x32_bf16 v[124:127], a[156:159], v[216:219], v[124:127]
    ds_read_b64_tr_b16 a[154:155], v232 offset:576
    v_mov_b32 v8, 0
    v_cvt_pk_bf16_f32 v226, v188, v189
    v_mfma_f32_16x16x32_bf16 v[180:183], a[96:99], a[0:3], 0
    v_exp_f32 v190, v190
    v_mfma_f32_16x16x32_bf16 v[180:183], a[100:103], a[4:7], v[180:183]
    ds_read_b64_tr_b16 a[156:157], v232 offset:96
    ds_read_b64_tr_b16 a[158:159], v232 offset:608
    v_mfma_f32_16x16x32_bf16 v[180:183], a[104:107], a[8:11], v[180:183]
    v_exp_f32 v191, v191
    v_mfma_f32_16x16x32_bf16 v[180:183], a[108:111], a[12:15], v[180:183]
    ds_read_b64_tr_b16 a[176:177], v233 offset:0
    v_cvt_pk_bf16_f32 v227, v190, v191
    v_mfma_f32_16x16x32_bf16 v[184:187], a[112:115], a[0:3], 0
    v_exp_f32 v176, v176
    v_mfma_f32_16x16x32_bf16 v[184:187], a[116:119], a[4:7], v[184:187]
    ds_read_b64_tr_b16 a[178:179], v233 offset:512
    ds_read_b64_tr_b16 a[180:181], v233 offset:32
    v_mfma_f32_16x16x32_bf16 v[184:187], a[120:123], a[8:11], v[184:187]
    v_exp_f32 v177, v177
    v_mfma_f32_16x16x32_bf16 v[184:187], a[124:127], a[12:15], v[184:187]
    ds_read_b64_tr_b16 a[182:183], v233 offset:544
    v_cvt_pk_bf16_f32 v192, v176, v177
    v_mfma_f32_16x16x32_bf16 v[128:131], a[160:163], v[216:219], v[128:131]
    v_exp_f32 v178, v178
    v_mfma_f32_16x16x32_bf16 v[128:131], a[192:195], v[220:223], v[128:131]
    ds_read_b64_tr_b16 a[160:161], v232 offset:128
    ds_read_b64_tr_b16 a[162:163], v232 offset:640
    v_mfma_f32_16x16x32_bf16 v[132:135], a[196:199], v[220:223], v[132:135]
    v_exp_f32 v179, v179
    v_mfma_f32_16x16x32_bf16 v[132:135], a[164:167], v[216:219], v[132:135]
    ds_read_b64_tr_b16 a[164:165], v232 offset:160
    v_cvt_pk_bf16_f32 v193, v178, v179
    v_mfma_f32_16x16x32_bf16 v[136:139], a[168:171], v[216:219], v[136:139]
    v_exp_f32 v180, v180
    v_mfma_f32_16x16x32_bf16 v[136:139], a[200:203], v[220:223], v[136:139]
    ds_read_b64_tr_b16 a[166:167], v232 offset:672
    ds_read_b64_tr_b16 a[168:169], v232 offset:192
    v_mfma_f32_16x16x32_bf16 v[140:143], a[204:207], v[220:223], v[140:143]
    v_exp_f32 v181, v181
    v_mfma_f32_16x16x32_bf16 v[140:143], a[172:175], v[216:219], v[140:143]
    ds_read_b64_tr_b16 a[170:171], v232 offset:704
    v_cvt_pk_bf16_f32 v194, v180, v181
    v_smfmac_f32_16x16x64_bf16 a[220:223], a[228:231], v[216:223], v1
    v_exp_f32 v182, v182
    v_mfma_f32_16x16x32_bf16 v[188:191], a[128:131], a[0:3], 0
    ds_read_b64_tr_b16 a[172:173], v232 offset:224
    ds_read_b64_tr_b16 a[174:175], v232 offset:736
    v_mfma_f32_16x16x32_bf16 v[188:191], a[132:135], a[4:7], v[188:191]
    v_exp_f32 v183, v183
    v_mfma_f32_16x16x32_bf16 v[188:191], a[136:139], a[8:11], v[188:191]
    ds_read_b64_tr_b16 a[184:185], v233 offset:64
    v_cvt_pk_bf16_f32 v195, v182, v183
    v_mfma_f32_16x16x32_bf16 v[188:191], a[140:143], a[12:15], v[188:191]
    ds_read_b64_tr_b16 a[186:187], v233 offset:576
    ds_read_b64_tr_b16 a[188:189], v233 offset:96
    v_mfma_f32_16x16x32_bf16 v[176:179], a[80:83], a[16:19], 0
    s_add_u32 m0, s87, 134432
    v_exp_f32 v184, v184
    v_mfma_f32_16x16x32_bf16 v[176:179], a[84:87], a[20:23], v[176:179]
    ds_read_b64_tr_b16 a[190:191], v233 offset:608
    ds_read_b64_tr_b16 a[192:193], v233 offset:128
    v_mfma_f32_16x16x32_bf16 v[176:179], a[88:91], a[24:27], v[176:179]
    buffer_load_dwordx4 v244, s[92:95], s43 offen offset:1024 lds
    v_exp_f32 v185, v185
    v_mfma_f32_16x16x32_bf16 v[176:179], a[92:95], a[28:31], v[176:179]
    s_waitcnt lgkmcnt(5)
    s_add_u32 m0, s87, 134464
    v_cvt_pk_bf16_f32 v196, v184, v185
    v_mfma_f32_16x16x32_bf16 v[144:147], a[144:147], v[224:227], v[144:147]
    buffer_load_dwordx4 v244, s[92:95], s43 offen offset:2048 lds
    v_exp_f32 v186, v186
    v_mfma_f32_16x16x32_bf16 v[148:151], a[148:151], v[224:227], v[148:151]
    ds_read_b64_tr_b16 a[194:195], v233 offset:640
    ds_read_b64_tr_b16 a[196:197], v233 offset:160
    s_add_u32 m0, s87, 134496
    v_mfma_f32_16x16x32_bf16 v[152:155], a[152:155], v[224:227], v[152:155]
    buffer_load_dwordx4 v244, s[92:95], s43 offen offset:3072 lds
    v_exp_f32 v187, v187
    v_mfma_f32_16x16x32_bf16 v[156:159], a[156:159], v[224:227], v[156:159]
    ds_read_b64_tr_b16 a[198:199], v233 offset:672
    s_waitcnt vmcnt(16)
    v_cvt_pk_bf16_f32 v197, v186, v187
    v_mfma_f32_16x16x32_bf16 v[160:163], a[160:163], v[224:227], v[160:163]
    ds_read_b64_tr_b16 a[64:65], v245 offset:0
    v_exp_f32 v188, v188
    v_mfma_f32_16x16x32_bf16 v[164:167], a[164:167], v[224:227], v[164:167]
    ds_read_b64_tr_b16 a[200:201], v233 offset:192
    ds_read_b64_tr_b16 a[202:203], v233 offset:704
    ds_read_b64_tr_b16 a[66:67], v245 offset:512
    v_mfma_f32_16x16x32_bf16 v[168:171], a[168:171], v[224:227], v[168:171]
    ds_read_b64_tr_b16 a[68:69], v245 offset:32
    v_exp_f32 v189, v189
    v_mfma_f32_16x16x32_bf16 v[172:175], a[172:175], v[224:227], v[172:175]
    ds_read_b64_tr_b16 a[204:205], v233 offset:224
    ds_read_b64_tr_b16 a[70:71], v245 offset:544
    v_cvt_pk_bf16_f32 v198, v188, v189
    v_mfma_f32_16x16x32_bf16 a[224:227], a[228:231], v[224:227], a[224:227]
    v_exp_f32 v190, v190
    v_mfma_f32_16x16x32_bf16 v[180:183], a[96:99], a[16:19], 0
    ds_read_b64_tr_b16 a[206:207], v233 offset:736
    ds_read_b64_tr_b16 a[72:73], v245 offset:64
    v_mfma_f32_16x16x32_bf16 v[180:183], a[100:103], a[20:23], v[180:183]
    v_exp_f32 v191, v191
    v_mfma_f32_16x16x32_bf16 v[180:183], a[104:107], a[24:27], v[180:183]
    ds_read_b64_tr_b16 a[74:75], v245 offset:576
    v_cvt_pk_bf16_f32 v199, v190, v191
    v_mfma_f32_16x16x32_bf16 v[180:183], a[108:111], a[28:31], v[180:183]
    ds_read_b64_tr_b16 a[76:77], v245 offset:96
    ds_read_b64_tr_b16 a[78:79], v245 offset:608
    s_waitcnt lgkmcnt(0)
    v_mfma_f32_16x16x32_bf16 v[184:187], a[112:115], a[16:19], 0
    ds_write_b128 v9, v[144:147] offset:0
    ds_write_b128 v9, v[148:151] offset:1024
    v_exp_f32 v176, v176
    v_mfma_f32_16x16x32_bf16 v[184:187], a[116:119], a[20:23], v[184:187]
    ds_write_b128 v9, v[152:155] offset:2048
    ds_write_b128 v9, v[156:159] offset:3072
    v_accvgpr_read_b32 v236, a224
    v_min_f32 v238, v238, v236
    v_mfma_f32_16x16x32_bf16 v[184:187], a[120:123], a[24:27], v[184:187]
    ds_write_b128 v9, v[160:163] offset:4096
    ds_write_b128 v9, v[164:167] offset:5120
    v_exp_f32 v177, v177
    v_mfma_f32_16x16x32_bf16 v[184:187], a[124:127], a[28:31], v[184:187]
    ds_write_b128 v9, v[168:171] offset:6144
    ds_write_b128 v9, v[172:175] offset:7168
    v_max_f32 v241, v241, v236
    v_cvt_pk_bf16_f32 v200, v176, v177
    v_mfma_f32_16x16x32_bf16 v[16:19], a[144:147], v[192:195], v[16:19]
    ds_write_b32 v11, v236
    s_add_u32 s43, s86, 6
    v_exp_f32 v178, v178
    v_mfma_f32_16x16x32_bf16 v[16:19], a[176:179], v[196:199], v[16:19]
    s_and_b32 s43, s43, 15
    s_lshl_b32 s43, s43, 15
    s_add_u32 m0, s87, 0
    v_mfma_f32_16x16x32_bf16 v[20:23], a[180:183], v[196:199], v[20:23]
    buffer_load_dwordx4 v244, s[92:95], s43 offen offset:0 lds
    v_exp_f32 v179, v179
    v_mfma_f32_16x16x32_bf16 v[20:23], a[148:151], v[192:195], v[20:23]
    s_add_u32 m0, s87, 32
    v_add_f32 v8, v8, v236
    v_cvt_pk_bf16_f32 v201, v178, v179
    v_mfma_f32_16x16x32_bf16 v[24:27], a[152:155], v[192:195], v[24:27]
    buffer_load_dwordx4 v244, s[92:95], s43 offen offset:1024 lds
    v_exp_f32 v180, v180
    v_mfma_f32_16x16x32_bf16 v[24:27], a[184:187], v[196:199], v[24:27]
    s_add_u32 m0, s87, 64
    v_mfma_f32_16x16x32_bf16 v[28:31], a[188:191], v[196:199], v[28:31]
    buffer_load_dwordx4 v244, s[92:95], s43 offen offset:2048 lds
    s_add_u32 m0, s87, 96
    v_exp_f32 v181, v181
    v_mfma_f32_16x16x32_bf16 v[28:31], a[156:159], v[192:195], v[28:31]
    buffer_load_dwordx4 v244, s[92:95], s43 offen offset:3072 lds
    s_waitcnt vmcnt(16)
    ds_read_b64_tr_b16 a[0:1], v245 offset:16768
    v_cvt_pk_bf16_f32 v202, v180, v181
    v_mfma_f32_16x16x32_bf16 v[188:191], a[128:131], a[16:19], 0
    ds_read_b64_tr_b16 a[2:3], v245 offset:17280
    v_exp_f32 v182, v182
    v_mfma_f32_16x16x32_bf16 v[188:191], a[132:135], a[20:23], v[188:191]
    ds_read_b64_tr_b16 a[4:5], v245 offset:16800
    ds_read_b64_tr_b16 a[6:7], v245 offset:17312
    v_mfma_f32_16x16x32_bf16 v[188:191], a[136:139], a[24:27], v[188:191]
    ds_read_b64_tr_b16 a[8:9], v245 offset:16832
    ds_read_b64_tr_b16 a[10:11], v245 offset:17344
    v_exp_f32 v183, v183
    v_mfma_f32_16x16x32_bf16 v[188:191], a[140:143], a[28:31], v[188:191]
    ds_read_b64_tr_b16 a[12:13], v245 offset:16864
    ds_read_b64_tr_b16 a[14:15], v245 offset:17376
    v_cvt_pk_bf16_f32 v203, v182, v183
    s_waitcnt lgkmcnt(0)
    s_barrier
    v_mfma_f32_16x16x32_bf16 v[176:179], a[80:83], a[32:35], 0
    s_add_u32 s43, s86, 8
    s_and_b32 s43, s43, 15
    s_lshl_b32 s43, s43, 15
    v_exp_f32 v184, v184
    v_mfma_f32_16x16x32_bf16 v[176:179], a[84:87], a[36:39], v[176:179]
    s_add_u32 m0, s87, 100608
    ds_read_b128 v[144:147], v12 offset:0
    v_mfma_f32_16x16x32_bf16 v[176:179], a[88:91], a[40:43], v[176:179]
    buffer_load_dwordx4 v244, s[92:95], s43 offen offset:0 lds
    s_add_u32 m0, s87, 100640
    ds_read_b128 v[148:151], v12 offset:1024
    v_exp_f32 v185, v185
    v_mfma_f32_16x16x32_bf16 v[176:179], a[92:95], a[44:47], v[176:179]
    buffer_load_dwordx4 v244, s[92:95], s43 offen offset:1024 lds
    s_add_u32 m0, s87, 100672
    ds_read_b128 v[152:155], v12 offset:2048
    v_cvt_pk_bf16_f32 v204, v184, v185
    v_mfma_f32_16x16x32_bf16 v[32:35], a[160:163], v[192:195], v[32:35]
    buffer_load_dwordx4 v244, s[92:95], s43 offen offset:2048 lds
    s_add_u32 m0, s87, 100704
    ds_read_b128 v[156:159], v12 offset:3072
    v_exp_f32 v186, v186
    v_mfma_f32_16x16x32_bf16 v[32:35], a[192:195], v[196:199], v[32:35]
    buffer_load_dwordx4 v244, s[92:95], s43 offen offset:3072 lds
    s_add_u32 s43, s86, 9
    s_and_b32 s43, s43, 15
    s_lshl_b32 s43, s43, 15
    s_add_u32 m0, s87, 117376
    v_mfma_f32_16x16x32_bf16 v[36:39], a[196:199], v[196:199], v[36:39]
    ds_read_b128 v[160:163], v13 offset:0
    v_exp_f32 v187, v187
    v_mfma_f32_16x16x32_bf16 v[36:39], a[164:167], v[192:195], v[36:39]
    buffer_load_dwordx4 v244, s[92:95], s43 offen offset:0 lds
    s_add_u32 m0, s87, 117408
    ds_read_b128 v[164:167], v13 offset:1024
    v_cvt_pk_bf16_f32 v205, v186, v187
    v_mfma_f32_16x16x32_bf16 v[40:43], a[168:171], v[192:195], v[40:43]
    buffer_load_dwordx4 v244, s[92:95], s43 offen offset:1024 lds
    s_add_u32 m0, s87, 117440
    ds_read_b128 v[168:171], v13 offset:2048
    v_exp_f32 v188, v188
    v_mfma_f32_16x16x32_bf16 v[40:43], a[200:203], v[196:199], v[40:43]
    buffer_load_dwordx4 v244, s[92:95], s43 offen offset:2048 lds
    s_add_u32 m0, s87, 117472
    ds_read_b128 v[172:175], v13 offset:3072
    v_mfma_f32_16x16x32_bf16 v[44:47], a[204:207], v[196:199], v[44:47]
    buffer_load_dwordx4 v244, s[92:95], s43 offen offset:3072 lds
    ds_read_b32 v237, v10
    s_add_u32 s43, s86, 7
    v_exp_f32 v189, v189
    v_mfma_f32_16x16x32_bf16 v[44:47], a[172:175], v[192:195], v[44:47]
    s_and_b32 s43, s43, 15
    s_lshl_b32 s43, s43, 15
    s_add_u32 m0, s87, 16768
    v_cvt_pk_bf16_f32 v206, v188, v189
    v_smfmac_f32_16x16x64_bf16 a[208:211], a[228:231], v[192:199], v1
    buffer_load_dwordx4 v244, s[92:95], s43 offen offset:0 lds
    s_add_u32 m0, s87, 16800
    v_exp_f32 v190, v190
    v_mfma_f32_16x16x32_bf16 v[180:183], a[96:99], a[32:35], 0
    buffer_load_dwordx4 v244, s[92:95], s43 offen offset:1024 lds
    s_add_u32 m0, s87, 16832
    v_mfma_f32_16x16x32_bf16 v[180:183], a[100:103], a[36:39], v[180:183]
    buffer_load_dwordx4 v244, s[92:95], s43 offen offset:2048 lds
    s_add_u32 m0, s87, 16864
    v_exp_f32 v191, v191
    v_mfma_f32_16x16x32_bf16 v[180:183], a[104:107], a[40:43], v[180:183]
    buffer_load_dwordx4 v244, s[92:95], s43 offen offset:3072 lds
    s_waitcnt vmcnt(24)
    ds_read_b64_tr_b16 a[16:17], v245 offset:33536
    ds_read_b64_tr_b16 a[18:19], v245 offset:34048
    ds_read_b64_tr_b16 a[20:21], v245 offset:33568
    v_cvt_pk_bf16_f32 v207, v190, v191
    v_mfma_f32_16x16x32_bf16 v[180:183], a[108:111], a[44:47], v[180:183]
    ds_read_b64_tr_b16 a[22:23], v245 offset:34080
    ds_read_b64_tr_b16 a[24:25], v245 offset:33600
    ds_read_b64_tr_b16 a[26:27], v245 offset:34112
    ds_read_b64_tr_b16 a[28:29], v245 offset:33632
    ds_read_b64_tr_b16 a[30:31], v245 offset:34144
    v_mfma_f32_16x16x32_bf16 v[184:187], a[112:115], a[32:35], 0
    s_waitcnt lgkmcnt(8)
    s_lshr_b32 s42, s24, 1
    s_add_u32 s42, s42, 16
    s_lshl_b32 s42, s42, 17
    v_exp_f32 v176, v176
    v_mfma_f32_16x16x32_bf16 v[184:187], a[116:119], a[36:39], v[184:187]
    s_lshl_b32 s40, s25, 11
    s_add_u32 s42, s42, s40
    v_add_f32 v236, v236, v237
    v_rcp_f32 v236, v236
    v_add_f32 v144, v144, v160
    v_add_f32 v145, v145, v161
    v_mfma_f32_16x16x32_bf16 v[184:187], a[120:123], a[40:43], v[184:187]
    v_add_f32 v146, v146, v162
    v_add_f32 v147, v147, v163
    v_add_f32 v148, v148, v164
    v_add_f32 v149, v149, v165
    v_exp_f32 v177, v177
    v_mfma_f32_16x16x32_bf16 v[184:187], a[124:127], a[44:47], v[184:187]
    v_add_f32 v150, v150, v166
    v_add_f32 v151, v151, v167
    v_add_f32 v152, v152, v168
    v_add_f32 v153, v153, v169
    v_add_f32 v154, v154, v170
    v_cvt_pk_bf16_f32 v208, v176, v177
    v_mfma_f32_16x16x32_bf16 v[48:51], a[144:147], v[200:203], v[48:51]
    v_add_f32 v155, v155, v171
    v_add_f32 v156, v156, v172
    v_add_f32 v157, v157, v173
    v_add_f32 v158, v158, v174
    v_exp_f32 v178, v178
    v_mfma_f32_16x16x32_bf16 v[48:51], a[176:179], v[204:207], v[48:51]
    v_add_f32 v159, v159, v175
    v_mul_f32 v144, v144, v236
    v_mul_f32 v145, v145, v236
    v_mul_f32 v146, v146, v236
    v_mul_f32 v147, v147, v236
    v_mul_f32 v148, v148, v236
    v_mfma_f32_16x16x32_bf16 v[52:55], a[180:183], v[204:207], v[52:55]
    v_mul_f32 v149, v149, v236
    v_mul_f32 v150, v150, v236
    v_mul_f32 v151, v151, v236
    v_cvt_pk_bf16_f32 v144, v144, v145
    v_exp_f32 v179, v179
    v_mfma_f32_16x16x32_bf16 v[52:55], a[148:151], v[200:203], v[52:55]
    v_cvt_pk_bf16_f32 v145, v146, v147
    v_cvt_pk_bf16_f32 v146, v148, v149
    v_cvt_pk_bf16_f32 v147, v150, v151
    s_lshl_b32 s41, s24, 19
    s_add_u32 s41, s41, 0
    v_cvt_pk_bf16_f32 v209, v178, v179
    v_mfma_f32_16x16x32_bf16 v[56:59], a[152:155], v[200:203], v[56:59]
    v_accvgpr_read_b32 v250, a208
    v_accvgpr_read_b32 v251, a209
    v_add_f32 v250, v250, v251
    v_min_f32 v238, v238, v250
    v_exp_f32 v180, v180
    v_mfma_f32_16x16x32_bf16 v[56:59], a[184:187], v[204:207], v[56:59]
    v_max_f32 v241, v241, v250
    v_add_f32 v8, v8, v250
    v_rcp_f32 v250, v250
    s_nop 0
    v_mul_f32 v16, v16, v250
    v_mul_f32 v17, v17, v250
    v_mfma_f32_16x16x32_bf16 v[60:63], a[188:191], v[204:207], v[60:63]
    v_mul_f32 v18, v18, v250
    v_mul_f32 v19, v19, v250
    v_mul_f32 v20, v20, v250
    v_exp_f32 v181, v181
    v_mfma_f32_16x16x32_bf16 v[60:63], a[156:159], v[200:203], v[60:63]
    v_mul_f32 v21, v21, v250
    v_mul_f32 v22, v22, v250
    v_mul_f32 v23, v23, v250
    v_cvt_pk_bf16_f32 v16, v16, v17
    v_cvt_pk_bf16_f32 v210, v180, v181
    v_mfma_f32_16x16x32_bf16 v[188:191], a[128:131], a[32:35], 0
    v_cvt_pk_bf16_f32 v17, v18, v19
    v_exp_f32 v182, v182
    v_mfma_f32_16x16x32_bf16 v[188:191], a[132:135], a[36:39], v[188:191]
    buffer_store_dwordx4 v[144:147], v248, s[20:23], s42 offen offset:0 sc1
    v_mul_f32 v152, v152, v236
    v_mul_f32 v153, v153, v236
    v_mul_f32 v154, v154, v236
    v_mul_f32 v155, v155, v236
    v_mul_f32 v156, v156, v236
    v_mfma_f32_16x16x32_bf16 v[188:191], a[136:139], a[40:43], v[188:191]
    v_mul_f32 v157, v157, v236
    v_mul_f32 v158, v158, v236
    v_mul_f32 v159, v159, v236
    v_cvt_pk_bf16_f32 v152, v152, v153
    v_exp_f32 v183, v183
    v_mfma_f32_16x16x32_bf16 v[188:191], a[140:143], a[44:47], v[188:191]
    v_cvt_pk_bf16_f32 v153, v154, v155
    v_cvt_pk_bf16_f32 v154, v156, v157
    v_cvt_pk_bf16_f32 v155, v158, v159
    v_cvt_pk_bf16_f32 v211, v182, v183
    buffer_store_dwordx4 v[152:155], v248, s[20:23], s42 offen offset:1024 sc1
    v_mfma_f32_16x16x32_bf16 v[176:179], a[80:83], a[48:51], 0
    s_waitcnt vmcnt(22)
    ds_read_b64_tr_b16 a[32:33], v245 offset:50304
    v_cvt_pk_bf16_f32 v18, v20, v21
    v_exp_f32 v184, v184
    v_mfma_f32_16x16x32_bf16 v[176:179], a[84:87], a[52:55], v[176:179]
    ds_read_b64_tr_b16 a[34:35], v245 offset:50816
    v_cvt_pk_bf16_f32 v19, v22, v23
    v_mfma_f32_16x16x32_bf16 v[176:179], a[88:91], a[56:59], v[176:179]
    buffer_store_dwordx4 v[16:19], v248, s[20:23], s41 offen offset:0 sc1
    ds_read_b64_tr_b16 a[36:37], v245 offset:50336
    v_mul_f32 v24, v24, v250
    v_exp_f32 v185, v185
    v_mfma_f32_16x16x32_bf16 v[176:179], a[92:95], a[60:63], v[176:179]
    ds_read_b64_tr_b16 a[38:39], v245 offset:50848
    v_mul_f32 v25, v25, v250
    v_mul_f32 v26, v26, v250
    v_mul_f32 v27, v27, v250
    v_cvt_pk_bf16_f32 v212, v184, v185
    v_mfma_f32_16x16x32_bf16 v[64:67], a[160:163], v[200:203], v[64:67]
    ds_read_b64_tr_b16 a[40:41], v245 offset:50368
    v_mul_f32 v28, v28, v250
    v_mul_f32 v29, v29, v250
    v_exp_f32 v186, v186
    v_mfma_f32_16x16x32_bf16 v[64:67], a[192:195], v[204:207], v[64:67]
    ds_read_b64_tr_b16 a[42:43], v245 offset:50880
    v_mul_f32 v30, v30, v250
    v_mul_f32 v31, v31, v250
    v_cvt_pk_bf16_f32 v24, v24, v25
    v_cvt_pk_bf16_f32 v25, v26, v27
    v_mfma_f32_16x16x32_bf16 v[68:71], a[196:199], v[204:207], v[68:71]
    ds_read_b64_tr_b16 a[44:45], v245 offset:50400
    v_cvt_pk_bf16_f32 v26, v28, v29
    v_exp_f32 v187, v187
    v_mfma_f32_16x16x32_bf16 v[68:71], a[164:167], v[200:203], v[68:71]
    ds_read_b64_tr_b16 a[46:47], v245 offset:50912
    v_cvt_pk_bf16_f32 v27, v30, v31
    v_cvt_pk_bf16_f32 v213, v186, v187
    v_mfma_f32_16x16x32_bf16 v[72:75], a[168:171], v[200:203], v[72:75]
    buffer_store_dwordx4 v[24:27], v248, s[20:23], s41 offen offset:1024 sc1
    v_mul_f32 v32, v32, v250
    v_mul_f32 v33, v33, v250
    v_exp_f32 v188, v188
    v_mfma_f32_16x16x32_bf16 v[72:75], a[200:203], v[204:207], v[72:75]
    v_mul_f32 v34, v34, v250
    v_mul_f32 v35, v35, v250
    v_mul_f32 v36, v36, v250
    v_mul_f32 v37, v37, v250
    v_mfma_f32_16x16x32_bf16 v[76:79], a[204:207], v[204:207], v[76:79]
    v_mul_f32 v38, v38, v250
    v_mul_f32 v39, v39, v250
    v_exp_f32 v189, v189
    v_mfma_f32_16x16x32_bf16 v[76:79], a[172:175], v[200:203], v[76:79]
    v_cvt_pk_bf16_f32 v32, v32, v33
    v_cvt_pk_bf16_f32 v33, v34, v35
    v_cvt_pk_bf16_f32 v34, v36, v37
    v_cvt_pk_bf16_f32 v214, v188, v189
    v_smfmac_f32_16x16x64_bf16 a[212:215], a[228:231], v[200:207], v1
    v_cvt_pk_bf16_f32 v35, v38, v39
    v_exp_f32 v190, v190
    v_mfma_f32_16x16x32_bf16 v[180:183], a[96:99], a[48:51], 0
    buffer_store_dwordx4 v[32:35], v248, s[20:23], s41 offen offset:2048 sc1
    v_mul_f32 v40, v40, v250
    v_mul_f32 v41, v41, v250
    v_mul_f32 v42, v42, v250
    v_mul_f32 v43, v43, v250
    v_mfma_f32_16x16x32_bf16 v[180:183], a[100:103], a[52:55], v[180:183]
    v_mul_f32 v44, v44, v250
    v_mul_f32 v45, v45, v250
    v_exp_f32 v191, v191
    v_mfma_f32_16x16x32_bf16 v[180:183], a[104:107], a[56:59], v[180:183]
    v_mul_f32 v46, v46, v250
    v_mul_f32 v47, v47, v250
    v_cvt_pk_bf16_f32 v40, v40, v41
    v_cvt_pk_bf16_f32 v215, v190, v191
    v_mfma_f32_16x16x32_bf16 v[180:183], a[108:111], a[60:63], v[180:183]
    v_cvt_pk_bf16_f32 v41, v42, v43
    v_cvt_pk_bf16_f32 v42, v44, v45
    v_cvt_pk_bf16_f32 v43, v46, v47
    buffer_store_dwordx4 v[40:43], v248, s[20:23], s41 offen offset:3072 sc1
    v_mfma_f32_16x16x32_bf16 v[184:187], a[112:115], a[48:51], 0
    s_waitcnt vmcnt(22)
    ds_read_b64_tr_b16 a[80:81], v247 offset:0
    ds_read_b64_tr_b16 a[82:83], v247 offset:512
    v_exp_f32 v176, v176
    v_mfma_f32_16x16x32_bf16 v[184:187], a[116:119], a[52:55], v[184:187]
    ds_read_b64_tr_b16 a[84:85], v247 offset:32
    s_lshl_b32 s41, s24, 19
    s_add_u32 s41, s41, 131072
    v_accvgpr_read_b32 v252, a212
    v_accvgpr_read_b32 v253, a213
    v_mfma_f32_16x16x32_bf16 v[184:187], a[120:123], a[56:59], v[184:187]
    ds_read_b64_tr_b16 a[86:87], v247 offset:544
    v_add_f32 v252, v252, v253
    v_min_f32 v238, v238, v252
    v_exp_f32 v177, v177
    v_mfma_f32_16x16x32_bf16 v[184:187], a[124:127], a[60:63], v[184:187]
    ds_read_b64_tr_b16 a[88:89], v247 offset:64
    v_max_f32 v241, v241, v252
    v_add_f32 v8, v8, v252
    v_rcp_f32 v252, v252
    v_cvt_pk_bf16_f32 v216, v176, v177
    v_mfma_f32_16x16x32_bf16 v[80:83], a[144:147], v[208:211], v[80:83]
    ds_read_b64_tr_b16 a[90:91], v247 offset:576
    v_mul_f32 v48, v48, v252
    v_exp_f32 v178, v178
    v_mfma_f32_16x16x32_bf16 v[80:83], a[176:179], v[212:215], v[80:83]
    ds_read_b64_tr_b16 a[92:93], v247 offset:96
    v_mul_f32 v49, v49, v252
    v_mul_f32 v50, v50, v252
    v_mul_f32 v51, v51, v252
    v_mfma_f32_16x16x32_bf16 v[84:87], a[180:183], v[212:215], v[84:87]
    ds_read_b64_tr_b16 a[94:95], v247 offset:608
    v_mul_f32 v52, v52, v252
    v_exp_f32 v179, v179
    v_mfma_f32_16x16x32_bf16 v[84:87], a[148:151], v[208:211], v[84:87]
    s_waitcnt vmcnt(18)
    ds_read_b64_tr_b16 a[96:97], v245 offset:0
    v_mul_f32 v53, v53, v252
    v_cvt_pk_bf16_f32 v217, v178, v179
    v_mfma_f32_16x16x32_bf16 v[88:91], a[152:155], v[208:211], v[88:91]
    ds_read_b64_tr_b16 a[98:99], v245 offset:512
    v_mul_f32 v54, v54, v252
    v_exp_f32 v180, v180
    v_mfma_f32_16x16x32_bf16 v[88:91], a[184:187], v[212:215], v[88:91]
    ds_read_b64_tr_b16 a[100:101], v245 offset:32
    v_mul_f32 v55, v55, v252
    v_cvt_pk_bf16_f32 v48, v48, v49
    v_cvt_pk_bf16_f32 v49, v50, v51
    v_mfma_f32_16x16x32_bf16 v[92:95], a[188:191], v[212:215], v[92:95]
    ds_read_b64_tr_b16 a[102:103], v245 offset:544
    v_cvt_pk_bf16_f32 v50, v52, v53
    v_exp_f32 v181, v181
    v_mfma_f32_16x16x32_bf16 v[92:95], a[156:159], v[208:211], v[92:95]
    ds_read_b64_tr_b16 a[104:105], v245 offset:64
    v_cvt_pk_bf16_f32 v51, v54, v55
    v_cvt_pk_bf16_f32 v218, v180, v181
    v_mfma_f32_16x16x32_bf16 v[188:191], a[128:131], a[48:51], 0
    buffer_store_dwordx4 v[48:51], v248, s[20:23], s41 offen offset:0 sc1
    ds_read_b64_tr_b16 a[106:107], v245 offset:576
    v_mul_f32 v56, v56, v252
    v_exp_f32 v182, v182
    v_mfma_f32_16x16x32_bf16 v[188:191], a[132:135], a[52:55], v[188:191]
    ds_read_b64_tr_b16 a[108:109], v245 offset:96
    v_mul_f32 v57, v57, v252
    v_mul_f32 v58, v58, v252
    v_mul_f32 v59, v59, v252
    v_mfma_f32_16x16x32_bf16 v[188:191], a[136:139], a[56:59], v[188:191]
    ds_read_b64_tr_b16 a[110:111], v245 offset:608
    v_mul_f32 v60, v60, v252
    v_exp_f32 v183, v183
    v_mfma_f32_16x16x32_bf16 v[188:191], a[140:143], a[60:63], v[188:191]
    v_mul_f32 v61, v61, v252
    v_mul_f32 v62, v62, v252
    v_mul_f32 v63, v63, v252
    v_cvt_pk_bf16_f32 v219, v182, v183
    v_mfma_f32_16x16x32_bf16 v[96:99], a[160:163], v[208:211], v[96:99]
    s_waitcnt vmcnt(7)
    ds_read_b64_tr_b16 a[48:49], v245 offset:16768
    ds_read_b64_tr_b16 a[50:51], v245 offset:17280
    v_cvt_pk_bf16_f32 v56, v56, v57
    v_cvt_pk_bf16_f32 v57, v58, v59
    v_cvt_pk_bf16_f32 v58, v60, v61
    v_exp_f32 v184, v184
    v_mfma_f32_16x16x32_bf16 v[96:99], a[192:195], v[212:215], v[96:99]
    ds_read_b64_tr_b16 a[52:53], v245 offset:16800
    ds_read_b64_tr_b16 a[54:55], v245 offset:17312
    v_cvt_pk_bf16_f32 v59, v62, v63
    v_exp_f32 v185, v185
    v_mfma_f32_16x16x32_bf16 v[100:103], a[196:199], v[212:215], v[100:103]
    buffer_store_dwordx4 v[56:59], v248, s[20:23], s41 offen offset:1024 sc1
    ds_read_b64_tr_b16 a[56:57], v245 offset:16832
    ds_read_b64_tr_b16 a[58:59], v245 offset:17344
    v_mul_f32 v64, v64, v252
    v_mul_f32 v65, v65, v252
    v_exp_f32 v186, v186
    v_cvt_pk_bf16_f32 v220, v184, v185
    v_mfma_f32_16x16x32_bf16 v[100:103], a[164:167], v[208:211], v[100:103]
    ds_read_b64_tr_b16 a[60:61], v245 offset:16864
    ds_read_b64_tr_b16 a[62:63], v245 offset:17376
    v_mul_f32 v66, v66, v252
    v_mul_f32 v67, v67, v252
    v_mul_f32 v68, v68, v252
    v_mul_f32 v69, v69, v252
    v_exp_f32 v187, v187
    v_mfma_f32_16x16x32_bf16 v[104:107], a[168:171], v[208:211], v[104:107]
    ds_read_b64_tr_b16 a[112:113], v246 offset:33536
    ds_read_b64_tr_b16 a[114:115], v246 offset:34048
    v_mul_f32 v70, v70, v252
    v_mul_f32 v71, v71, v252
    v_exp_f32 v188, v188
    v_cvt_pk_bf16_f32 v221, v186, v187
    v_mfma_f32_16x16x32_bf16 v[104:107], a[200:203], v[212:215], v[104:107]
    ds_read_b64_tr_b16 a[116:117], v246 offset:33568
    ds_read_b64_tr_b16 a[118:119], v246 offset:34080
    v_cvt_pk_bf16_f32 v64, v64, v65
    v_cvt_pk_bf16_f32 v65, v66, v67
    v_cvt_pk_bf16_f32 v66, v68, v69
    v_cvt_pk_bf16_f32 v67, v70, v71
    v_exp_f32 v189, v189
    v_mfma_f32_16x16x32_bf16 v[108:111], a[204:207], v[212:215], v[108:111]
    buffer_store_dwordx4 v[64:67], v248, s[20:23], s41 offen offset:2048 sc1
    ds_read_b64_tr_b16 a[120:121], v246 offset:33600
    ds_read_b64_tr_b16 a[122:123], v246 offset:34112
    v_mul_f32 v72, v72, v252
    v_mul_f32 v73, v73, v252
    v_exp_f32 v190, v190
    v_cvt_pk_bf16_f32 v222, v188, v189
    v_mfma_f32_16x16x32_bf16 v[108:111], a[172:175], v[208:211], v[108:111]
    ds_read_b64_tr_b16 a[124:125], v246 offset:33632
    v_mul_f32 v74, v74, v252
    v_mul_f32 v75, v75, v252
    v_mul_f32 v76, v76, v252
    v_mul_f32 v77, v77, v252
    v_mul_f32 v78, v78, v252
    v_exp_f32 v191, v191
    v_smfmac_f32_16x16x64_bf16 a[216:219], a[228:231], v[208:215], v1
    ds_read_b64_tr_b16 a[126:127], v246 offset:34144
    v_mul_f32 v79, v79, v252
    v_cvt_pk_bf16_f32 v72, v72, v73
    v_cvt_pk_bf16_f32 v73, v74, v75
    v_cvt_pk_bf16_f32 v74, v76, v77
    v_cvt_pk_bf16_f32 v75, v78, v79
    buffer_store_dwordx4 v[72:75], v248, s[20:23], s41 offen offset:3072 sc1
    v_cvt_pk_bf16_f32 v223, v190, v191
    v_mfma_f32_16x16x32_bf16 v[112:115], a[144:147], v[216:219], v[112:115]
    ds_read_b64_tr_b16 a[128:129], v246 offset:50304
    ds_read_b64_tr_b16 a[130:131], v246 offset:50816
    s_lshl_b32 s41, s24, 19
    s_add_u32 s41, s41, 262144
    v_mfma_f32_16x16x32_bf16 v[112:115], a[176:179], v[220:223], v[112:115]
    ds_read_b64_tr_b16 a[132:133], v246 offset:50336
    v_accvgpr_read_b32 v254, a216
    v_accvgpr_read_b32 v255, a217
    v_add_f32 v254, v254, v255
    v_min_f32 v238, v238, v254
    v_mfma_f32_16x16x32_bf16 v[116:119], a[180:183], v[220:223], v[116:119]
    ds_read_b64_tr_b16 a[134:135], v246 offset:50848
    v_max_f32 v241, v241, v254
    v_add_f32 v8, v8, v254
    v_rcp_f32 v254, v254
    s_nop 0
    v_mul_f32 v80, v80, v254
    v_mfma_f32_16x16x32_bf16 v[116:119], a[148:151], v[216:219], v[116:119]
    ds_read_b64_tr_b16 a[136:137], v246 offset:50368
    v_mul_f32 v81, v81, v254
    v_mul_f32 v82, v82, v254
    v_mul_f32 v83, v83, v254
    v_mul_f32 v84, v84, v254
    v_mfma_f32_16x16x32_bf16 v[120:123], a[152:155], v[216:219], v[120:123]
    ds_read_b64_tr_b16 a[138:139], v246 offset:50880
    v_mul_f32 v85, v85, v254
    v_mul_f32 v86, v86, v254
    v_mul_f32 v87, v87, v254
    v_cvt_pk_bf16_f32 v80, v80, v81
    v_mfma_f32_16x16x32_bf16 v[120:123], a[184:187], v[220:223], v[120:123]
    ds_read_b64_tr_b16 a[140:141], v246 offset:50400
    v_cvt_pk_bf16_f32 v81, v82, v83
    v_cvt_pk_bf16_f32 v82, v84, v85
    v_cvt_pk_bf16_f32 v83, v86, v87
    v_mfma_f32_16x16x32_bf16 v[124:127], a[188:191], v[220:223], v[124:127]
    buffer_store_dwordx4 v[80:83], v248, s[20:23], s41 offen offset:0 sc1
    ds_read_b64_tr_b16 a[142:143], v246 offset:50912
    v_mul_f32 v88, v88, v254
    v_mul_f32 v89, v89, v254
    v_mul_f32 v90, v90, v254
    v_mfma_f32_16x16x32_bf16 v[124:127], a[156:159], v[216:219], v[124:127]
    v_mul_f32 v91, v91, v254
    v_mul_f32 v92, v92, v254
    v_mul_f32 v93, v93, v254
    v_mul_f32 v94, v94, v254
    v_mul_f32 v95, v95, v254
    v_mfma_f32_16x16x32_bf16 v[128:131], a[160:163], v[216:219], v[128:131]
    v_cvt_pk_bf16_f32 v88, v88, v89
    v_cvt_pk_bf16_f32 v89, v90, v91
    v_cvt_pk_bf16_f32 v90, v92, v93
    v_cvt_pk_bf16_f32 v91, v94, v95
    v_mfma_f32_16x16x32_bf16 v[128:131], a[192:195], v[220:223], v[128:131]
    buffer_store_dwordx4 v[88:91], v248, s[20:23], s41 offen offset:1024 sc1
    v_mul_f32 v96, v96, v254
    v_mul_f32 v97, v97, v254
    v_mul_f32 v98, v98, v254
    v_mfma_f32_16x16x32_bf16 v[132:135], a[196:199], v[220:223], v[132:135]
    v_mul_f32 v99, v99, v254
    v_mul_f32 v100, v100, v254
    v_mul_f32 v101, v101, v254
    v_mul_f32 v102, v102, v254
    v_mfma_f32_16x16x32_bf16 v[132:135], a[164:167], v[216:219], v[132:135]
    v_mul_f32 v103, v103, v254
    v_cvt_pk_bf16_f32 v96, v96, v97
    v_cvt_pk_bf16_f32 v97, v98, v99
    v_cvt_pk_bf16_f32 v98, v100, v101
    v_mfma_f32_16x16x32_bf16 v[136:139], a[168:171], v[216:219], v[136:139]
    v_cvt_pk_bf16_f32 v99, v102, v103
    v_mfma_f32_16x16x32_bf16 v[136:139], a[200:203], v[220:223], v[136:139]
    buffer_store_dwordx4 v[96:99], v248, s[20:23], s41 offen offset:2048 sc1
    v_mul_f32 v104, v104, v254
    v_mul_f32 v105, v105, v254
    v_mul_f32 v106, v106, v254
    v_mfma_f32_16x16x32_bf16 v[140:143], a[204:207], v[220:223], v[140:143]
    v_mul_f32 v107, v107, v254
    v_mul_f32 v108, v108, v254
    v_mul_f32 v109, v109, v254
    v_mul_f32 v110, v110, v254
    v_mfma_f32_16x16x32_bf16 v[140:143], a[172:175], v[216:219], v[140:143]
    v_mul_f32 v111, v111, v254
    v_cvt_pk_bf16_f32 v104, v104, v105
    v_cvt_pk_bf16_f32 v105, v106, v107
    v_smfmac_f32_16x16x64_bf16 a[220:223], a[228:231], v[216:223], v1
    v_cvt_pk_bf16_f32 v106, v108, v109
    v_cvt_pk_bf16_f32 v107, v110, v111
    buffer_store_dwordx4 v[104:107], v248, s[20:23], s41 offen offset:3072 sc1
    s_lshl_b32 s41, s24, 19
    s_add_u32 s41, s41, 393216
    s_nop 2
    v_accvgpr_read_b32 v242, a220
    v_accvgpr_read_b32 v243, a221
    v_add_f32 v242, v242, v243
    v_min_f32 v238, v238, v242
    v_max_f32 v241, v241, v242
    v_add_f32 v8, v8, v242
    v_rcp_f32 v242, v242
    s_nop 0
    v_pk_mul_f32 v[112:113], v[112:113], v[242:243] op_sel_hi:[1,0]
    v_pk_mul_f32 v[114:115], v[114:115], v[242:243] op_sel_hi:[1,0]
    v_pk_mul_f32 v[116:117], v[116:117], v[242:243] op_sel_hi:[1,0]
    v_pk_mul_f32 v[118:119], v[118:119], v[242:243] op_sel_hi:[1,0]
    v_cvt_pk_bf16_f32 v112, v112, v113
    v_cvt_pk_bf16_f32 v113, v114, v115
    v_cvt_pk_bf16_f32 v114, v116, v117
    v_cvt_pk_bf16_f32 v115, v118, v119
    buffer_store_dwordx4 v[112:115], v248, s[20:23], s41 offen offset:0 sc1
    v_pk_mul_f32 v[120:121], v[120:121], v[242:243] op_sel_hi:[1,0]
    v_pk_mul_f32 v[122:123], v[122:123], v[242:243] op_sel_hi:[1,0]
    v_pk_mul_f32 v[124:125], v[124:125], v[242:243] op_sel_hi:[1,0]
    v_pk_mul_f32 v[126:127], v[126:127], v[242:243] op_sel_hi:[1,0]
    v_cvt_pk_bf16_f32 v120, v120, v121
    v_cvt_pk_bf16_f32 v121, v122, v123
    v_cvt_pk_bf16_f32 v122, v124, v125
    v_cvt_pk_bf16_f32 v123, v126, v127
    buffer_store_dwordx4 v[120:123], v248, s[20:23], s41 offen offset:1024 sc1
    v_pk_mul_f32 v[128:129], v[128:129], v[242:243] op_sel_hi:[1,0]
    v_pk_mul_f32 v[130:131], v[130:131], v[242:243] op_sel_hi:[1,0]
    v_pk_mul_f32 v[132:133], v[132:133], v[242:243] op_sel_hi:[1,0]
    v_pk_mul_f32 v[134:135], v[134:135], v[242:243] op_sel_hi:[1,0]
    v_cvt_pk_bf16_f32 v128, v128, v129
    v_cvt_pk_bf16_f32 v129, v130, v131
    v_cvt_pk_bf16_f32 v130, v132, v133
    v_cvt_pk_bf16_f32 v131, v134, v135
    buffer_store_dwordx4 v[128:131], v248, s[20:23], s41 offen offset:2048 sc1
    v_pk_mul_f32 v[136:137], v[136:137], v[242:243] op_sel_hi:[1,0]
    v_pk_mul_f32 v[138:139], v[138:139], v[242:243] op_sel_hi:[1,0]
    v_pk_mul_f32 v[140:141], v[140:141], v[242:243] op_sel_hi:[1,0]
    v_pk_mul_f32 v[142:143], v[142:143], v[242:243] op_sel_hi:[1,0]
    v_cvt_pk_bf16_f32 v136, v136, v137
    v_cvt_pk_bf16_f32 v137, v138, v139
    v_cvt_pk_bf16_f32 v138, v140, v141
    v_cvt_pk_bf16_f32 v139, v142, v143
    buffer_store_dwordx4 v[136:139], v248, s[20:23], s41 offen offset:3072 sc1
    s_waitcnt lgkmcnt(0)
    v_cmp_lt_f32 vcc, 0x2b800000, v238
    s_nop 1
    s_mov_b64 s[42:43], vcc
    v_cmp_gt_f32 vcc, 0x53800000, v241
    s_nop 1
    s_and_b64 s[42:43], s[42:43], vcc
    v_cmp_eq_f32 vcc, v8, v8
    s_nop 1
    s_and_b64 s[42:43], s[42:43], vcc
    s_cmp_eq_u64 s[42:43], -1
    s_cselect_b32 s42, 0, 1
    s_lshl_b32 s43, s24, 2
    s_add_u32 s43, s43, 163584
    v_mov_b32 v11, s43
    v_mov_b32 v12, s42
    ds_write_b32 v11, v12
    v_mov_b32 v11, 163584
    s_lshl_b32 s40, s88, 5
    s_lshl_b32 s41, s84, 4
    s_add_u32 s40, s40, s41
    s_lshl_b32 s41, s24, 2
    s_add_u32 s40, s40, s41
    s_lshl_b32 s40, s40, 7
    s_add_u32 s40, s40, 41943040
    v_and_b32 v1, 3, v0
    v_lshlrev_b32 v1, 7, v1
    v_add_u32 v1, s40, v1
    s_lshl_b32 s40, s26, 5
    s_add_u32 s40, s40, s27
    s_lshl_b32 s40, s40, 7
    s_add_u32 s40, s40, 41943040
    v_cmp_eq_u32 vcc, 0, v14
    v_mov_b32 v8, s40
    v_mov_b32 v7, 0x7ffffff0
    v_cndmask_b32 v8, v7, v8, vcc
    s_mul_i32 s40, s88, 2359296
    s_add_u32 s44, s58, s40
    s_addc_u32 s45, s59, 0
    s_mov_b32 s46, 2359296
    s_mov_b32 s47, 0x20000
    s_add_u32 s40, s89, 0
    s_lshl_b32 s28, s40, 17
    s_add_u32 s40, s90, 0
    s_lshl_b32 s16, s40, 17
    s_add_u32 s40, s89, 1
    s_lshl_b32 s29, s40, 17
    s_add_u32 s40, s90, 1
    s_lshl_b32 s17, s40, 17
    s_add_u32 s40, s89, 2
    s_lshl_b32 s30, s40, 17
    s_add_u32 s40, s90, 2
    s_lshl_b32 s18, s40, 17
    s_add_u32 s40, s89, 3
    s_lshl_b32 s31, s40, 17
    s_add_u32 s40, s90, 3
    s_lshl_b32 s19, s40, 17
    s_min_u32 s40, s89, s90
    s_add_u32 s40, s40, 4
    s_lshl_b32 s32, s40, 17
    s_waitcnt vmcnt(0) lgkmcnt(0)
    s_barrier
    ds_read_b128 v[4:7], v11
    s_waitcnt lgkmcnt(0)
    v_or3_b32 v4, v4, v5, v6
    v_or_b32 v4, v4, v7
    s_nop 0
    v_readfirstlane_b32 s42, v4
    s_nop 1
    s_cmp_lg_u32 s42, 0
    s_cbranch_scc1 L_safe
    buffer_store_dword v15, v8, s[96:99], 0 offen sc1
    s_add_u32 s43, s86, 10
    s_and_b32 s43, s43, 15
    s_lshl_b32 s43, s43, 15
    s_add_u32 m0, s87, 33536
    s_nop 0
    buffer_load_dwordx4 v244, s[92:95], s43 offen offset:0 lds
    s_add_u32 m0, s87, 33568
    s_nop 0
    buffer_load_dwordx4 v244, s[92:95], s43 offen offset:1024 lds
    s_add_u32 m0, s87, 33600
    s_nop 0
    buffer_load_dwordx4 v244, s[92:95], s43 offen offset:2048 lds
    s_add_u32 m0, s87, 33632
    s_nop 0
    buffer_load_dwordx4 v244, s[92:95], s43 offen offset:3072 lds
    s_add_u32 s43, s86, 11
    s_and_b32 s43, s43, 15
    s_lshl_b32 s43, s43, 15
    s_add_u32 m0, s87, 50304
    s_nop 0
    buffer_load_dwordx4 v244, s[92:95], s43 offen offset:0 lds
    s_add_u32 m0, s87, 50336
    s_nop 0
    buffer_load_dwordx4 v244, s[92:95], s43 offen offset:1024 lds
    s_add_u32 m0, s87, 50368
    s_nop 0
    buffer_load_dwordx4 v244, s[92:95], s43 offen offset:2048 lds
    s_add_u32 m0, s87, 50400
    s_nop 0
    buffer_load_dwordx4 v244, s[92:95], s43 offen offset:3072 lds
    s_add_u32 s43, s86, 12
    s_and_b32 s43, s43, 15
    s_lshl_b32 s43, s43, 15
    s_add_u32 m0, s87, 134400
    s_nop 0
    buffer_load_dwordx4 v244, s[92:95], s43 offen offset:0 lds
    s_add_u32 m0, s87, 134432
    s_nop 0
    buffer_load_dwordx4 v244, s[92:95], s43 offen offset:1024 lds
    s_add_u32 m0, s87, 134464
    s_nop 0
    buffer_load_dwordx4 v244, s[92:95], s43 offen offset:2048 lds
    s_add_u32 m0, s87, 134496
    s_nop 0
    buffer_load_dwordx4 v244, s[92:95], s43 offen offset:3072 lds
    s_add_u32 s43, s86, 13
    s_and_b32 s43, s43, 15
    s_lshl_b32 s43, s43, 15
    s_add_u32 m0, s87, 0
    s_nop 0
    buffer_load_dwordx4 v244, s[92:95], s43 offen offset:0 lds
    s_add_u32 m0, s87, 32
    s_nop 0
    buffer_load_dwordx4 v244, s[92:95], s43 offen offset:1024 lds
    s_add_u32 m0, s87, 64
    s_nop 0
    buffer_load_dwordx4 v244, s[92:95], s43 offen offset:2048 lds
    s_add_u32 m0, s87, 96
    s_nop 0
    buffer_load_dwordx4 v244, s[92:95], s43 offen offset:3072 lds
    s_add_u32 s43, s86, 14
    s_and_b32 s43, s43, 15
    s_lshl_b32 s43, s43, 15
    s_add_u32 m0, s87, 16768
    s_nop 0
    buffer_load_dwordx4 v244, s[92:95], s43 offen offset:0 lds
    s_add_u32 m0, s87, 16800
    s_nop 0
    buffer_load_dwordx4 v244, s[92:95], s43 offen offset:1024 lds
    s_add_u32 m0, s87, 16832
    s_nop 0
    buffer_load_dwordx4 v244, s[92:95], s43 offen offset:2048 lds
    s_add_u32 m0, s87, 16864
    s_nop 0
    buffer_load_dwordx4 v244, s[92:95], s43 offen offset:3072 lds
    s_add_u32 s43, s86, 15
    s_and_b32 s43, s43, 15
    s_lshl_b32 s43, s43, 15
    s_add_u32 m0, s87, 100608
    s_nop 0
    buffer_load_dwordx4 v244, s[92:95], s43 offen offset:0 lds
    s_add_u32 m0, s87, 100640
    s_nop 0
    buffer_load_dwordx4 v244, s[92:95], s43 offen offset:1024 lds
    s_add_u32 m0, s87, 100672
    s_nop 0
    buffer_load_dwordx4 v244, s[92:95], s43 offen offset:2048 lds
    s_add_u32 m0, s87, 100704
    s_nop 0
    buffer_load_dwordx4 v244, s[92:95], s43 offen offset:3072 lds
    s_add_u32 s40, s86, 0
    s_and_b32 s40, s40, 15
    s_lshl_b32 s40, s40, 10
    v_add_u32 v241, s40, v240
    s_add_u32 s40, s86, 2
    s_and_b32 s40, s40, 15
    s_lshl_b32 s40, s40, 10
    v_add_u32 v242, s40, v240
    s_xor_b32 s40, s24, 1
    s_mul_i32 s42, s40, 15360
    s_add_u32 s42, s42, 0
    v_add_u32 v4, s42, v248
    s_mul_i32 s42, s40, 12288
    s_add_u32 s42, s42, 61440
    v_add_u32 v7, s42, v248
    s_xor_b32 s40, s24, 2
    s_mul_i32 s42, s40, 15360
    s_add_u32 s42, s42, 5120
    v_add_u32 v5, s42, v248
    s_mul_i32 s42, s40, 12288
    s_add_u32 s42, s42, 65536
    v_add_u32 v8, s42, v248
    s_xor_b32 s40, s24, 3
    s_mul_i32 s42, s40, 15360
    s_add_u32 s42, s42, 10240
    v_add_u32 v6, s42, v248
    s_mul_i32 s42, s40, 12288
    s_add_u32 s42, s42, 69632
    v_add_u32 v9, s42, v248
    s_mul_i32 s42, s24, 15360
    v_add_u32 v10, s42, v248
    s_mul_i32 s42, s24, 12288
    s_add_u32 s42, s42, 61440
    v_add_u32 v11, s42, v248
L_poll:
    s_mov_b32 s41, 0x40000
L_p0:
    v_cmp_le_u32 vcc, 0x100, v249
    s_nop 1
    s_cbranch_vccnz L_p1
    buffer_load_dword v249, v239, s[80:83], 0 offen sc1
    s_sleep 2
    s_sub_u32 s41, s41, 1
    s_cmp_lg_u32 s41, 0
    s_waitcnt vmcnt(0)
    s_cbranch_scc1 L_p0
L_p1:
    buffer_load_dword v12, v1, s[96:99], 0 offen sc1
    s_waitcnt vmcnt(21)
    ds_read_b64_tr_b16 a[144:145], v245 offset:33536
    ds_read_b64_tr_b16 a[146:147], v245 offset:34048
    ds_read_b64_tr_b16 a[148:149], v245 offset:33568
    ds_read_b64_tr_b16 a[150:151], v245 offset:34080
    ds_read_b64_tr_b16 a[152:153], v245 offset:33600
    ds_read_b64_tr_b16 a[154:155], v245 offset:34112
    ds_read_b64_tr_b16 a[156:157], v245 offset:33632
    ds_read_b64_tr_b16 a[158:159], v245 offset:34144
    s_waitcnt vmcnt(17)
    ds_read_b64_tr_b16 a[160:161], v245 offset:50304
    ds_read_b64_tr_b16 a[162:163], v245 offset:50816
    ds_read_b64_tr_b16 a[164:165], v245 offset:50336
    ds_read_b64_tr_b16 a[166:167], v245 offset:50848
    ds_read_b64_tr_b16 a[168:169], v245 offset:50368
    ds_read_b64_tr_b16 a[170:171], v245 offset:50880
    ds_read_b64_tr_b16 a[172:173], v245 offset:50400
    ds_read_b64_tr_b16 a[174:175], v245 offset:50912
    s_waitcnt vmcnt(13)
    ds_read_b64_tr_b16 a[176:177], v247 offset:0
    ds_read_b64_tr_b16 a[178:179], v247 offset:512
    ds_read_b64_tr_b16 a[180:181], v247 offset:32
    ds_read_b64_tr_b16 a[182:183], v247 offset:544
    ds_read_b64_tr_b16 a[184:185], v247 offset:64
    ds_read_b64_tr_b16 a[186:187], v247 offset:576
    ds_read_b64_tr_b16 a[188:189], v247 offset:96
    ds_read_b64_tr_b16 a[190:191], v247 offset:608
    s_waitcnt vmcnt(9)
    ds_read_b64_tr_b16 a[192:193], v245 offset:0
    ds_read_b64_tr_b16 a[194:195], v245 offset:512
    ds_read_b64_tr_b16 a[196:197], v245 offset:32
    ds_read_b64_tr_b16 a[198:199], v245 offset:544
    ds_read_b64_tr_b16 a[200:201], v245 offset:64
    ds_read_b64_tr_b16 a[202:203], v245 offset:576
    ds_read_b64_tr_b16 a[204:205], v245 offset:96
    ds_read_b64_tr_b16 a[206:207], v245 offset:608
    s_waitcnt vmcnt(5)
    ds_read_b64_tr_b16 a[208:209], v245 offset:16768
    ds_read_b64_tr_b16 a[210:211], v245 offset:17280
    ds_read_b64_tr_b16 a[212:213], v245 offset:16800
    ds_read_b64_tr_b16 a[214:215], v245 offset:17312
    ds_read_b64_tr_b16 a[216:217], v245 offset:16832
    ds_read_b64_tr_b16 a[218:219], v245 offset:17344
    ds_read_b64_tr_b16 a[220:221], v245 offset:16864
    ds_read_b64_tr_b16 a[222:223], v245 offset:17376
    s_waitcnt vmcnt(1)
    ds_read_b64_tr_b16 a[224:225], v246 offset:33536
    ds_read_b64_tr_b16 a[226:227], v246 offset:34048
    ds_read_b64_tr_b16 a[228:229], v246 offset:33568
    ds_read_b64_tr_b16 a[230:231], v246 offset:34080
    ds_read_b64_tr_b16 a[232:233], v246 offset:33600
    ds_read_b64_tr_b16 a[234:235], v246 offset:34112
    ds_read_b64_tr_b16 a[236:237], v246 offset:33632
    ds_read_b64_tr_b16 a[238:239], v246 offset:34144
    s_waitcnt lgkmcnt(0)
    s_barrier
L_p2:
    s_waitcnt vmcnt(0)
    v_cmp_ne_u32 vcc, 1, v12
    s_nop 1
    s_cbranch_vccz L_p3
    s_sleep 1
    buffer_load_dword v12, v1, s[96:99], 0 offen sc1
    s_sub_u32 s41, s41, 1
    s_cmp_gt_i32 s41, 0
    s_cbranch_scc1 L_p2
    s_waitcnt vmcnt(0)
L_p3:
    buffer_load_dwordx4 v[160:163], v241, s[44:47], s28 offen offset:0 sc1
    buffer_load_dwordx4 v[164:167], v241, s[44:47], s28 offen offset:1024 sc1
    buffer_load_dwordx4 v[168:171], v242, s[44:47], s28 offen offset:0 sc1
    buffer_load_dwordx4 v[172:175], v242, s[44:47], s28 offen offset:1024 sc1
    buffer_load_dwordx4 v[176:179], v241, s[44:47], s29 offen offset:0 sc1
    buffer_load_dwordx4 v[180:183], v241, s[44:47], s29 offen offset:1024 sc1
    buffer_load_dwordx4 v[184:187], v242, s[44:47], s29 offen offset:0 sc1
    buffer_load_dwordx4 v[188:191], v242, s[44:47], s29 offen offset:1024 sc1
    buffer_load_dwordx4 v[192:195], v241, s[44:47], s30 offen offset:0 sc1
    buffer_load_dwordx4 v[196:199], v241, s[44:47], s30 offen offset:1024 sc1
    buffer_load_dwordx4 v[200:203], v242, s[44:47], s30 offen offset:0 sc1
    buffer_load_dwordx4 v[204:207], v242, s[44:47], s30 offen offset:1024 sc1
    buffer_load_dwordx4 v[208:211], v241, s[44:47], s31 offen offset:0 sc1
    buffer_load_dwordx4 v[212:215], v241, s[44:47], s31 offen offset:1024 sc1
    buffer_load_dwordx4 v[216:219], v242, s[44:47], s31 offen offset:0 sc1
    buffer_load_dwordx4 v[220:223], v242, s[44:47], s31 offen offset:1024 sc1
L_go:
    s_lshl_b32 s41, s2, 2
    s_add_u32 s41, s41, s24
    s_mul_i32 s33, s41, 5120
    s_add_u32 s33, s33, 33554432
    s_add_u32 s34, s33, 4096
    s_lshl_b32 s42, s41, 7
    s_add_u32 s42, s42, 42008576
    v_cmp_eq_u32 vcc, 0, v0
    v_mov_b32 v12, s42
    v_mov_b32 v13, 0x7ffffff0
    v_cndmask_b32 v13, v13, v12, vcc
    s_xor_b32 s41, s41, 10
    s_mul_i32 s35, s41, 5120
    s_add_u32 s35, s35, 33554432
    s_add_u32 s36, s35, 4096
    s_lshl_b32 s42, s41, 7
    s_add_u32 s42, s42, 42008576
    v_mov_b32 v1, s42
    v_lshlrev_b32 v12, 10, v2
    v_lshl_add_u32 v12, v3, 3, v12
    s_lshl_b32 s41, s84, 1
    s_xor_b32 s41, s41, s24
    s_lshl_b32 s41, s41, 5
    s_lshl_b32 s42, s85, 7
    s_add_u32 s41, s41, s42
    v_add_u32 v12, s41, v12
    s_lshr_b32 s37, s32, 3
    s_cmp_ge_u32 s24, 2
    s_cselect_b32 s37, 0x100000, s37
    s_add_u32 s40, s86, 4
    s_and_b32 s40, s40, 15
    s_lshl_b32 s40, s40, 10
    v_add_u32 v243, s40, v240
    s_add_u32 s40, s86, 6
    s_and_b32 s40, s40, 15
    s_lshl_b32 s40, s40, 10
    v_add_u32 v249, s40, v240
    s_mul_i32 s41, s88, 294912
    s_add_u32 s4, s54, s41
    s_addc_u32 s5, s55, 0
    s_mov_b32 s6, 294912
    s_mov_b32 s7, 0x20000
    s_waitcnt vmcnt(12)
    v_mfma_f32_16x16x32_bf16 v[16:19], a[240:243], v[160:163], 0
    buffer_load_dwordx4 v[224:227], v241, s[44:47], s32 offen offset:0 sc1
    v_mfma_f32_16x16x32_bf16 v[16:19], a[64:67], v[164:167], v[16:19]
    v_mfma_f32_16x16x32_bf16 v[16:19], a[0:3], v[168:171], v[16:19]
    v_mfma_f32_16x16x32_bf16 v[16:19], a[16:19], v[172:175], v[16:19]
    v_mfma_f32_16x16x32_bf16 v[20:23], a[20:23], v[172:175], 0
    buffer_load_dwordx4 v[228:231], v241, s[44:47], s32 offen offset:1024 sc1
    v_mfma_f32_16x16x32_bf16 v[20:23], a[4:7], v[168:171], v[20:23]
    v_mfma_f32_16x16x32_bf16 v[20:23], a[68:71], v[164:167], v[20:23]
    v_mfma_f32_16x16x32_bf16 v[20:23], a[244:247], v[160:163], v[20:23]
    v_mfma_f32_16x16x32_bf16 v[24:27], a[248:251], v[160:163], 0
    buffer_load_dwordx4 v[232:235], v242, s[44:47], s32 offen offset:0 sc1
    v_mfma_f32_16x16x32_bf16 v[24:27], a[72:75], v[164:167], v[24:27]
    v_mfma_f32_16x16x32_bf16 v[24:27], a[8:11], v[168:171], v[24:27]
    v_mfma_f32_16x16x32_bf16 v[24:27], a[24:27], v[172:175], v[24:27]
    v_mfma_f32_16x16x32_bf16 v[28:31], a[28:31], v[172:175], 0
    buffer_load_dwordx4 v[236:239], v242, s[44:47], s32 offen offset:1024 sc1
    v_mfma_f32_16x16x32_bf16 v[28:31], a[12:15], v[168:171], v[28:31]
    v_mfma_f32_16x16x32_bf16 v[28:31], a[76:79], v[164:167], v[28:31]
    v_mfma_f32_16x16x32_bf16 v[28:31], a[252:255], v[160:163], v[28:31]
    s_waitcnt vmcnt(12)
    v_mfma_f32_16x16x32_bf16 v[32:35], a[240:243], v[176:179], 0
    buffer_load_dwordx4 v[160:163], v243, s[44:47], s28 offen offset:0 sc1
    v_mfma_f32_16x16x32_bf16 v[32:35], a[64:67], v[180:183], v[32:35]
    v_mfma_f32_16x16x32_bf16 v[32:35], a[0:3], v[184:187], v[32:35]
    v_mfma_f32_16x16x32_bf16 v[32:35], a[16:19], v[188:191], v[32:35]
    v_mfma_f32_16x16x32_bf16 v[36:39], a[20:23], v[188:191], 0
    buffer_load_dwordx4 v[164:167], v243, s[44:47], s28 offen offset:1024 sc1
    v_mfma_f32_16x16x32_bf16 v[36:39], a[4:7], v[184:187], v[36:39]
    v_mfma_f32_16x16x32_bf16 v[36:39], a[68:71], v[180:183], v[36:39]
    v_mfma_f32_16x16x32_bf16 v[36:39], a[244:247], v[176:179], v[36:39]
    v_mfma_f32_16x16x32_bf16 v[40:43], a[248:251], v[176:179], 0
    buffer_load_dwordx4 v[168:171], v249, s[44:47], s28 offen offset:0 sc1
    v_mfma_f32_16x16x32_bf16 v[40:43], a[72:75], v[180:183], v[40:43]
    v_mfma_f32_16x16x32_bf16 v[40:43], a[8:11], v[184:187], v[40:43]
    v_mfma_f32_16x16x32_bf16 v[40:43], a[24:27], v[188:191], v[40:43]
    v_mfma_f32_16x16x32_bf16 v[44:47], a[28:31], v[188:191], 0
    buffer_load_dwordx4 v[172:175], v249, s[44:47], s28 offen offset:1024 sc1
    v_mfma_f32_16x16x32_bf16 v[44:47], a[12:15], v[184:187], v[44:47]
    v_mfma_f32_16x16x32_bf16 v[44:47], a[76:79], v[180:183], v[44:47]
    v_mfma_f32_16x16x32_bf16 v[44:47], a[252:255], v[176:179], v[44:47]
    s_waitcnt vmcnt(12)
    v_mfma_f32_16x16x32_bf16 v[48:51], a[240:243], v[192:195], 0
    buffer_load_dwordx4 v[176:179], v243, s[44:47], s29 offen offset:0 sc1
    v_mfma_f32_16x16x32_bf16 v[48:51], a[64:67], v[196:199], v[48:51]
    v_mfma_f32_16x16x32_bf16 v[48:51], a[0:3], v[200:203], v[48:51]
    v_mfma_f32_16x16x32_bf16 v[48:51], a[16:19], v[204:207], v[48:51]
    v_mfma_f32_16x16x32_bf16 v[52:55], a[20:23], v[204:207], 0
    buffer_load_dwordx4 v[180:183], v243, s[44:47], s29 offen offset:1024 sc1
    v_mfma_f32_16x16x32_bf16 v[52:55], a[4:7], v[200:203], v[52:55]
    v_mfma_f32_16x16x32_bf16 v[52:55], a[68:71], v[196:199], v[52:55]
    v_mfma_f32_16x16x32_bf16 v[52:55], a[244:247], v[192:195], v[52:55]
    v_mfma_f32_16x16x32_bf16 v[56:59], a[248:251], v[192:195], 0
    buffer_load_dwordx4 v[184:187], v249, s[44:47], s29 offen offset:0 sc1
    v_mfma_f32_16x16x32_bf16 v[56:59], a[72:75], v[196:199], v[56:59]
    v_mfma_f32_16x16x32_bf16 v[56:59], a[8:11], v[200:203], v[56:59]
    v_mfma_f32_16x16x32_bf16 v[56:59], a[24:27], v[204:207], v[56:59]
    v_mfma_f32_16x16x32_bf16 v[60:63], a[28:31], v[204:207], 0
    buffer_load_dwordx4 v[188:191], v249, s[44:47], s29 offen offset:1024 sc1
    v_mfma_f32_16x16x32_bf16 v[60:63], a[12:15], v[200:203], v[60:63]
    v_mfma_f32_16x16x32_bf16 v[60:63], a[76:79], v[196:199], v[60:63]
    v_mfma_f32_16x16x32_bf16 v[60:63], a[252:255], v[192:195], v[60:63]
    s_waitcnt vmcnt(12)
    v_mfma_f32_16x16x32_bf16 v[64:67], a[240:243], v[208:211], 0
    buffer_load_dwordx4 v[192:195], v243, s[44:47], s30 offen offset:0 sc1
    v_mfma_f32_16x16x32_bf16 v[64:67], a[64:67], v[212:215], v[64:67]
    v_mfma_f32_16x16x32_bf16 v[64:67], a[0:3], v[216:219], v[64:67]
    v_mfma_f32_16x16x32_bf16 v[64:67], a[16:19], v[220:223], v[64:67]
    v_mfma_f32_16x16x32_bf16 v[68:71], a[20:23], v[220:223], 0
    buffer_load_dwordx4 v[196:199], v243, s[44:47], s30 offen offset:1024 sc1
    v_mfma_f32_16x16x32_bf16 v[68:71], a[4:7], v[216:219], v[68:71]
    v_mfma_f32_16x16x32_bf16 v[68:71], a[68:71], v[212:215], v[68:71]
    v_mfma_f32_16x16x32_bf16 v[68:71], a[244:247], v[208:211], v[68:71]
    v_mfma_f32_16x16x32_bf16 v[72:75], a[248:251], v[208:211], 0
    buffer_load_dwordx4 v[200:203], v249, s[44:47], s30 offen offset:0 sc1
    v_mfma_f32_16x16x32_bf16 v[72:75], a[72:75], v[212:215], v[72:75]
    v_mfma_f32_16x16x32_bf16 v[72:75], a[8:11], v[216:219], v[72:75]
    v_mfma_f32_16x16x32_bf16 v[72:75], a[24:27], v[220:223], v[72:75]
    v_mfma_f32_16x16x32_bf16 v[76:79], a[28:31], v[220:223], 0
    buffer_load_dwordx4 v[204:207], v249, s[44:47], s30 offen offset:1024 sc1
    v_mfma_f32_16x16x32_bf16 v[76:79], a[12:15], v[216:219], v[76:79]
    v_mfma_f32_16x16x32_bf16 v[76:79], a[76:79], v[212:215], v[76:79]
    v_mfma_f32_16x16x32_bf16 v[76:79], a[252:255], v[208:211], v[76:79]
    s_waitcnt vmcnt(12)
    v_mfma_f32_16x16x32_bf16 v[80:83], a[240:243], v[224:227], 0
    buffer_load_dwordx4 v[208:211], v243, s[44:47], s31 offen offset:0 sc1
    v_mfma_f32_16x16x32_bf16 v[80:83], a[64:67], v[228:231], v[80:83]
    v_mfma_f32_16x16x32_bf16 v[80:83], a[0:3], v[232:235], v[80:83]
    v_mfma_f32_16x16x32_bf16 v[80:83], a[16:19], v[236:239], v[80:83]
    v_mfma_f32_16x16x32_bf16 v[84:87], a[20:23], v[236:239], 0
    buffer_load_dwordx4 v[212:215], v243, s[44:47], s31 offen offset:1024 sc1
    v_mfma_f32_16x16x32_bf16 v[84:87], a[4:7], v[232:235], v[84:87]
    v_mfma_f32_16x16x32_bf16 v[84:87], a[68:71], v[228:231], v[84:87]
    v_mfma_f32_16x16x32_bf16 v[84:87], a[244:247], v[224:227], v[84:87]
    v_mfma_f32_16x16x32_bf16 v[88:91], a[248:251], v[224:227], 0
    buffer_load_dwordx4 v[216:219], v249, s[44:47], s31 offen offset:0 sc1
    v_mfma_f32_16x16x32_bf16 v[88:91], a[72:75], v[228:231], v[88:91]
    v_mfma_f32_16x16x32_bf16 v[88:91], a[8:11], v[232:235], v[88:91]
    v_mfma_f32_16x16x32_bf16 v[88:91], a[24:27], v[236:239], v[88:91]
    v_mfma_f32_16x16x32_bf16 v[92:95], a[28:31], v[236:239], 0
    buffer_load_dwordx4 v[220:223], v249, s[44:47], s31 offen offset:1024 sc1
    v_mfma_f32_16x16x32_bf16 v[92:95], a[12:15], v[232:235], v[92:95]
    v_mfma_f32_16x16x32_bf16 v[92:95], a[76:79], v[228:231], v[92:95]
    v_mfma_f32_16x16x32_bf16 v[92:95], a[252:255], v[224:227], v[92:95]
    s_waitcnt vmcnt(12)
    v_mfma_f32_16x16x32_bf16 v[16:19], a[32:35], v[160:163], v[16:19]
    buffer_load_dwordx4 v[224:227], v243, s[44:47], s32 offen offset:0 sc1
    v_mfma_f32_16x16x32_bf16 v[16:19], a[80:83], v[164:167], v[16:19]
    v_mfma_f32_16x16x32_bf16 v[16:19], a[96:99], v[168:171], v[16:19]
    v_mfma_f32_16x16x32_bf16 v[16:19], a[48:51], v[172:175], v[16:19]
    v_mfma_f32_16x16x32_bf16 v[20:23], a[52:55], v[172:175], v[20:23]
    buffer_load_dwordx4 v[228:231], v243, s[44:47], s32 offen offset:1024 sc1
    v_mfma_f32_16x16x32_bf16 v[20:23], a[100:103], v[168:171], v[20:23]
    v_mfma_f32_16x16x32_bf16 v[20:23], a[84:87], v[164:167], v[20:23]
    v_mfma_f32_16x16x32_bf16 v[20:23], a[36:39], v[160:163], v[20:23]
    v_mfma_f32_16x16x32_bf16 v[24:27], a[40:43], v[160:163], v[24:27]
    buffer_load_dwordx4 v[232:235], v249, s[44:47], s32 offen offset:0 sc1
    v_mfma_f32_16x16x32_bf16 v[24:27], a[88:91], v[164:167], v[24:27]
    v_mfma_f32_16x16x32_bf16 v[24:27], a[104:107], v[168:171], v[24:27]
    v_mfma_f32_16x16x32_bf16 v[24:27], a[56:59], v[172:175], v[24:27]
    v_mfma_f32_16x16x32_bf16 v[28:31], a[60:63], v[172:175], v[28:31]
    buffer_load_dwordx4 v[236:239], v249, s[44:47], s32 offen offset:1024 sc1
    s_add_u32 s40, s86, 8
    s_and_b32 s40, s40, 15
    v_mfma_f32_16x16x32_bf16 v[28:31], a[108:111], v[168:171], v[28:31]
    s_lshl_b32 s40, s40, 10
    v_add_u32 v241, s40, v240
    v_mfma_f32_16x16x32_bf16 v[28:31], a[92:95], v[164:167], v[28:31]
    s_add_u32 s40, s86, 10
    s_and_b32 s40, s40, 15
    v_mfma_f32_16x16x32_bf16 v[28:31], a[44:47], v[160:163], v[28:31]
    s_lshl_b32 s40, s40, 10
    v_add_u32 v242, s40, v240
    s_waitcnt vmcnt(12)
    v_mfma_f32_16x16x32_bf16 v[32:35], a[32:35], v[176:179], v[32:35]
    buffer_load_dwordx4 v[160:163], v241, s[44:47], s28 offen offset:0 sc1
    v_mfma_f32_16x16x32_bf16 v[32:35], a[80:83], v[180:183], v[32:35]
    v_mfma_f32_16x16x32_bf16 v[32:35], a[96:99], v[184:187], v[32:35]
    v_mfma_f32_16x16x32_bf16 v[32:35], a[48:51], v[188:191], v[32:35]
    v_mfma_f32_16x16x32_bf16 v[36:39], a[52:55], v[188:191], v[36:39]
    buffer_load_dwordx4 v[164:167], v241, s[44:47], s28 offen offset:1024 sc1
    v_mfma_f32_16x16x32_bf16 v[36:39], a[100:103], v[184:187], v[36:39]
    v_mfma_f32_16x16x32_bf16 v[36:39], a[84:87], v[180:183], v[36:39]
    v_mfma_f32_16x16x32_bf16 v[36:39], a[36:39], v[176:179], v[36:39]
    v_mfma_f32_16x16x32_bf16 v[40:43], a[40:43], v[176:179], v[40:43]
    buffer_load_dwordx4 v[168:171], v242, s[44:47], s28 offen offset:0 sc1
    v_mfma_f32_16x16x32_bf16 v[40:43], a[88:91], v[180:183], v[40:43]
    v_mfma_f32_16x16x32_bf16 v[40:43], a[104:107], v[184:187], v[40:43]
    v_mfma_f32_16x16x32_bf16 v[40:43], a[56:59], v[188:191], v[40:43]
    v_mfma_f32_16x16x32_bf16 v[44:47], a[60:63], v[188:191], v[44:47]
    buffer_load_dwordx4 v[172:175], v242, s[44:47], s28 offen offset:1024 sc1
    v_mfma_f32_16x16x32_bf16 v[44:47], a[108:111], v[184:187], v[44:47]
    v_mfma_f32_16x16x32_bf16 v[44:47], a[92:95], v[180:183], v[44:47]
    v_mfma_f32_16x16x32_bf16 v[44:47], a[44:47], v[176:179], v[44:47]
    s_waitcnt vmcnt(12)
    v_mfma_f32_16x16x32_bf16 v[48:51], a[32:35], v[192:195], v[48:51]
    buffer_load_dwordx4 v[176:179], v241, s[44:47], s29 offen offset:0 sc1
    v_mfma_f32_16x16x32_bf16 v[48:51], a[80:83], v[196:199], v[48:51]
    v_mfma_f32_16x16x32_bf16 v[48:51], a[96:99], v[200:203], v[48:51]
    v_mfma_f32_16x16x32_bf16 v[48:51], a[48:51], v[204:207], v[48:51]
    v_mfma_f32_16x16x32_bf16 v[52:55], a[52:55], v[204:207], v[52:55]
    buffer_load_dwordx4 v[180:183], v241, s[44:47], s29 offen offset:1024 sc1
    v_mfma_f32_16x16x32_bf16 v[52:55], a[100:103], v[200:203], v[52:55]
    v_mfma_f32_16x16x32_bf16 v[52:55], a[84:87], v[196:199], v[52:55]
    v_mfma_f32_16x16x32_bf16 v[52:55], a[36:39], v[192:195], v[52:55]
    v_mfma_f32_16x16x32_bf16 v[56:59], a[40:43], v[192:195], v[56:59]
    buffer_load_dwordx4 v[184:187], v242, s[44:47], s29 offen offset:0 sc1
    v_mfma_f32_16x16x32_bf16 v[56:59], a[88:91], v[196:199], v[56:59]
    v_mfma_f32_16x16x32_bf16 v[56:59], a[104:107], v[200:203], v[56:59]
    v_mfma_f32_16x16x32_bf16 v[56:59], a[56:59], v[204:207], v[56:59]
    v_mfma_f32_16x16x32_bf16 v[60:63], a[60:63], v[204:207], v[60:63]
    buffer_load_dwordx4 v[188:191], v242, s[44:47], s29 offen offset:1024 sc1
    v_mfma_f32_16x16x32_bf16 v[60:63], a[108:111], v[200:203], v[60:63]
    v_mfma_f32_16x16x32_bf16 v[60:63], a[92:95], v[196:199], v[60:63]
    v_mfma_f32_16x16x32_bf16 v[60:63], a[44:47], v[192:195], v[60:63]
    s_waitcnt vmcnt(12)
    v_mfma_f32_16x16x32_bf16 v[64:67], a[32:35], v[208:211], v[64:67]
    buffer_load_dwordx4 v[192:195], v241, s[44:47], s30 offen offset:0 sc1
    v_mfma_f32_16x16x32_bf16 v[64:67], a[80:83], v[212:215], v[64:67]
    v_mfma_f32_16x16x32_bf16 v[64:67], a[96:99], v[216:219], v[64:67]
    v_mfma_f32_16x16x32_bf16 v[64:67], a[48:51], v[220:223], v[64:67]
    v_mfma_f32_16x16x32_bf16 v[68:71], a[52:55], v[220:223], v[68:71]
    buffer_load_dwordx4 v[196:199], v241, s[44:47], s30 offen offset:1024 sc1
    v_mfma_f32_16x16x32_bf16 v[68:71], a[100:103], v[216:219], v[68:71]
    v_mfma_f32_16x16x32_bf16 v[68:71], a[84:87], v[212:215], v[68:71]
    v_mfma_f32_16x16x32_bf16 v[68:71], a[36:39], v[208:211], v[68:71]
    v_mfma_f32_16x16x32_bf16 v[72:75], a[40:43], v[208:211], v[72:75]
    buffer_load_dwordx4 v[200:203], v242, s[44:47], s30 offen offset:0 sc1
    v_mfma_f32_16x16x32_bf16 v[72:75], a[88:91], v[212:215], v[72:75]
    v_mfma_f32_16x16x32_bf16 v[72:75], a[104:107], v[216:219], v[72:75]
    v_mfma_f32_16x16x32_bf16 v[72:75], a[56:59], v[220:223], v[72:75]
    v_mfma_f32_16x16x32_bf16 v[76:79], a[60:63], v[220:223], v[76:79]
    buffer_load_dwordx4 v[204:207], v242, s[44:47], s30 offen offset:1024 sc1
    v_mfma_f32_16x16x32_bf16 v[76:79], a[108:111], v[216:219], v[76:79]
    v_mfma_f32_16x16x32_bf16 v[76:79], a[92:95], v[212:215], v[76:79]
    v_mfma_f32_16x16x32_bf16 v[76:79], a[44:47], v[208:211], v[76:79]
    s_waitcnt vmcnt(12)
    v_mfma_f32_16x16x32_bf16 v[80:83], a[32:35], v[224:227], v[80:83]
    buffer_load_dwordx4 v[208:211], v241, s[44:47], s31 offen offset:0 sc1
    v_mfma_f32_16x16x32_bf16 v[80:83], a[80:83], v[228:231], v[80:83]
    v_mfma_f32_16x16x32_bf16 v[80:83], a[96:99], v[232:235], v[80:83]
    v_mfma_f32_16x16x32_bf16 v[80:83], a[48:51], v[236:239], v[80:83]
    v_mfma_f32_16x16x32_bf16 v[84:87], a[52:55], v[236:239], v[84:87]
    buffer_load_dwordx4 v[212:215], v241, s[44:47], s31 offen offset:1024 sc1
    v_mfma_f32_16x16x32_bf16 v[84:87], a[100:103], v[232:235], v[84:87]
    v_mfma_f32_16x16x32_bf16 v[84:87], a[84:87], v[228:231], v[84:87]
    v_mfma_f32_16x16x32_bf16 v[84:87], a[36:39], v[224:227], v[84:87]
    v_mfma_f32_16x16x32_bf16 v[88:91], a[40:43], v[224:227], v[88:91]
    buffer_load_dwordx4 v[216:219], v242, s[44:47], s31 offen offset:0 sc1
    v_mfma_f32_16x16x32_bf16 v[88:91], a[88:91], v[228:231], v[88:91]
    v_mfma_f32_16x16x32_bf16 v[88:91], a[104:107], v[232:235], v[88:91]
    v_mfma_f32_16x16x32_bf16 v[88:91], a[56:59], v[236:239], v[88:91]
    v_mfma_f32_16x16x32_bf16 v[92:95], a[60:63], v[236:239], v[92:95]
    buffer_load_dwordx4 v[220:223], v242, s[44:47], s31 offen offset:1024 sc1
    v_mfma_f32_16x16x32_bf16 v[92:95], a[108:111], v[232:235], v[92:95]
    v_mfma_f32_16x16x32_bf16 v[92:95], a[92:95], v[228:231], v[92:95]
    v_mfma_f32_16x16x32_bf16 v[92:95], a[44:47], v[224:227], v[92:95]
    s_waitcnt vmcnt(12)
    v_mfma_f32_16x16x32_bf16 v[16:19], a[112:115], v[160:163], v[16:19]
    buffer_load_dwordx4 v[224:227], v241, s[44:47], s32 offen offset:0 sc1
    v_mfma_f32_16x16x32_bf16 v[16:19], a[128:131], v[164:167], v[16:19]
    v_mfma_f32_16x16x32_bf16 v[16:19], a[144:147], v[168:171], v[16:19]
    v_mfma_f32_16x16x32_bf16 v[16:19], a[160:163], v[172:175], v[16:19]
    v_mfma_f32_16x16x32_bf16 v[20:23], a[164:167], v[172:175], v[20:23]
    buffer_load_dwordx4 v[228:231], v241, s[44:47], s32 offen offset:1024 sc1
    v_mfma_f32_16x16x32_bf16 v[20:23], a[148:151], v[168:171], v[20:23]
    v_mfma_f32_16x16x32_bf16 v[20:23], a[132:135], v[164:167], v[20:23]
    v_mfma_f32_16x16x32_bf16 v[20:23], a[116:119], v[160:163], v[20:23]
    v_mfma_f32_16x16x32_bf16 v[24:27], a[120:123], v[160:163], v[24:27]
    buffer_load_dwordx4 v[232:235], v242, s[44:47], s32 offen offset:0 sc1
    v_mfma_f32_16x16x32_bf16 v[24:27], a[136:139], v[164:167], v[24:27]
    v_mfma_f32_16x16x32_bf16 v[24:27], a[152:155], v[168:171], v[24:27]
    v_mfma_f32_16x16x32_bf16 v[24:27], a[168:171], v[172:175], v[24:27]
    v_mfma_f32_16x16x32_bf16 v[28:31], a[172:175], v[172:175], v[28:31]
    buffer_load_dwordx4 v[236:239], v242, s[44:47], s32 offen offset:1024 sc1
    s_add_u32 s40, s86, 12
    s_and_b32 s40, s40, 15
    v_mfma_f32_16x16x32_bf16 v[28:31], a[156:159], v[168:171], v[28:31]
    s_lshl_b32 s40, s40, 10
    v_add_u32 v243, s40, v240
    v_mfma_f32_16x16x32_bf16 v[28:31], a[140:143], v[164:167], v[28:31]
    s_add_u32 s40, s86, 14
    s_and_b32 s40, s40, 15
    v_mfma_f32_16x16x32_bf16 v[28:31], a[124:127], v[160:163], v[28:31]
    s_lshl_b32 s40, s40, 10
    v_add_u32 v249, s40, v240
    s_waitcnt vmcnt(12)
    v_mfma_f32_16x16x32_bf16 v[32:35], a[112:115], v[176:179], v[32:35]
    buffer_load_dwordx4 v[160:163], v243, s[44:47], s28 offen offset:0 sc1
    v_mfma_f32_16x16x32_bf16 v[32:35], a[128:131], v[180:183], v[32:35]
    v_mfma_f32_16x16x32_bf16 v[32:35], a[144:147], v[184:187], v[32:35]
    v_mfma_f32_16x16x32_bf16 v[32:35], a[160:163], v[188:191], v[32:35]
    v_mfma_f32_16x16x32_bf16 v[36:39], a[164:167], v[188:191], v[36:39]
    buffer_load_dwordx4 v[164:167], v243, s[44:47], s28 offen offset:1024 sc1
    v_mfma_f32_16x16x32_bf16 v[36:39], a[148:151], v[184:187], v[36:39]
    v_mfma_f32_16x16x32_bf16 v[36:39], a[132:135], v[180:183], v[36:39]
    v_mfma_f32_16x16x32_bf16 v[36:39], a[116:119], v[176:179], v[36:39]
    v_mfma_f32_16x16x32_bf16 v[40:43], a[120:123], v[176:179], v[40:43]
    buffer_load_dwordx4 v[168:171], v249, s[44:47], s28 offen offset:0 sc1
    v_mfma_f32_16x16x32_bf16 v[40:43], a[136:139], v[180:183], v[40:43]
    v_mfma_f32_16x16x32_bf16 v[40:43], a[152:155], v[184:187], v[40:43]
    v_mfma_f32_16x16x32_bf16 v[40:43], a[168:171], v[188:191], v[40:43]
    v_mfma_f32_16x16x32_bf16 v[44:47], a[172:175], v[188:191], v[44:47]
    buffer_load_dwordx4 v[172:175], v249, s[44:47], s28 offen offset:1024 sc1
    v_mfma_f32_16x16x32_bf16 v[44:47], a[156:159], v[184:187], v[44:47]
    v_mfma_f32_16x16x32_bf16 v[44:47], a[140:143], v[180:183], v[44:47]
    v_mfma_f32_16x16x32_bf16 v[44:47], a[124:127], v[176:179], v[44:47]
    s_waitcnt vmcnt(12)
    v_mfma_f32_16x16x32_bf16 v[48:51], a[112:115], v[192:195], v[48:51]
    buffer_load_dwordx4 v[176:179], v243, s[44:47], s29 offen offset:0 sc1
    v_mfma_f32_16x16x32_bf16 v[48:51], a[128:131], v[196:199], v[48:51]
    v_mfma_f32_16x16x32_bf16 v[48:51], a[144:147], v[200:203], v[48:51]
    v_mfma_f32_16x16x32_bf16 v[48:51], a[160:163], v[204:207], v[48:51]
    v_mfma_f32_16x16x32_bf16 v[52:55], a[164:167], v[204:207], v[52:55]
    buffer_load_dwordx4 v[180:183], v243, s[44:47], s29 offen offset:1024 sc1
    v_mfma_f32_16x16x32_bf16 v[52:55], a[148:151], v[200:203], v[52:55]
    v_mfma_f32_16x16x32_bf16 v[52:55], a[132:135], v[196:199], v[52:55]
    v_mfma_f32_16x16x32_bf16 v[52:55], a[116:119], v[192:195], v[52:55]
    v_mfma_f32_16x16x32_bf16 v[56:59], a[120:123], v[192:195], v[56:59]
    buffer_load_dwordx4 v[184:187], v249, s[44:47], s29 offen offset:0 sc1
    v_mfma_f32_16x16x32_bf16 v[56:59], a[136:139], v[196:199], v[56:59]
    v_mfma_f32_16x16x32_bf16 v[56:59], a[152:155], v[200:203], v[56:59]
    v_mfma_f32_16x16x32_bf16 v[56:59], a[168:171], v[204:207], v[56:59]
    v_mfma_f32_16x16x32_bf16 v[60:63], a[172:175], v[204:207], v[60:63]
    buffer_load_dwordx4 v[188:191], v249, s[44:47], s29 offen offset:1024 sc1
    v_mfma_f32_16x16x32_bf16 v[60:63], a[156:159], v[200:203], v[60:63]
    v_mfma_f32_16x16x32_bf16 v[60:63], a[140:143], v[196:199], v[60:63]
    v_mfma_f32_16x16x32_bf16 v[60:63], a[124:127], v[192:195], v[60:63]
    s_waitcnt vmcnt(12)
    v_mfma_f32_16x16x32_bf16 v[64:67], a[112:115], v[208:211], v[64:67]
    buffer_load_dwordx4 v[192:195], v243, s[44:47], s30 offen offset:0 sc1
    v_mfma_f32_16x16x32_bf16 v[64:67], a[128:131], v[212:215], v[64:67]
    v_mfma_f32_16x16x32_bf16 v[64:67], a[144:147], v[216:219], v[64:67]
    v_mfma_f32_16x16x32_bf16 v[64:67], a[160:163], v[220:223], v[64:67]
    v_mfma_f32_16x16x32_bf16 v[68:71], a[164:167], v[220:223], v[68:71]
    buffer_load_dwordx4 v[196:199], v243, s[44:47], s30 offen offset:1024 sc1
    v_mfma_f32_16x16x32_bf16 v[68:71], a[148:151], v[216:219], v[68:71]
    v_mfma_f32_16x16x32_bf16 v[68:71], a[132:135], v[212:215], v[68:71]
    v_mfma_f32_16x16x32_bf16 v[68:71], a[116:119], v[208:211], v[68:71]
    v_mfma_f32_16x16x32_bf16 v[72:75], a[120:123], v[208:211], v[72:75]
    buffer_load_dwordx4 v[200:203], v249, s[44:47], s30 offen offset:0 sc1
    v_mfma_f32_16x16x32_bf16 v[72:75], a[136:139], v[212:215], v[72:75]
    v_mfma_f32_16x16x32_bf16 v[72:75], a[152:155], v[216:219], v[72:75]
    v_mfma_f32_16x16x32_bf16 v[72:75], a[168:171], v[220:223], v[72:75]
    v_mfma_f32_16x16x32_bf16 v[76:79], a[172:175], v[220:223], v[76:79]
    buffer_load_dwordx4 v[204:207], v249, s[44:47], s30 offen offset:1024 sc1
    v_mfma_f32_16x16x32_bf16 v[76:79], a[156:159], v[216:219], v[76:79]
    v_mfma_f32_16x16x32_bf16 v[76:79], a[140:143], v[212:215], v[76:79]
    v_mfma_f32_16x16x32_bf16 v[76:79], a[124:127], v[208:211], v[76:79]
    s_waitcnt vmcnt(12)
    v_mfma_f32_16x16x32_bf16 v[80:83], a[112:115], v[224:227], v[80:83]
    buffer_load_dwordx4 v[208:211], v243, s[44:47], s31 offen offset:0 sc1
    v_mfma_f32_16x16x32_bf16 v[80:83], a[128:131], v[228:231], v[80:83]
    v_mfma_f32_16x16x32_bf16 v[80:83], a[144:147], v[232:235], v[80:83]
    v_mfma_f32_16x16x32_bf16 v[80:83], a[160:163], v[236:239], v[80:83]
    v_mfma_f32_16x16x32_bf16 v[84:87], a[164:167], v[236:239], v[84:87]
    buffer_load_dwordx4 v[212:215], v243, s[44:47], s31 offen offset:1024 sc1
    v_mfma_f32_16x16x32_bf16 v[84:87], a[148:151], v[232:235], v[84:87]
    v_mfma_f32_16x16x32_bf16 v[84:87], a[132:135], v[228:231], v[84:87]
    v_mfma_f32_16x16x32_bf16 v[84:87], a[116:119], v[224:227], v[84:87]
    v_mfma_f32_16x16x32_bf16 v[88:91], a[120:123], v[224:227], v[88:91]
    buffer_load_dwordx4 v[216:219], v249, s[44:47], s31 offen offset:0 sc1
    v_mfma_f32_16x16x32_bf16 v[88:91], a[136:139], v[228:231], v[88:91]
    v_mfma_f32_16x16x32_bf16 v[88:91], a[152:155], v[232:235], v[88:91]
    v_mfma_f32_16x16x32_bf16 v[88:91], a[168:171], v[236:239], v[88:91]
    v_mfma_f32_16x16x32_bf16 v[92:95], a[172:175], v[236:239], v[92:95]
    buffer_load_dwordx4 v[220:223], v249, s[44:47], s31 offen offset:1024 sc1
    v_mfma_f32_16x16x32_bf16 v[92:95], a[156:159], v[232:235], v[92:95]
    v_mfma_f32_16x16x32_bf16 v[92:95], a[140:143], v[228:231], v[92:95]
    v_mfma_f32_16x16x32_bf16 v[92:95], a[124:127], v[224:227], v[92:95]
    s_waitcnt vmcnt(12)
    v_mfma_f32_16x16x32_bf16 v[16:19], a[176:179], v[160:163], v[16:19]
    buffer_load_dwordx4 v[224:227], v243, s[44:47], s32 offen offset:0 sc1
    v_mfma_f32_16x16x32_bf16 v[16:19], a[192:195], v[164:167], v[16:19]
    v_mfma_f32_16x16x32_bf16 v[16:19], a[208:211], v[168:171], v[16:19]
    v_mfma_f32_16x16x32_bf16 v[16:19], a[224:227], v[172:175], v[16:19]
    v_mfma_f32_16x16x32_bf16 v[20:23], a[228:231], v[172:175], v[20:23]
    buffer_load_dwordx4 v[228:231], v243, s[44:47], s32 offen offset:1024 sc1
    v_mfma_f32_16x16x32_bf16 v[20:23], a[212:215], v[168:171], v[20:23]
    v_mfma_f32_16x16x32_bf16 v[20:23], a[196:199], v[164:167], v[20:23]
    v_mfma_f32_16x16x32_bf16 v[20:23], a[180:183], v[160:163], v[20:23]
    v_mfma_f32_16x16x32_bf16 v[24:27], a[184:187], v[160:163], v[24:27]
    buffer_load_dwordx4 v[232:235], v249, s[44:47], s32 offen offset:0 sc1
    v_mfma_f32_16x16x32_bf16 v[24:27], a[200:203], v[164:167], v[24:27]
    v_mfma_f32_16x16x32_bf16 v[24:27], a[216:219], v[168:171], v[24:27]
    v_mfma_f32_16x16x32_bf16 v[24:27], a[232:235], v[172:175], v[24:27]
    v_mfma_f32_16x16x32_bf16 v[28:31], a[236:239], v[172:175], v[28:31]
    buffer_load_dwordx4 v[236:239], v249, s[44:47], s32 offen offset:1024 sc1
    s_add_u32 s40, s86, 0
    s_and_b32 s40, s40, 15
    v_mfma_f32_16x16x32_bf16 v[28:31], a[220:223], v[168:171], v[28:31]
    s_lshl_b32 s40, s40, 10
    v_add_u32 v241, s40, v240
    v_mfma_f32_16x16x32_bf16 v[28:31], a[204:207], v[164:167], v[28:31]
    s_add_u32 s40, s86, 2
    s_and_b32 s40, s40, 15
    v_mfma_f32_16x16x32_bf16 v[28:31], a[188:191], v[160:163], v[28:31]
    s_lshl_b32 s40, s40, 10
    v_add_u32 v242, s40, v240
    s_waitcnt vmcnt(12)
    v_mfma_f32_16x16x32_bf16 v[32:35], a[176:179], v[176:179], v[32:35]
    buffer_load_dwordx4 v[160:163], v241, s[44:47], s16 offen offset:0 sc1
    v_mfma_f32_16x16x32_bf16 v[32:35], a[192:195], v[180:183], v[32:35]
    v_mfma_f32_16x16x32_bf16 v[32:35], a[208:211], v[184:187], v[32:35]
    v_mfma_f32_16x16x32_bf16 v[32:35], a[224:227], v[188:191], v[32:35]
    ds_write_b128 v4, v[20:23] offset:0
    v_mfma_f32_16x16x32_bf16 v[36:39], a[228:231], v[188:191], v[36:39]
    buffer_load_dwordx4 v[164:167], v241, s[44:47], s16 offen offset:1024 sc1
    v_mfma_f32_16x16x32_bf16 v[36:39], a[212:215], v[184:187], v[36:39]
    v_mfma_f32_16x16x32_bf16 v[36:39], a[196:199], v[180:183], v[36:39]
    ds_write_b128 v5, v[24:27] offset:0
    v_mfma_f32_16x16x32_bf16 v[36:39], a[180:183], v[176:179], v[36:39]
    v_mfma_f32_16x16x32_bf16 v[40:43], a[184:187], v[176:179], v[40:43]
    buffer_load_dwordx4 v[168:171], v242, s[44:47], s16 offen offset:0 sc1
    v_mfma_f32_16x16x32_bf16 v[40:43], a[200:203], v[180:183], v[40:43]
    ds_write_b128 v6, v[28:31] offset:0
    v_mfma_f32_16x16x32_bf16 v[40:43], a[216:219], v[184:187], v[40:43]
    v_mfma_f32_16x16x32_bf16 v[40:43], a[232:235], v[188:191], v[40:43]
    v_mfma_f32_16x16x32_bf16 v[44:47], a[236:239], v[188:191], v[44:47]
    buffer_load_dwordx4 v[172:175], v242, s[44:47], s16 offen offset:1024 sc1
    v_mfma_f32_16x16x32_bf16 v[44:47], a[220:223], v[184:187], v[44:47]
    v_mfma_f32_16x16x32_bf16 v[44:47], a[204:207], v[180:183], v[44:47]
    v_mfma_f32_16x16x32_bf16 v[44:47], a[188:191], v[176:179], v[44:47]
    s_waitcnt vmcnt(12)
    v_mfma_f32_16x16x32_bf16 v[48:51], a[176:179], v[192:195], v[48:51]
    buffer_load_dwordx4 v[176:179], v241, s[44:47], s17 offen offset:0 sc1
    v_mfma_f32_16x16x32_bf16 v[48:51], a[192:195], v[196:199], v[48:51]
    v_mfma_f32_16x16x32_bf16 v[48:51], a[208:211], v[200:203], v[48:51]
    v_mfma_f32_16x16x32_bf16 v[48:51], a[224:227], v[204:207], v[48:51]
    ds_write_b128 v4, v[36:39] offset:1024
    v_mfma_f32_16x16x32_bf16 v[52:55], a[228:231], v[204:207], v[52:55]
    buffer_load_dwordx4 v[180:183], v241, s[44:47], s17 offen offset:1024 sc1
    v_mfma_f32_16x16x32_bf16 v[52:55], a[212:215], v[200:203], v[52:55]
    v_mfma_f32_16x16x32_bf16 v[52:55], a[196:199], v[196:199], v[52:55]
    ds_write_b128 v5, v[40:43] offset:1024
    v_mfma_f32_16x16x32_bf16 v[52:55], a[180:183], v[192:195], v[52:55]
    v_mfma_f32_16x16x32_bf16 v[56:59], a[184:187], v[192:195], v[56:59]
    buffer_load_dwordx4 v[184:187], v242, s[44:47], s17 offen offset:0 sc1
    v_mfma_f32_16x16x32_bf16 v[56:59], a[200:203], v[196:199], v[56:59]
    ds_write_b128 v6, v[44:47] offset:1024
    v_mfma_f32_16x16x32_bf16 v[56:59], a[216:219], v[200:203], v[56:59]
    v_mfma_f32_16x16x32_bf16 v[56:59], a[232:235], v[204:207], v[56:59]
    v_mfma_f32_16x16x32_bf16 v[60:63], a[236:239], v[204:207], v[60:63]
    buffer_load_dwordx4 v[188:191], v242, s[44:47], s17 offen offset:1024 sc1
    v_mfma_f32_16x16x32_bf16 v[60:63], a[220:223], v[200:203], v[60:63]
    v_mfma_f32_16x16x32_bf16 v[60:63], a[204:207], v[196:199], v[60:63]
    v_mfma_f32_16x16x32_bf16 v[60:63], a[188:191], v[192:195], v[60:63]
    s_waitcnt vmcnt(12)
    v_mfma_f32_16x16x32_bf16 v[64:67], a[176:179], v[208:211], v[64:67]
    buffer_load_dwordx4 v[192:195], v241, s[44:47], s18 offen offset:0 sc1
    v_mfma_f32_16x16x32_bf16 v[64:67], a[192:195], v[212:215], v[64:67]
    v_mfma_f32_16x16x32_bf16 v[64:67], a[208:211], v[216:219], v[64:67]
    v_mfma_f32_16x16x32_bf16 v[64:67], a[224:227], v[220:223], v[64:67]
    ds_write_b128 v4, v[52:55] offset:2048
    v_mfma_f32_16x16x32_bf16 v[68:71], a[228:231], v[220:223], v[68:71]
    buffer_load_dwordx4 v[196:199], v241, s[44:47], s18 offen offset:1024 sc1
    v_mfma_f32_16x16x32_bf16 v[68:71], a[212:215], v[216:219], v[68:71]
    v_mfma_f32_16x16x32_bf16 v[68:71], a[196:199], v[212:215], v[68:71]
    ds_write_b128 v5, v[56:59] offset:2048
    v_mfma_f32_16x16x32_bf16 v[68:71], a[180:183], v[208:211], v[68:71]
    v_mfma_f32_16x16x32_bf16 v[72:75], a[184:187], v[208:211], v[72:75]
    buffer_load_dwordx4 v[200:203], v242, s[44:47], s18 offen offset:0 sc1
    v_mfma_f32_16x16x32_bf16 v[72:75], a[200:203], v[212:215], v[72:75]
    ds_write_b128 v6, v[60:63] offset:2048
    v_mfma_f32_16x16x32_bf16 v[72:75], a[216:219], v[216:219], v[72:75]
    v_mfma_f32_16x16x32_bf16 v[72:75], a[232:235], v[220:223], v[72:75]
    v_mfma_f32_16x16x32_bf16 v[76:79], a[236:239], v[220:223], v[76:79]
    buffer_load_dwordx4 v[204:207], v242, s[44:47], s18 offen offset:1024 sc1
    v_mfma_f32_16x16x32_bf16 v[76:79], a[220:223], v[216:219], v[76:79]
    v_mfma_f32_16x16x32_bf16 v[76:79], a[204:207], v[212:215], v[76:79]
    v_mfma_f32_16x16x32_bf16 v[76:79], a[188:191], v[208:211], v[76:79]
    s_waitcnt vmcnt(12)
    v_mfma_f32_16x16x32_bf16 v[80:83], a[176:179], v[224:227], v[80:83]
    buffer_load_dwordx4 v[208:211], v241, s[44:47], s19 offen offset:0 sc1
    v_mfma_f32_16x16x32_bf16 v[80:83], a[192:195], v[228:231], v[80:83]
    v_mfma_f32_16x16x32_bf16 v[80:83], a[208:211], v[232:235], v[80:83]
    v_mfma_f32_16x16x32_bf16 v[80:83], a[224:227], v[236:239], v[80:83]
    ds_write_b128 v4, v[68:71] offset:3072
    v_mfma_f32_16x16x32_bf16 v[84:87], a[228:231], v[236:239], v[84:87]
    buffer_load_dwordx4 v[212:215], v241, s[44:47], s19 offen offset:1024 sc1
    v_mfma_f32_16x16x32_bf16 v[84:87], a[212:215], v[232:235], v[84:87]
    v_mfma_f32_16x16x32_bf16 v[84:87], a[196:199], v[228:231], v[84:87]
    ds_write_b128 v5, v[72:75] offset:3072
    v_mfma_f32_16x16x32_bf16 v[84:87], a[180:183], v[224:227], v[84:87]
    v_mfma_f32_16x16x32_bf16 v[88:91], a[184:187], v[224:227], v[88:91]
    buffer_load_dwordx4 v[216:219], v242, s[44:47], s19 offen offset:0 sc1
    v_mfma_f32_16x16x32_bf16 v[88:91], a[200:203], v[228:231], v[88:91]
    ds_write_b128 v6, v[76:79] offset:3072
    v_mfma_f32_16x16x32_bf16 v[88:91], a[216:219], v[232:235], v[88:91]
    v_mfma_f32_16x16x32_bf16 v[88:91], a[232:235], v[236:239], v[88:91]
    v_mfma_f32_16x16x32_bf16 v[92:95], a[236:239], v[236:239], v[92:95]
    buffer_load_dwordx4 v[220:223], v242, s[44:47], s19 offen offset:1024 sc1
    s_add_u32 s40, s86, 4
    s_and_b32 s40, s40, 15
    v_mfma_f32_16x16x32_bf16 v[92:95], a[220:223], v[232:235], v[92:95]
    s_lshl_b32 s40, s40, 10
    v_add_u32 v243, s40, v240
    v_mfma_f32_16x16x32_bf16 v[92:95], a[204:207], v[228:231], v[92:95]
    s_add_u32 s40, s86, 6
    s_and_b32 s40, s40, 15
    v_mfma_f32_16x16x32_bf16 v[92:95], a[188:191], v[224:227], v[92:95]
    s_lshl_b32 s40, s40, 10
    v_add_u32 v249, s40, v240
    s_waitcnt vmcnt(12)
    v_mfma_f32_16x16x32_bf16 v[96:99], a[240:243], v[160:163], 0
    buffer_load_dwordx4 v[224:227], v243, s[44:47], s16 offen offset:0 sc1
    v_mfma_f32_16x16x32_bf16 v[96:99], a[64:67], v[164:167], v[96:99]
    v_mfma_f32_16x16x32_bf16 v[96:99], a[0:3], v[168:171], v[96:99]
    v_mfma_f32_16x16x32_bf16 v[96:99], a[16:19], v[172:175], v[96:99]
    ds_write_b128 v4, v[84:87] offset:4096
    v_mfma_f32_16x16x32_bf16 v[100:103], a[20:23], v[172:175], 0
    buffer_load_dwordx4 v[228:231], v243, s[44:47], s16 offen offset:1024 sc1
    v_mfma_f32_16x16x32_bf16 v[100:103], a[4:7], v[168:171], v[100:103]
    ds_write_b128 v5, v[88:91] offset:4096
    v_mfma_f32_16x16x32_bf16 v[100:103], a[68:71], v[164:167], v[100:103]
    v_mfma_f32_16x16x32_bf16 v[100:103], a[244:247], v[160:163], v[100:103]
    ds_write_b128 v6, v[92:95] offset:4096
    v_mfma_f32_16x16x32_bf16 v[104:107], a[248:251], v[160:163], 0
    buffer_load_dwordx4 v[232:235], v249, s[44:47], s16 offen offset:0 sc1
    v_mfma_f32_16x16x32_bf16 v[104:107], a[72:75], v[164:167], v[104:107]
    v_mfma_f32_16x16x32_bf16 v[104:107], a[8:11], v[168:171], v[104:107]
    v_mfma_f32_16x16x32_bf16 v[104:107], a[24:27], v[172:175], v[104:107]
    v_mfma_f32_16x16x32_bf16 v[108:111], a[28:31], v[172:175], 0
    buffer_load_dwordx4 v[236:239], v249, s[44:47], s16 offen offset:1024 sc1
    v_mfma_f32_16x16x32_bf16 v[108:111], a[12:15], v[168:171], v[108:111]
    v_mfma_f32_16x16x32_bf16 v[108:111], a[76:79], v[164:167], v[108:111]
    v_mfma_f32_16x16x32_bf16 v[108:111], a[252:255], v[160:163], v[108:111]
    s_waitcnt lgkmcnt(0)
    s_barrier
    s_waitcnt vmcnt(12)
    v_mfma_f32_16x16x32_bf16 v[112:115], a[240:243], v[176:179], 0
    buffer_load_dwordx4 v[160:163], v243, s[44:47], s17 offen offset:0 sc1
    v_mfma_f32_16x16x32_bf16 v[112:115], a[64:67], v[180:183], v[112:115]
    ds_read_b128 v[20:23], v10 offset:0
    ds_read_b128 v[24:27], v10 offset:5120
    v_mfma_f32_16x16x32_bf16 v[112:115], a[0:3], v[184:187], v[112:115]
    ds_read_b128 v[28:31], v10 offset:10240
    ds_read_b128 v[36:39], v10 offset:1024
    v_mfma_f32_16x16x32_bf16 v[112:115], a[16:19], v[188:191], v[112:115]
    ds_read_b128 v[40:43], v10 offset:6144
    ds_read_b128 v[44:47], v10 offset:11264
    v_mfma_f32_16x16x32_bf16 v[116:119], a[20:23], v[188:191], 0
    buffer_load_dwordx4 v[164:167], v243, s[44:47], s17 offen offset:1024 sc1
    v_mfma_f32_16x16x32_bf16 v[116:119], a[4:7], v[184:187], v[116:119]
    ds_read_b128 v[52:55], v10 offset:2048
    ds_read_b128 v[56:59], v10 offset:7168
    v_mfma_f32_16x16x32_bf16 v[116:119], a[68:71], v[180:183], v[116:119]
    ds_read_b128 v[60:63], v10 offset:12288
    ds_read_b128 v[68:71], v10 offset:3072
    v_mfma_f32_16x16x32_bf16 v[116:119], a[244:247], v[176:179], v[116:119]
    ds_read_b128 v[72:75], v10 offset:8192
    ds_read_b128 v[76:79], v10 offset:13312
    v_mfma_f32_16x16x32_bf16 v[120:123], a[248:251], v[176:179], 0
    buffer_load_dwordx4 v[168:171], v249, s[44:47], s17 offen offset:0 sc1
    v_mfma_f32_16x16x32_bf16 v[120:123], a[72:75], v[180:183], v[120:123]
    ds_read_b128 v[84:87], v10 offset:4096
    ds_read_b128 v[88:91], v10 offset:9216
    v_mfma_f32_16x16x32_bf16 v[120:123], a[8:11], v[184:187], v[120:123]
    ds_read_b128 v[92:95], v10 offset:14336
    v_mfma_f32_16x16x32_bf16 v[120:123], a[24:27], v[188:191], v[120:123]
    s_waitcnt lgkmcnt(12)
    v_add_f32 v16, v16, v20
    v_add_f32 v17, v17, v21
    v_mfma_f32_16x16x32_bf16 v[124:127], a[28:31], v[188:191], 0
    buffer_load_dwordx4 v[172:175], v249, s[44:47], s17 offen offset:1024 sc1
    v_add_f32 v18, v18, v22
    v_add_f32 v19, v19, v23
    v_mfma_f32_16x16x32_bf16 v[124:127], a[12:15], v[184:187], v[124:127]
    v_mfma_f32_16x16x32_bf16 v[124:127], a[76:79], v[180:183], v[124:127]
    v_add_f32 v24, v24, v28
    v_add_f32 v25, v25, v29
    v_mfma_f32_16x16x32_bf16 v[124:127], a[252:255], v[176:179], v[124:127]
    v_add_f32 v26, v26, v30
    v_add_f32 v27, v27, v31
    s_waitcnt vmcnt(12)
    s_waitcnt lgkmcnt(0)
    v_mfma_f32_16x16x32_bf16 v[128:131], a[240:243], v[192:195], 0
    buffer_load_dwordx4 v[176:179], v243, s[44:47], s18 offen offset:0 sc1
    v_add_f32 v16, v16, v24
    v_add_f32 v17, v17, v25
    v_mfma_f32_16x16x32_bf16 v[128:131], a[64:67], v[196:199], v[128:131]
    v_add_f32 v18, v18, v26
    v_add_f32 v19, v19, v27
    v_mfma_f32_16x16x32_bf16 v[128:131], a[0:3], v[200:203], v[128:131]
    v_add_f32 v32, v32, v36
    v_add_f32 v33, v33, v37
    v_mfma_f32_16x16x32_bf16 v[128:131], a[16:19], v[204:207], v[128:131]
    v_add_f32 v34, v34, v38
    v_add_f32 v35, v35, v39
    v_mfma_f32_16x16x32_bf16 v[132:135], a[20:23], v[204:207], 0
    buffer_load_dwordx4 v[180:183], v243, s[44:47], s18 offen offset:1024 sc1
    v_add_f32 v40, v40, v44
    v_add_f32 v41, v41, v45
    v_mfma_f32_16x16x32_bf16 v[132:135], a[4:7], v[200:203], v[132:135]
    v_add_f32 v42, v42, v46
    v_add_f32 v43, v43, v47
    v_mfma_f32_16x16x32_bf16 v[132:135], a[68:71], v[196:199], v[132:135]
    v_add_f32 v32, v32, v40
    v_add_f32 v33, v33, v41
    v_mfma_f32_16x16x32_bf16 v[132:135], a[244:247], v[192:195], v[132:135]
    v_add_f32 v34, v34, v42
    v_add_f32 v35, v35, v43
    v_mfma_f32_16x16x32_bf16 v[136:139], a[248:251], v[192:195], 0
    buffer_load_dwordx4 v[184:187], v249, s[44:47], s18 offen offset:0 sc1
    v_add_f32 v48, v48, v52
    v_add_f32 v49, v49, v53
    v_mfma_f32_16x16x32_bf16 v[136:139], a[72:75], v[196:199], v[136:139]
    v_add_f32 v50, v50, v54
    v_add_f32 v51, v51, v55
    v_mfma_f32_16x16x32_bf16 v[136:139], a[8:11], v[200:203], v[136:139]
    v_add_f32 v56, v56, v60
    v_add_f32 v57, v57, v61
    v_mfma_f32_16x16x32_bf16 v[136:139], a[24:27], v[204:207], v[136:139]
    v_add_f32 v58, v58, v62
    v_add_f32 v59, v59, v63
    v_mfma_f32_16x16x32_bf16 v[140:143], a[28:31], v[204:207], 0
    buffer_load_dwordx4 v[188:191], v249, s[44:47], s18 offen offset:1024 sc1
    v_add_f32 v48, v48, v56
    v_add_f32 v49, v49, v57
    v_mfma_f32_16x16x32_bf16 v[140:143], a[12:15], v[200:203], v[140:143]
    v_mfma_f32_16x16x32_bf16 v[140:143], a[76:79], v[196:199], v[140:143]
    v_add_f32 v50, v50, v58
    v_add_f32 v51, v51, v59
    v_mfma_f32_16x16x32_bf16 v[140:143], a[252:255], v[192:195], v[140:143]
    s_waitcnt vmcnt(12)
    v_mfma_f32_16x16x32_bf16 v[144:147], a[240:243], v[208:211], 0
    buffer_load_dwordx4 v[192:195], v243, s[44:47], s19 offen offset:0 sc1
    v_add_f32 v64, v64, v68
    v_add_f32 v65, v65, v69
    v_mfma_f32_16x16x32_bf16 v[144:147], a[64:67], v[212:215], v[144:147]
    v_add_f32 v66, v66, v70
    v_add_f32 v67, v67, v71
    v_mfma_f32_16x16x32_bf16 v[144:147], a[0:3], v[216:219], v[144:147]
    buffer_load_dwordx4 v[196:199], v243, s[44:47], s19 offen offset:1024 sc1
    v_add_f32 v72, v72, v76
    v_add_f32 v73, v73, v77
    v_mfma_f32_16x16x32_bf16 v[144:147], a[16:19], v[220:223], v[144:147]
    v_add_f32 v74, v74, v78
    v_add_f32 v75, v75, v79
    v_mfma_f32_16x16x32_bf16 v[148:151], a[20:23], v[220:223], 0
    buffer_load_dwordx4 v[200:203], v249, s[44:47], s19 offen offset:0 sc1
    v_add_f32 v64, v64, v72
    v_add_f32 v65, v65, v73
    v_mfma_f32_16x16x32_bf16 v[148:151], a[4:7], v[216:219], v[148:151]
    v_add_f32 v66, v66, v74
    v_add_f32 v67, v67, v75
    v_mfma_f32_16x16x32_bf16 v[148:151], a[68:71], v[212:215], v[148:151]
    buffer_load_dwordx4 v[204:207], v249, s[44:47], s19 offen offset:1024 sc1
    v_add_f32 v80, v80, v84
    v_add_f32 v81, v81, v85
    v_mfma_f32_16x16x32_bf16 v[148:151], a[244:247], v[208:211], v[148:151]
    v_add_f32 v82, v82, v86
    v_add_f32 v83, v83, v87
    v_mfma_f32_16x16x32_bf16 v[152:155], a[248:251], v[208:211], 0
    buffer_store_dwordx4 v[16:19], v248, s[96:99], s33 offen offset:0 sc1
    v_add_f32 v88, v88, v92
    v_add_f32 v89, v89, v93
    v_mfma_f32_16x16x32_bf16 v[152:155], a[72:75], v[212:215], v[152:155]
    v_add_f32 v90, v90, v94
    v_add_f32 v91, v91, v95
    v_mfma_f32_16x16x32_bf16 v[152:155], a[8:11], v[216:219], v[152:155]
    buffer_store_dwordx4 v[32:35], v248, s[96:99], s33 offen offset:1024 sc1
    v_add_f32 v80, v80, v88
    v_add_f32 v81, v81, v89
    v_mfma_f32_16x16x32_bf16 v[152:155], a[24:27], v[220:223], v[152:155]
    v_add_f32 v82, v82, v90
    v_add_f32 v83, v83, v91
    v_mfma_f32_16x16x32_bf16 v[156:159], a[28:31], v[220:223], 0
    buffer_store_dwordx4 v[48:51], v248, s[96:99], s33 offen offset:2048 sc1
    s_add_u32 s40, s86, 8
    s_and_b32 s40, s40, 15
    v_mfma_f32_16x16x32_bf16 v[156:159], a[12:15], v[216:219], v[156:159]
    s_lshl_b32 s40, s40, 10
    v_add_u32 v241, s40, v240
    v_mfma_f32_16x16x32_bf16 v[156:159], a[76:79], v[212:215], v[156:159]
    buffer_store_dwordx4 v[64:67], v248, s[96:99], s33 offen offset:3072 sc1
    s_add_u32 s40, s86, 10
    s_and_b32 s40, s40, 15
    v_mfma_f32_16x16x32_bf16 v[156:159], a[252:255], v[208:211], v[156:159]
    buffer_store_dwordx4 v[80:83], v248, s[96:99], s34 offen offset:0 sc1
    s_lshl_b32 s40, s40, 10
    v_add_u32 v242, s40, v240
    s_waitcnt vmcnt(17)
    v_mfma_f32_16x16x32_bf16 v[96:99], a[32:35], v[224:227], v[96:99]
    buffer_load_dwordx4 v[208:211], v241, s[44:47], s16 offen offset:0 sc1
    v_mfma_f32_16x16x32_bf16 v[96:99], a[80:83], v[228:231], v[96:99]
    v_mfma_f32_16x16x32_bf16 v[96:99], a[96:99], v[232:235], v[96:99]
    v_mfma_f32_16x16x32_bf16 v[96:99], a[48:51], v[236:239], v[96:99]
    v_mfma_f32_16x16x32_bf16 v[100:103], a[52:55], v[236:239], v[100:103]
    buffer_load_dwordx4 v[212:215], v241, s[44:47], s16 offen offset:1024 sc1
    v_mfma_f32_16x16x32_bf16 v[100:103], a[100:103], v[232:235], v[100:103]
    v_mfma_f32_16x16x32_bf16 v[100:103], a[84:87], v[228:231], v[100:103]
    v_mfma_f32_16x16x32_bf16 v[100:103], a[36:39], v[224:227], v[100:103]
    v_mfma_f32_16x16x32_bf16 v[104:107], a[40:43], v[224:227], v[104:107]
    buffer_load_dwordx4 v[216:219], v242, s[44:47], s16 offen offset:0 sc1
    v_mfma_f32_16x16x32_bf16 v[104:107], a[88:91], v[228:231], v[104:107]
    v_mfma_f32_16x16x32_bf16 v[104:107], a[104:107], v[232:235], v[104:107]
    v_mfma_f32_16x16x32_bf16 v[104:107], a[56:59], v[236:239], v[104:107]
    v_mfma_f32_16x16x32_bf16 v[108:111], a[60:63], v[236:239], v[108:111]
    buffer_load_dwordx4 v[220:223], v242, s[44:47], s16 offen offset:1024 sc1
    v_mfma_f32_16x16x32_bf16 v[108:111], a[108:111], v[232:235], v[108:111]
    v_mfma_f32_16x16x32_bf16 v[108:111], a[92:95], v[228:231], v[108:111]
    v_mfma_f32_16x16x32_bf16 v[108:111], a[44:47], v[224:227], v[108:111]
    s_waitcnt vmcnt(17)
    v_mfma_f32_16x16x32_bf16 v[112:115], a[32:35], v[160:163], v[112:115]
    buffer_load_dwordx4 v[224:227], v241, s[44:47], s17 offen offset:0 sc1
    v_mfma_f32_16x16x32_bf16 v[112:115], a[80:83], v[164:167], v[112:115]
    v_mfma_f32_16x16x32_bf16 v[112:115], a[96:99], v[168:171], v[112:115]
    v_mfma_f32_16x16x32_bf16 v[112:115], a[48:51], v[172:175], v[112:115]
    v_mfma_f32_16x16x32_bf16 v[116:119], a[52:55], v[172:175], v[116:119]
    buffer_load_dwordx4 v[228:231], v241, s[44:47], s17 offen offset:1024 sc1
    v_mfma_f32_16x16x32_bf16 v[116:119], a[100:103], v[168:171], v[116:119]
    v_mfma_f32_16x16x32_bf16 v[116:119], a[84:87], v[164:167], v[116:119]
    v_mfma_f32_16x16x32_bf16 v[116:119], a[36:39], v[160:163], v[116:119]
    v_mfma_f32_16x16x32_bf16 v[120:123], a[40:43], v[160:163], v[120:123]
    buffer_load_dwordx4 v[232:235], v242, s[44:47], s17 offen offset:0 sc1
    v_mfma_f32_16x16x32_bf16 v[120:123], a[88:91], v[164:167], v[120:123]
    v_mfma_f32_16x16x32_bf16 v[120:123], a[104:107], v[168:171], v[120:123]
    v_mfma_f32_16x16x32_bf16 v[120:123], a[56:59], v[172:175], v[120:123]
    v_mfma_f32_16x16x32_bf16 v[124:127], a[60:63], v[172:175], v[124:127]
    buffer_load_dwordx4 v[236:239], v242, s[44:47], s17 offen offset:1024 sc1
    v_mfma_f32_16x16x32_bf16 v[124:127], a[108:111], v[168:171], v[124:127]
    v_mfma_f32_16x16x32_bf16 v[124:127], a[92:95], v[164:167], v[124:127]
    v_mfma_f32_16x16x32_bf16 v[124:127], a[44:47], v[160:163], v[124:127]
    s_waitcnt vmcnt(17)
    v_mfma_f32_16x16x32_bf16 v[128:131], a[32:35], v[176:179], v[128:131]
    buffer_load_dwordx4 v[160:163], v241, s[44:47], s18 offen offset:0 sc1
    v_mfma_f32_16x16x32_bf16 v[128:131], a[80:83], v[180:183], v[128:131]
    v_mfma_f32_16x16x32_bf16 v[128:131], a[96:99], v[184:187], v[128:131]
    v_mfma_f32_16x16x32_bf16 v[128:131], a[48:51], v[188:191], v[128:131]
    v_mfma_f32_16x16x32_bf16 v[132:135], a[52:55], v[188:191], v[132:135]
    buffer_load_dwordx4 v[164:167], v241, s[44:47], s18 offen offset:1024 sc1
    v_mfma_f32_16x16x32_bf16 v[132:135], a[100:103], v[184:187], v[132:135]
    v_mfma_f32_16x16x32_bf16 v[132:135], a[84:87], v[180:183], v[132:135]
    v_mfma_f32_16x16x32_bf16 v[132:135], a[36:39], v[176:179], v[132:135]
    v_mfma_f32_16x16x32_bf16 v[136:139], a[40:43], v[176:179], v[136:139]
    buffer_load_dwordx4 v[168:171], v242, s[44:47], s18 offen offset:0 sc1
    v_mfma_f32_16x16x32_bf16 v[136:139], a[88:91], v[180:183], v[136:139]
    v_mfma_f32_16x16x32_bf16 v[136:139], a[104:107], v[184:187], v[136:139]
    v_mfma_f32_16x16x32_bf16 v[136:139], a[56:59], v[188:191], v[136:139]
    v_mfma_f32_16x16x32_bf16 v[140:143], a[60:63], v[188:191], v[140:143]
    buffer_load_dwordx4 v[172:175], v242, s[44:47], s18 offen offset:1024 sc1
    v_mfma_f32_16x16x32_bf16 v[140:143], a[108:111], v[184:187], v[140:143]
    v_mfma_f32_16x16x32_bf16 v[140:143], a[92:95], v[180:183], v[140:143]
    v_mfma_f32_16x16x32_bf16 v[140:143], a[44:47], v[176:179], v[140:143]
    s_waitcnt vmcnt(12)
    buffer_store_dword v15, v13, s[96:99], 0 offen sc1
    v_mfma_f32_16x16x32_bf16 v[144:147], a[32:35], v[192:195], v[144:147]
    buffer_load_dwordx4 v[176:179], v241, s[44:47], s19 offen offset:0 sc1
    v_mfma_f32_16x16x32_bf16 v[144:147], a[80:83], v[196:199], v[144:147]
    v_mfma_f32_16x16x32_bf16 v[144:147], a[96:99], v[200:203], v[144:147]
    v_mfma_f32_16x16x32_bf16 v[144:147], a[48:51], v[204:207], v[144:147]
    v_mfma_f32_16x16x32_bf16 v[148:151], a[52:55], v[204:207], v[148:151]
    buffer_load_dwordx4 v[180:183], v241, s[44:47], s19 offen offset:1024 sc1
    v_mfma_f32_16x16x32_bf16 v[148:151], a[100:103], v[200:203], v[148:151]
    v_mfma_f32_16x16x32_bf16 v[148:151], a[84:87], v[196:199], v[148:151]
    v_mfma_f32_16x16x32_bf16 v[148:151], a[36:39], v[192:195], v[148:151]
    v_mfma_f32_16x16x32_bf16 v[152:155], a[40:43], v[192:195], v[152:155]
    buffer_load_dwordx4 v[184:187], v242, s[44:47], s19 offen offset:0 sc1
    v_mfma_f32_16x16x32_bf16 v[152:155], a[88:91], v[196:199], v[152:155]
    v_mfma_f32_16x16x32_bf16 v[152:155], a[104:107], v[200:203], v[152:155]
    v_mfma_f32_16x16x32_bf16 v[152:155], a[56:59], v[204:207], v[152:155]
    v_mfma_f32_16x16x32_bf16 v[156:159], a[60:63], v[204:207], v[156:159]
    buffer_load_dwordx4 v[188:191], v242, s[44:47], s19 offen offset:1024 sc1
    s_add_u32 s40, s86, 12
    s_and_b32 s40, s40, 15
    v_mfma_f32_16x16x32_bf16 v[156:159], a[108:111], v[200:203], v[156:159]
    s_lshl_b32 s40, s40, 10
    v_add_u32 v243, s40, v240
    v_mfma_f32_16x16x32_bf16 v[156:159], a[92:95], v[196:199], v[156:159]
    s_add_u32 s40, s86, 14
    s_and_b32 s40, s40, 15
    v_mfma_f32_16x16x32_bf16 v[156:159], a[44:47], v[192:195], v[156:159]
    s_lshl_b32 s40, s40, 10
    v_add_u32 v249, s40, v240
    s_waitcnt vmcnt(13)
    v_mfma_f32_16x16x32_bf16 v[96:99], a[112:115], v[208:211], v[96:99]
    buffer_load_dwordx4 v[192:195], v243, s[44:47], s16 offen offset:0 sc1
    v_mfma_f32_16x16x32_bf16 v[96:99], a[128:131], v[212:215], v[96:99]
    v_mfma_f32_16x16x32_bf16 v[96:99], a[144:147], v[216:219], v[96:99]
    v_mfma_f32_16x16x32_bf16 v[96:99], a[160:163], v[220:223], v[96:99]
    v_mfma_f32_16x16x32_bf16 v[100:103], a[164:167], v[220:223], v[100:103]
    buffer_load_dwordx4 v[196:199], v243, s[44:47], s16 offen offset:1024 sc1
    v_mfma_f32_16x16x32_bf16 v[100:103], a[148:151], v[216:219], v[100:103]
    v_mfma_f32_16x16x32_bf16 v[100:103], a[132:135], v[212:215], v[100:103]
    v_mfma_f32_16x16x32_bf16 v[100:103], a[116:119], v[208:211], v[100:103]
    v_mfma_f32_16x16x32_bf16 v[104:107], a[120:123], v[208:211], v[104:107]
    buffer_load_dwordx4 v[200:203], v249, s[44:47], s16 offen offset:0 sc1
    v_mfma_f32_16x16x32_bf16 v[104:107], a[136:139], v[212:215], v[104:107]
    v_mfma_f32_16x16x32_bf16 v[104:107], a[152:155], v[216:219], v[104:107]
    v_mfma_f32_16x16x32_bf16 v[104:107], a[168:171], v[220:223], v[104:107]
    v_mfma_f32_16x16x32_bf16 v[108:111], a[172:175], v[220:223], v[108:111]
    buffer_load_dwordx4 v[204:207], v249, s[44:47], s16 offen offset:1024 sc1
    v_mfma_f32_16x16x32_bf16 v[108:111], a[156:159], v[216:219], v[108:111]
    v_mfma_f32_16x16x32_bf16 v[108:111], a[140:143], v[212:215], v[108:111]
    v_mfma_f32_16x16x32_bf16 v[108:111], a[124:127], v[208:211], v[108:111]
    s_waitcnt vmcnt(13)
    v_mfma_f32_16x16x32_bf16 v[112:115], a[112:115], v[224:227], v[112:115]
    buffer_load_dwordx4 v[208:211], v243, s[44:47], s17 offen offset:0 sc1
    v_mfma_f32_16x16x32_bf16 v[112:115], a[128:131], v[228:231], v[112:115]
    v_mfma_f32_16x16x32_bf16 v[112:115], a[144:147], v[232:235], v[112:115]
    v_mfma_f32_16x16x32_bf16 v[112:115], a[160:163], v[236:239], v[112:115]
    v_mfma_f32_16x16x32_bf16 v[116:119], a[164:167], v[236:239], v[116:119]
    buffer_load_dwordx4 v[212:215], v243, s[44:47], s17 offen offset:1024 sc1
    v_mfma_f32_16x16x32_bf16 v[116:119], a[148:151], v[232:235], v[116:119]
    v_mfma_f32_16x16x32_bf16 v[116:119], a[132:135], v[228:231], v[116:119]
    v_mfma_f32_16x16x32_bf16 v[116:119], a[116:119], v[224:227], v[116:119]
    v_mfma_f32_16x16x32_bf16 v[120:123], a[120:123], v[224:227], v[120:123]
    buffer_load_dwordx4 v[216:219], v249, s[44:47], s17 offen offset:0 sc1
    v_mfma_f32_16x16x32_bf16 v[120:123], a[136:139], v[228:231], v[120:123]
    v_mfma_f32_16x16x32_bf16 v[120:123], a[152:155], v[232:235], v[120:123]
    v_mfma_f32_16x16x32_bf16 v[120:123], a[168:171], v[236:239], v[120:123]
    v_mfma_f32_16x16x32_bf16 v[124:127], a[172:175], v[236:239], v[124:127]
    buffer_load_dwordx4 v[220:223], v249, s[44:47], s17 offen offset:1024 sc1
    v_mfma_f32_16x16x32_bf16 v[124:127], a[156:159], v[232:235], v[124:127]
    v_mfma_f32_16x16x32_bf16 v[124:127], a[140:143], v[228:231], v[124:127]
    v_mfma_f32_16x16x32_bf16 v[124:127], a[124:127], v[224:227], v[124:127]
    s_waitcnt vmcnt(13)
    v_mfma_f32_16x16x32_bf16 v[128:131], a[112:115], v[160:163], v[128:131]
    buffer_load_dwordx4 v[224:227], v243, s[44:47], s18 offen offset:0 sc1
    v_mfma_f32_16x16x32_bf16 v[128:131], a[128:131], v[164:167], v[128:131]
    v_mfma_f32_16x16x32_bf16 v[128:131], a[144:147], v[168:171], v[128:131]
    v_mfma_f32_16x16x32_bf16 v[128:131], a[160:163], v[172:175], v[128:131]
    v_mfma_f32_16x16x32_bf16 v[132:135], a[164:167], v[172:175], v[132:135]
    buffer_load_dwordx4 v[228:231], v243, s[44:47], s18 offen offset:1024 sc1
    v_mfma_f32_16x16x32_bf16 v[132:135], a[148:151], v[168:171], v[132:135]
    v_mfma_f32_16x16x32_bf16 v[132:135], a[132:135], v[164:167], v[132:135]
    v_mfma_f32_16x16x32_bf16 v[132:135], a[116:119], v[160:163], v[132:135]
    v_mfma_f32_16x16x32_bf16 v[136:139], a[120:123], v[160:163], v[136:139]
    buffer_load_dwordx4 v[232:235], v249, s[44:47], s18 offen offset:0 sc1
    v_mfma_f32_16x16x32_bf16 v[136:139], a[136:139], v[164:167], v[136:139]
    v_mfma_f32_16x16x32_bf16 v[136:139], a[152:155], v[168:171], v[136:139]
    v_mfma_f32_16x16x32_bf16 v[136:139], a[168:171], v[172:175], v[136:139]
    v_mfma_f32_16x16x32_bf16 v[140:143], a[172:175], v[172:175], v[140:143]
    buffer_load_dwordx4 v[236:239], v249, s[44:47], s18 offen offset:1024 sc1
    v_mfma_f32_16x16x32_bf16 v[140:143], a[156:159], v[168:171], v[140:143]
    v_mfma_f32_16x16x32_bf16 v[140:143], a[140:143], v[164:167], v[140:143]
    v_mfma_f32_16x16x32_bf16 v[140:143], a[124:127], v[160:163], v[140:143]
    s_waitcnt vmcnt(12)
    v_mfma_f32_16x16x32_bf16 v[144:147], a[112:115], v[176:179], v[144:147]
    buffer_load_dwordx4 v[160:163], v243, s[44:47], s19 offen offset:0 sc1
    v_mfma_f32_16x16x32_bf16 v[144:147], a[128:131], v[180:183], v[144:147]
    v_mfma_f32_16x16x32_bf16 v[144:147], a[144:147], v[184:187], v[144:147]
    v_mfma_f32_16x16x32_bf16 v[144:147], a[160:163], v[188:191], v[144:147]
    v_mfma_f32_16x16x32_bf16 v[148:151], a[164:167], v[188:191], v[148:151]
    buffer_load_dwordx4 v[164:167], v243, s[44:47], s19 offen offset:1024 sc1
    v_mfma_f32_16x16x32_bf16 v[148:151], a[148:151], v[184:187], v[148:151]
    v_mfma_f32_16x16x32_bf16 v[148:151], a[132:135], v[180:183], v[148:151]
    v_mfma_f32_16x16x32_bf16 v[148:151], a[116:119], v[176:179], v[148:151]
    v_mfma_f32_16x16x32_bf16 v[152:155], a[120:123], v[176:179], v[152:155]
    buffer_load_dwordx4 v[168:171], v249, s[44:47], s19 offen offset:0 sc1
    v_mfma_f32_16x16x32_bf16 v[152:155], a[136:139], v[180:183], v[152:155]
    v_mfma_f32_16x16x32_bf16 v[152:155], a[152:155], v[184:187], v[152:155]
    v_mfma_f32_16x16x32_bf16 v[152:155], a[168:171], v[188:191], v[152:155]
    v_mfma_f32_16x16x32_bf16 v[156:159], a[172:175], v[188:191], v[156:159]
    buffer_load_dwordx4 v[172:175], v249, s[44:47], s19 offen offset:1024 sc1
    v_mfma_f32_16x16x32_bf16 v[156:159], a[156:159], v[184:187], v[156:159]
    v_mfma_f32_16x16x32_bf16 v[156:159], a[140:143], v[180:183], v[156:159]
    v_mfma_f32_16x16x32_bf16 v[156:159], a[124:127], v[176:179], v[156:159]
    s_waitcnt vmcnt(12)
    v_mfma_f32_16x16x32_bf16 v[96:99], a[176:179], v[192:195], v[96:99]
    buffer_load_dword v14, v1, s[96:99], 0 offen sc1
    v_mfma_f32_16x16x32_bf16 v[96:99], a[192:195], v[196:199], v[96:99]
    v_mfma_f32_16x16x32_bf16 v[96:99], a[208:211], v[200:203], v[96:99]
    v_mfma_f32_16x16x32_bf16 v[96:99], a[224:227], v[204:207], v[96:99]
    v_mfma_f32_16x16x32_bf16 v[100:103], a[228:231], v[204:207], v[100:103]
    v_mfma_f32_16x16x32_bf16 v[100:103], a[212:215], v[200:203], v[100:103]
    v_mfma_f32_16x16x32_bf16 v[100:103], a[196:199], v[196:199], v[100:103]
    v_mfma_f32_16x16x32_bf16 v[100:103], a[180:183], v[192:195], v[100:103]
    v_mfma_f32_16x16x32_bf16 v[104:107], a[184:187], v[192:195], v[104:107]
    v_mfma_f32_16x16x32_bf16 v[104:107], a[200:203], v[196:199], v[104:107]
    v_mfma_f32_16x16x32_bf16 v[104:107], a[216:219], v[200:203], v[104:107]
    v_mfma_f32_16x16x32_bf16 v[104:107], a[232:235], v[204:207], v[104:107]
    v_mfma_f32_16x16x32_bf16 v[108:111], a[236:239], v[204:207], v[108:111]
    v_mfma_f32_16x16x32_bf16 v[108:111], a[220:223], v[200:203], v[108:111]
    v_mfma_f32_16x16x32_bf16 v[108:111], a[204:207], v[196:199], v[108:111]
    v_mfma_f32_16x16x32_bf16 v[108:111], a[188:191], v[192:195], v[108:111]
    s_waitcnt vmcnt(9)
    v_mfma_f32_16x16x32_bf16 v[112:115], a[176:179], v[208:211], v[112:115]
    v_mfma_f32_16x16x32_bf16 v[112:115], a[192:195], v[212:215], v[112:115]
    v_mfma_f32_16x16x32_bf16 v[112:115], a[208:211], v[216:219], v[112:115]
    v_mfma_f32_16x16x32_bf16 v[112:115], a[224:227], v[220:223], v[112:115]
    ds_write_b128 v7, v[100:103] offset:0
    v_mfma_f32_16x16x32_bf16 v[116:119], a[228:231], v[220:223], v[116:119]
    v_mfma_f32_16x16x32_bf16 v[116:119], a[212:215], v[216:219], v[116:119]
    v_mfma_f32_16x16x32_bf16 v[116:119], a[196:199], v[212:215], v[116:119]
    v_mfma_f32_16x16x32_bf16 v[116:119], a[180:183], v[208:211], v[116:119]
    ds_write_b128 v8, v[104:107] offset:0
    v_mfma_f32_16x16x32_bf16 v[120:123], a[184:187], v[208:211], v[120:123]
    v_mfma_f32_16x16x32_bf16 v[120:123], a[200:203], v[212:215], v[120:123]
    v_mfma_f32_16x16x32_bf16 v[120:123], a[216:219], v[216:219], v[120:123]
    v_mfma_f32_16x16x32_bf16 v[120:123], a[232:235], v[220:223], v[120:123]
    ds_write_b128 v9, v[108:111] offset:0
    v_mfma_f32_16x16x32_bf16 v[124:127], a[236:239], v[220:223], v[124:127]
    v_mfma_f32_16x16x32_bf16 v[124:127], a[220:223], v[216:219], v[124:127]
    v_mfma_f32_16x16x32_bf16 v[124:127], a[204:207], v[212:215], v[124:127]
    v_mfma_f32_16x16x32_bf16 v[124:127], a[188:191], v[208:211], v[124:127]
    s_waitcnt vmcnt(0)
    v_cmp_ne_u32 vcc, 1, v14
    s_mov_b32 s41, 0x40000
    s_nop 0
    s_cbranch_vccnz L_late
    v_mfma_f32_16x16x32_bf16 v[128:131], a[176:179], v[224:227], v[128:131]
    buffer_load_dwordx4 v[20:23], v248, s[96:99], s35 offen offset:0 sc1
    v_mfma_f32_16x16x32_bf16 v[128:131], a[192:195], v[228:231], v[128:131]
    buffer_load_dwordx4 v[36:39], v248, s[96:99], s35 offen offset:1024 sc1
    v_mfma_f32_16x16x32_bf16 v[128:131], a[208:211], v[232:235], v[128:131]
    buffer_load_dwordx4 v[52:55], v248, s[96:99], s35 offen offset:2048 sc1
    v_mfma_f32_16x16x32_bf16 v[128:131], a[224:227], v[236:239], v[128:131]
    ds_write_b128 v7, v[116:119] offset:1024
    v_mfma_f32_16x16x32_bf16 v[132:135], a[228:231], v[236:239], v[132:135]
    buffer_load_dwordx4 v[68:71], v248, s[96:99], s35 offen offset:3072 sc1
    v_mfma_f32_16x16x32_bf16 v[132:135], a[212:215], v[232:235], v[132:135]
    buffer_load_dwordx4 v[84:87], v248, s[96:99], s36 offen offset:0 sc1
    v_mfma_f32_16x16x32_bf16 v[132:135], a[196:199], v[228:231], v[132:135]
    v_mfma_f32_16x16x32_bf16 v[132:135], a[180:183], v[224:227], v[132:135]
    ds_write_b128 v8, v[120:123] offset:1024
    v_mfma_f32_16x16x32_bf16 v[136:139], a[184:187], v[224:227], v[136:139]
    v_mfma_f32_16x16x32_bf16 v[136:139], a[200:203], v[228:231], v[136:139]
    v_mfma_f32_16x16x32_bf16 v[136:139], a[216:219], v[232:235], v[136:139]
    v_mfma_f32_16x16x32_bf16 v[136:139], a[232:235], v[236:239], v[136:139]
    ds_write_b128 v9, v[124:127] offset:1024
    v_mfma_f32_16x16x32_bf16 v[140:143], a[236:239], v[236:239], v[140:143]
    v_mfma_f32_16x16x32_bf16 v[140:143], a[220:223], v[232:235], v[140:143]
    v_mfma_f32_16x16x32_bf16 v[140:143], a[204:207], v[228:231], v[140:143]
    v_mfma_f32_16x16x32_bf16 v[140:143], a[188:191], v[224:227], v[140:143]
    v_mfma_f32_16x16x32_bf16 v[144:147], a[176:179], v[160:163], v[144:147]
    v_mfma_f32_16x16x32_bf16 v[144:147], a[192:195], v[164:167], v[144:147]
    v_mfma_f32_16x16x32_bf16 v[144:147], a[208:211], v[168:171], v[144:147]
    v_mfma_f32_16x16x32_bf16 v[144:147], a[224:227], v[172:175], v[144:147]
    ds_write_b128 v7, v[132:135] offset:2048
    v_mfma_f32_16x16x32_bf16 v[148:151], a[228:231], v[172:175], v[148:151]
    v_mfma_f32_16x16x32_bf16 v[148:151], a[212:215], v[168:171], v[148:151]
    v_mfma_f32_16x16x32_bf16 v[148:151], a[196:199], v[164:167], v[148:151]
    v_mfma_f32_16x16x32_bf16 v[148:151], a[180:183], v[160:163], v[148:151]
    ds_write_b128 v8, v[136:139] offset:2048
    v_mfma_f32_16x16x32_bf16 v[152:155], a[184:187], v[160:163], v[152:155]
    v_mfma_f32_16x16x32_bf16 v[152:155], a[200:203], v[164:167], v[152:155]
    v_mfma_f32_16x16x32_bf16 v[152:155], a[216:219], v[168:171], v[152:155]
    v_mfma_f32_16x16x32_bf16 v[152:155], a[232:235], v[172:175], v[152:155]
    ds_write_b128 v9, v[140:143] offset:2048
    v_mfma_f32_16x16x32_bf16 v[156:159], a[236:239], v[172:175], v[156:159]
    v_mfma_f32_16x16x32_bf16 v[156:159], a[220:223], v[168:171], v[156:159]
    v_mfma_f32_16x16x32_bf16 v[156:159], a[204:207], v[164:167], v[156:159]
    v_mfma_f32_16x16x32_bf16 v[156:159], a[188:191], v[160:163], v[156:159]
L_join:
    ds_write_b128 v7, v[148:151] offset:3072
    s_nop 1
    ds_write_b128 v8, v[152:155] offset:3072
    s_nop 3
    ds_write_b128 v9, v[156:159] offset:3072
    s_waitcnt lgkmcnt(0)
    s_barrier
    ds_read_b128 v[100:103], v11 offset:0
    ds_read_b128 v[104:107], v11 offset:4096
    ds_read_b128 v[108:111], v11 offset:8192
    ds_read_b128 v[116:119], v11 offset:1024
    ds_read_b128 v[120:123], v11 offset:5120
    ds_read_b128 v[124:127], v11 offset:9216
    ds_read_b128 v[132:135], v11 offset:2048
    ds_read_b128 v[136:139], v11 offset:6144
    ds_read_b128 v[140:143], v11 offset:10240
    ds_read_b128 v[148:151], v11 offset:3072
    ds_read_b128 v[152:155], v11 offset:7168
    ds_read_b128 v[156:159], v11 offset:11264
    s_waitcnt vmcnt(0)
    v_pk_add_f32 v[80:81], v[80:81], v[84:85]
    v_pk_add_f32 v[82:83], v[82:83], v[86:87]
    v_cvt_pk_bf16_f32 v80, v80, v81
    v_cvt_pk_bf16_f32 v81, v82, v83
    buffer_store_dwordx2 v[80:81], v12, s[4:7], s37 offen
    v_pk_add_f32 v[96:97], v[96:97], v[20:21]
    v_pk_add_f32 v[98:99], v[98:99], v[22:23]
    s_waitcnt lgkmcnt(9)
    v_pk_add_f32 v[96:97], v[96:97], v[100:101]
    v_pk_add_f32 v[104:105], v[104:105], v[108:109]
    v_pk_add_f32 v[98:99], v[98:99], v[102:103]
    v_pk_add_f32 v[106:107], v[106:107], v[110:111]
    v_pk_add_f32 v[96:97], v[96:97], v[104:105]
    v_pk_add_f32 v[98:99], v[98:99], v[106:107]
    s_lshr_b32 s41, s16, 3
    v_cvt_pk_bf16_f32 v96, v96, v97
    v_cvt_pk_bf16_f32 v97, v98, v99
    buffer_store_dwordx2 v[96:97], v12, s[4:7], s41 offen
    v_pk_add_f32 v[112:113], v[112:113], v[36:37]
    v_pk_add_f32 v[114:115], v[114:115], v[38:39]
    s_waitcnt lgkmcnt(6)
    v_pk_add_f32 v[112:113], v[112:113], v[116:117]
    v_pk_add_f32 v[120:121], v[120:121], v[124:125]
    v_pk_add_f32 v[114:115], v[114:115], v[118:119]
    v_pk_add_f32 v[122:123], v[122:123], v[126:127]
    v_pk_add_f32 v[112:113], v[112:113], v[120:121]
    v_pk_add_f32 v[114:115], v[114:115], v[122:123]
    s_lshr_b32 s41, s17, 3
    v_cvt_pk_bf16_f32 v112, v112, v113
    v_cvt_pk_bf16_f32 v113, v114, v115
    buffer_store_dwordx2 v[112:113], v12, s[4:7], s41 offen
    v_pk_add_f32 v[128:129], v[128:129], v[52:53]
    v_pk_add_f32 v[130:131], v[130:131], v[54:55]
    s_waitcnt lgkmcnt(3)
    v_pk_add_f32 v[128:129], v[128:129], v[132:133]
    v_pk_add_f32 v[136:137], v[136:137], v[140:141]
    v_pk_add_f32 v[130:131], v[130:131], v[134:135]
    v_pk_add_f32 v[138:139], v[138:139], v[142:143]
    v_pk_add_f32 v[128:129], v[128:129], v[136:137]
    v_pk_add_f32 v[130:131], v[130:131], v[138:139]
    s_lshr_b32 s41, s18, 3
    v_cvt_pk_bf16_f32 v128, v128, v129
    v_cvt_pk_bf16_f32 v129, v130, v131
    buffer_store_dwordx2 v[128:129], v12, s[4:7], s41 offen
    v_pk_add_f32 v[144:145], v[144:145], v[68:69]
    v_pk_add_f32 v[146:147], v[146:147], v[70:71]
    s_waitcnt lgkmcnt(0)
    v_pk_add_f32 v[144:145], v[144:145], v[148:149]
    v_pk_add_f32 v[152:153], v[152:153], v[156:157]
    v_pk_add_f32 v[146:147], v[146:147], v[150:151]
    v_pk_add_f32 v[154:155], v[154:155], v[158:159]
    v_pk_add_f32 v[144:145], v[144:145], v[152:153]
    v_pk_add_f32 v[146:147], v[146:147], v[154:155]
    s_lshr_b32 s41, s19, 3
    v_cvt_pk_bf16_f32 v144, v144, v145
    v_cvt_pk_bf16_f32 v145, v146, v147
    buffer_store_dwordx2 v[144:145], v12, s[4:7], s41 offen
L_end:
    s_endpgm
L_late:
    v_mfma_f32_16x16x32_bf16 v[128:131], a[176:179], v[224:227], v[128:131]
    v_mfma_f32_16x16x32_bf16 v[128:131], a[192:195], v[228:231], v[128:131]
    v_mfma_f32_16x16x32_bf16 v[128:131], a[208:211], v[232:235], v[128:131]
    v_mfma_f32_16x16x32_bf16 v[128:131], a[224:227], v[236:239], v[128:131]
    ds_write_b128 v7, v[116:119] offset:1024
    v_mfma_f32_16x16x32_bf16 v[132:135], a[228:231], v[236:239], v[132:135]
    v_mfma_f32_16x16x32_bf16 v[132:135], a[212:215], v[232:235], v[132:135]
    v_mfma_f32_16x16x32_bf16 v[132:135], a[196:199], v[228:231], v[132:135]
    v_mfma_f32_16x16x32_bf16 v[132:135], a[180:183], v[224:227], v[132:135]
    ds_write_b128 v8, v[120:123] offset:1024
    v_mfma_f32_16x16x32_bf16 v[136:139], a[184:187], v[224:227], v[136:139]
    v_mfma_f32_16x16x32_bf16 v[136:139], a[200:203], v[228:231], v[136:139]
    v_mfma_f32_16x16x32_bf16 v[136:139], a[216:219], v[232:235], v[136:139]
    v_mfma_f32_16x16x32_bf16 v[136:139], a[232:235], v[236:239], v[136:139]
    ds_write_b128 v9, v[124:127] offset:1024
    v_mfma_f32_16x16x32_bf16 v[140:143], a[236:239], v[236:239], v[140:143]
    v_mfma_f32_16x16x32_bf16 v[140:143], a[220:223], v[232:235], v[140:143]
    v_mfma_f32_16x16x32_bf16 v[140:143], a[204:207], v[228:231], v[140:143]
    v_mfma_f32_16x16x32_bf16 v[140:143], a[188:191], v[224:227], v[140:143]
    v_mfma_f32_16x16x32_bf16 v[144:147], a[176:179], v[160:163], v[144:147]
    v_mfma_f32_16x16x32_bf16 v[144:147], a[192:195], v[164:167], v[144:147]
    v_mfma_f32_16x16x32_bf16 v[144:147], a[208:211], v[168:171], v[144:147]
    v_mfma_f32_16x16x32_bf16 v[144:147], a[224:227], v[172:175], v[144:147]
    ds_write_b128 v7, v[132:135] offset:2048
    v_mfma_f32_16x16x32_bf16 v[148:151], a[228:231], v[172:175], v[148:151]
    v_mfma_f32_16x16x32_bf16 v[148:151], a[212:215], v[168:171], v[148:151]
    v_mfma_f32_16x16x32_bf16 v[148:151], a[196:199], v[164:167], v[148:151]
    v_mfma_f32_16x16x32_bf16 v[148:151], a[180:183], v[160:163], v[148:151]
    ds_write_b128 v8, v[136:139] offset:2048
    v_mfma_f32_16x16x32_bf16 v[152:155], a[184:187], v[160:163], v[152:155]
    v_mfma_f32_16x16x32_bf16 v[152:155], a[200:203], v[164:167], v[152:155]
    v_mfma_f32_16x16x32_bf16 v[152:155], a[216:219], v[168:171], v[152:155]
    v_mfma_f32_16x16x32_bf16 v[152:155], a[232:235], v[172:175], v[152:155]
    ds_write_b128 v9, v[140:143] offset:2048
    v_mfma_f32_16x16x32_bf16 v[156:159], a[236:239], v[172:175], v[156:159]
    v_mfma_f32_16x16x32_bf16 v[156:159], a[220:223], v[168:171], v[156:159]
    v_mfma_f32_16x16x32_bf16 v[156:159], a[204:207], v[164:167], v[156:159]
    v_mfma_f32_16x16x32_bf16 v[156:159], a[188:191], v[160:163], v[156:159]
L_x0:
    buffer_load_dword v14, v1, s[96:99], 0 offen sc1
    s_sub_u32 s41, s41, 1
    s_waitcnt vmcnt(0)
    v_cmp_ne_u32 vcc, 1, v14
    s_nop 1
    s_cbranch_vccz L_x1
    s_cmp_gt_i32 s41, 0
    s_cbranch_scc1 L_x0
L_x1:
    buffer_load_dwordx4 v[20:23], v248, s[96:99], s35 offen offset:0 sc1
    buffer_load_dwordx4 v[36:39], v248, s[96:99], s35 offen offset:1024 sc1
    buffer_load_dwordx4 v[52:55], v248, s[96:99], s35 offen offset:2048 sc1
    buffer_load_dwordx4 v[68:71], v248, s[96:99], s35 offen offset:3072 sc1
    buffer_load_dwordx4 v[84:87], v248, s[96:99], s36 offen offset:0 sc1
    s_branch L_join
L_hot_end:
L_safe:
    s_mov_b32 s91, 1
    s_waitcnt vmcnt(0)
    s_barrier
    s_branch L_restart
L_safe2:
    v_cvt_pk_bf16_f32 v49, v50, v51
    v_cvt_pk_bf16_f32 v50, v52, v53
    v_cvt_pk_bf16_f32 v51, v54, v55
    v_mul_f32 v56, s38, v56
    v_mul_f32 v57, s38, v57
    v_mul_f32 v58, s38, v58
    v_mul_f32 v59, s38, v59
    v_mul_f32 v60, s38, v60
    v_mul_f32 v61, s38, v61
    v_mul_f32 v62, s38, v62
    v_mul_f32 v63, s38, v63
    v_cvt_pk_bf16_f32 v56, v56, v57
    v_cvt_pk_bf16_f32 v57, v58, v59
    v_cvt_pk_bf16_f32 v58, v60, v61
    v_cvt_pk_bf16_f32 v59, v62, v63
    v_permlane16_swap_b32 v48, v50
    v_permlane16_swap_b32 v49, v51
    v_accvgpr_write_b32 a16, v48
    v_accvgpr_write_b32 a17, v49
    v_accvgpr_write_b32 a18, v50
    v_accvgpr_write_b32 a19, v51
    v_mul_f32 v64, s38, v64
    v_mul_f32 v65, s38, v65
    v_mul_f32 v66, s38, v66
    v_mul_f32 v67, s38, v67
    v_mul_f32 v68, s38, v68
    v_mul_f32 v69, s38, v69
    v_mul_f32 v70, s38, v70
    v_mul_f32 v71, s38, v71
    v_cvt_pk_bf16_f32 v64, v64, v65
    v_cvt_pk_bf16_f32 v65, v66, v67
    v_cvt_pk_bf16_f32 v66, v68, v69
    v_cvt_pk_bf16_f32 v67, v70, v71
    v_permlane16_swap_b32 v56, v58
    v_permlane16_swap_b32 v57, v59
    v_accvgpr_write_b32 a20, v56
    v_accvgpr_write_b32 a21, v57
    v_accvgpr_write_b32 a22, v58
    v_accvgpr_write_b32 a23, v59
    v_mul_f32 v72, s38, v72
    v_mul_f32 v73, s38, v73
    v_mul_f32 v74, s38, v74
    v_mul_f32 v75, s38, v75
    v_mul_f32 v76, s38, v76
    v_mul_f32 v77, s38, v77
    v_mul_f32 v78, s38, v78
    v_mul_f32 v79, s38, v79
    v_cvt_pk_bf16_f32 v72, v72, v73
    v_cvt_pk_bf16_f32 v73, v74, v75
    v_cvt_pk_bf16_f32 v74, v76, v77
    v_cvt_pk_bf16_f32 v75, v78, v79
    v_permlane16_swap_b32 v64, v66
    v_permlane16_swap_b32 v65, v67
    v_accvgpr_write_b32 a24, v64
    v_accvgpr_write_b32 a25, v65
    v_accvgpr_write_b32 a26, v66
    v_accvgpr_write_b32 a27, v67
    v_permlane16_swap_b32 v72, v74
    v_permlane16_swap_b32 v73, v75
    v_accvgpr_write_b32 a28, v72
    v_accvgpr_write_b32 a29, v73
    v_accvgpr_write_b32 a30, v74
    v_accvgpr_write_b32 a31, v75
    v_mul_f32 v80, s38, v80
    v_mul_f32 v81, s38, v81
    v_mul_f32 v82, s38, v82
    v_mul_f32 v83, s38, v83
    v_mul_f32 v84, s38, v84
    v_mul_f32 v85, s38, v85
    v_mul_f32 v86, s38, v86
    v_mul_f32 v87, s38, v87
    v_cvt_pk_bf16_f32 v80, v80, v81
    v_cvt_pk_bf16_f32 v81, v82, v83
    v_cvt_pk_bf16_f32 v82, v84, v85
    v_cvt_pk_bf16_f32 v83, v86, v87
    v_mul_f32 v88, s38, v88
    v_mul_f32 v89, s38, v89
    v_mul_f32 v90, s38, v90
    v_mul_f32 v91, s38, v91
    v_mul_f32 v92, s38, v92
    v_mul_f32 v93, s38, v93
    v_mul_f32 v94, s38, v94
    v_mul_f32 v95, s38, v95
    v_cvt_pk_bf16_f32 v88, v88, v89
    v_cvt_pk_bf16_f32 v89, v90, v91
    v_cvt_pk_bf16_f32 v90, v92, v93
    v_cvt_pk_bf16_f32 v91, v94, v95
    v_permlane16_swap_b32 v80, v82
    v_permlane16_swap_b32 v81, v83
    v_accvgpr_write_b32 a32, v80
    v_accvgpr_write_b32 a33, v81
    v_accvgpr_write_b32 a34, v82
    v_accvgpr_write_b32 a35, v83
    v_mul_f32 v96, s38, v96
    v_mul_f32 v97, s38, v97
    v_mul_f32 v98, s38, v98
    v_mul_f32 v99, s38, v99
    v_mul_f32 v100, s38, v100
    v_mul_f32 v101, s38, v101
    v_mul_f32 v102, s38, v102
    v_mul_f32 v103, s38, v103
    v_cvt_pk_bf16_f32 v96, v96, v97
    v_cvt_pk_bf16_f32 v97, v98, v99
    v_cvt_pk_bf16_f32 v98, v100, v101
    v_cvt_pk_bf16_f32 v99, v102, v103
    v_permlane16_swap_b32 v88, v90
    v_permlane16_swap_b32 v89, v91
    v_accvgpr_write_b32 a36, v88
    v_accvgpr_write_b32 a37, v89
    v_accvgpr_write_b32 a38, v90
    v_accvgpr_write_b32 a39, v91
    v_mul_f32 v104, s38, v104
    v_mul_f32 v105, s38, v105
    v_mul_f32 v106, s38, v106
    v_mul_f32 v107, s38, v107
    v_mul_f32 v108, s38, v108
    v_mul_f32 v109, s38, v109
    v_mul_f32 v110, s38, v110
    v_mul_f32 v111, s38, v111
    v_cvt_pk_bf16_f32 v104, v104, v105
    v_cvt_pk_bf16_f32 v105, v106, v107
    v_cvt_pk_bf16_f32 v106, v108, v109
    v_cvt_pk_bf16_f32 v107, v110, v111
    v_permlane16_swap_b32 v96, v98
    v_permlane16_swap_b32 v97, v99
    v_accvgpr_write_b32 a40, v96
    v_accvgpr_write_b32 a41, v97
    v_accvgpr_write_b32 a42, v98
    v_accvgpr_write_b32 a43, v99
    v_permlane16_swap_b32 v104, v106
    v_permlane16_swap_b32 v105, v107
    v_accvgpr_write_b32 a44, v104
    v_accvgpr_write_b32 a45, v105
    v_accvgpr_write_b32 a46, v106
    v_accvgpr_write_b32 a47, v107
    v_mul_f32 v112, s38, v112
    v_mul_f32 v113, s38, v113
    v_mul_f32 v114, s38, v114
    v_mul_f32 v115, s38, v115
    v_mul_f32 v116, s38, v116
    v_mul_f32 v117, s38, v117
    v_mul_f32 v118, s38, v118
    v_mul_f32 v119, s38, v119
    v_cvt_pk_bf16_f32 v112, v112, v113
    v_cvt_pk_bf16_f32 v113, v114, v115
    v_cvt_pk_bf16_f32 v114, v116, v117
    v_cvt_pk_bf16_f32 v115, v118, v119
    v_mul_f32 v120, s38, v120
    v_mul_f32 v121, s38, v121
    v_mul_f32 v122, s38, v122
    v_mul_f32 v123, s38, v123
    v_mul_f32 v124, s38, v124
    v_mul_f32 v125, s38, v125
    v_mul_f32 v126, s38, v126
    v_mul_f32 v127, s38, v127
    v_cvt_pk_bf16_f32 v120, v120, v121
    v_cvt_pk_bf16_f32 v121, v122, v123
    v_cvt_pk_bf16_f32 v122, v124, v125
    v_cvt_pk_bf16_f32 v123, v126, v127
    v_permlane16_swap_b32 v112, v114
    v_permlane16_swap_b32 v113, v115
    v_accvgpr_write_b32 a48, v112
    v_accvgpr_write_b32 a49, v113
    v_accvgpr_write_b32 a50, v114
    v_accvgpr_write_b32 a51, v115
    v_mul_f32 v128, s38, v128
    v_mul_f32 v129, s38, v129
    v_mul_f32 v130, s38, v130
    v_mul_f32 v131, s38, v131
    v_mul_f32 v132, s38, v132
    v_mul_f32 v133, s38, v133
    v_mul_f32 v134, s38, v134
    v_mul_f32 v135, s38, v135
    v_cvt_pk_bf16_f32 v128, v128, v129
    v_cvt_pk_bf16_f32 v129, v130, v131
    v_cvt_pk_bf16_f32 v130, v132, v133
    v_cvt_pk_bf16_f32 v131, v134, v135
    v_permlane16_swap_b32 v120, v122
    v_permlane16_swap_b32 v121, v123
    v_accvgpr_write_b32 a52, v120
    v_accvgpr_write_b32 a53, v121
    v_accvgpr_write_b32 a54, v122
    v_accvgpr_write_b32 a55, v123
    v_mul_f32 v136, s38, v136
    v_mul_f32 v137, s38, v137
    v_mul_f32 v138, s38, v138
    v_mul_f32 v139, s38, v139
    v_mul_f32 v140, s38, v140
    v_mul_f32 v141, s38, v141
    v_mul_f32 v142, s38, v142
    v_mul_f32 v143, s38, v143
    v_cvt_pk_bf16_f32 v136, v136, v137
    v_cvt_pk_bf16_f32 v137, v138, v139
    v_cvt_pk_bf16_f32 v138, v140, v141
    v_cvt_pk_bf16_f32 v139, v142, v143
    v_permlane16_swap_b32 v128, v130
    v_permlane16_swap_b32 v129, v131
    v_accvgpr_write_b32 a56, v128
    v_accvgpr_write_b32 a57, v129
    v_accvgpr_write_b32 a58, v130
    v_accvgpr_write_b32 a59, v131
    v_permlane16_swap_b32 v136, v138
    v_permlane16_swap_b32 v137, v139
    v_accvgpr_write_b32 a60, v136
    v_accvgpr_write_b32 a61, v137
    v_accvgpr_write_b32 a62, v138
    v_accvgpr_write_b32 a63, v139
    s_waitcnt vmcnt(0) lgkmcnt(0)
    s_mov_b32 s35, 0
    v_mov_b32 v16, 0
    v_mov_b32 v17, 0
    v_mov_b32 v18, 0
    v_mov_b32 v19, 0
    v_mov_b32 v20, 0
    v_mov_b32 v21, 0
    v_mov_b32 v22, 0
    v_mov_b32 v23, 0
    v_mov_b32 v24, 0
    v_mov_b32 v25, 0
    v_mov_b32 v26, 0
    v_mov_b32 v27, 0
    v_mov_b32 v28, 0
    v_mov_b32 v29, 0
    v_mov_b32 v30, 0
    v_mov_b32 v31, 0
    v_mov_b32 v32, 0
    v_mov_b32 v33, 0
    v_mov_b32 v34, 0
    v_mov_b32 v35, 0
    v_mov_b32 v36, 0
    v_mov_b32 v37, 0
    v_mov_b32 v38, 0
    v_mov_b32 v39, 0
    v_mov_b32 v40, 0
    v_mov_b32 v41, 0
    v_mov_b32 v42, 0
    v_mov_b32 v43, 0
    v_mov_b32 v44, 0
    v_mov_b32 v45, 0
    v_mov_b32 v46, 0
    v_mov_b32 v47, 0
    v_mov_b32 v48, 0
    v_mov_b32 v49, 0
    v_mov_b32 v50, 0
    v_mov_b32 v51, 0
    v_mov_b32 v52, 0
    v_mov_b32 v53, 0
    v_mov_b32 v54, 0
    v_mov_b32 v55, 0
    v_mov_b32 v56, 0
    v_mov_b32 v57, 0
    v_mov_b32 v58, 0
    v_mov_b32 v59, 0
    v_mov_b32 v60, 0
    v_mov_b32 v61, 0
    v_mov_b32 v62, 0
    v_mov_b32 v63, 0
    v_mov_b32 v64, 0
    v_mov_b32 v65, 0
    v_mov_b32 v66, 0
    v_mov_b32 v67, 0
    v_mov_b32 v68, 0
    v_mov_b32 v69, 0
    v_mov_b32 v70, 0
    v_mov_b32 v71, 0
    v_mov_b32 v72, 0
    v_mov_b32 v73, 0
    v_mov_b32 v74, 0
    v_mov_b32 v75, 0
    v_mov_b32 v76, 0
    v_mov_b32 v77, 0
    v_mov_b32 v78, 0
    v_mov_b32 v79, 0
    v_mov_b32 v80, 0
    v_mov_b32 v81, 0
    v_mov_b32 v82, 0
    v_mov_b32 v83, 0
    v_mov_b32 v84, 0
    v_mov_b32 v85, 0
    v_mov_b32 v86, 0
    v_mov_b32 v87, 0
    v_mov_b32 v88, 0
    v_mov_b32 v89, 0
    v_mov_b32 v90, 0
    v_mov_b32 v91, 0
    v_mov_b32 v92, 0
    v_mov_b32 v93, 0
    v_mov_b32 v94, 0
    v_mov_b32 v95, 0
    v_mov_b32 v96, 0
    v_mov_b32 v97, 0
    v_mov_b32 v98, 0
    v_mov_b32 v99, 0
    v_mov_b32 v100, 0
    v_mov_b32 v101, 0
    v_mov_b32 v102, 0
    v_mov_b32 v103, 0
    v_mov_b32 v104, 0
    v_mov_b32 v105, 0
    v_mov_b32 v106, 0
    v_mov_b32 v107, 0
    v_mov_b32 v108, 0
    v_mov_b32 v109, 0
    v_mov_b32 v110, 0
    v_mov_b32 v111, 0
    v_mov_b32 v112, 0
    v_mov_b32 v113, 0
    v_mov_b32 v114, 0
    v_mov_b32 v115, 0
    v_mov_b32 v116, 0
    v_mov_b32 v117, 0
    v_mov_b32 v118, 0
    v_mov_b32 v119, 0
    v_mov_b32 v120, 0
    v_mov_b32 v121, 0
    v_mov_b32 v122, 0
    v_mov_b32 v123, 0
    v_mov_b32 v124, 0
    v_mov_b32 v125, 0
    v_mov_b32 v126, 0
    v_mov_b32 v127, 0
    v_mov_b32 v128, 0
    v_mov_b32 v129, 0
    v_mov_b32 v130, 0
    v_mov_b32 v131, 0
    v_mov_b32 v132, 0
    v_mov_b32 v133, 0
    v_mov_b32 v134, 0
    v_mov_b32 v135, 0
    v_mov_b32 v136, 0
    v_mov_b32 v137, 0
    v_mov_b32 v138, 0
    v_mov_b32 v139, 0
    v_mov_b32 v140, 0
    v_mov_b32 v141, 0
    v_mov_b32 v142, 0
    v_mov_b32 v143, 0
    v_mov_b32 v144, 0
    v_mov_b32 v145, 0
    v_mov_b32 v146, 0
    v_mov_b32 v147, 0
    v_mov_b32 v148, 0
    v_mov_b32 v149, 0
    v_mov_b32 v150, 0
    v_mov_b32 v151, 0
    v_mov_b32 v152, 0
    v_mov_b32 v153, 0
    v_mov_b32 v154, 0
    v_mov_b32 v155, 0
    v_mov_b32 v156, 0
    v_mov_b32 v157, 0
    v_mov_b32 v158, 0
    v_mov_b32 v159, 0
    v_mov_b32 v160, 0
    v_mov_b32 v161, 0
    v_mov_b32 v162, 0
    v_mov_b32 v163, 0
    v_mov_b32 v164, 0
    v_mov_b32 v165, 0
    v_mov_b32 v166, 0
    v_mov_b32 v167, 0
    v_mov_b32 v168, 0
    v_mov_b32 v169, 0
    v_mov_b32 v170, 0
    v_mov_b32 v171, 0
    v_mov_b32 v172, 0
    v_mov_b32 v173, 0
    v_mov_b32 v174, 0
    v_mov_b32 v175, 0
    v_mov_b32 v250, 0xff800000
    v_accvgpr_write_b32 a208, 0
    v_accvgpr_write_b32 a209, 0
    v_accvgpr_write_b32 a210, 0
    v_accvgpr_write_b32 a211, 0
    v_mov_b32 v251, 0xff800000
    v_accvgpr_write_b32 a212, 0
    v_accvgpr_write_b32 a213, 0
    v_accvgpr_write_b32 a214, 0
    v_accvgpr_write_b32 a215, 0
    v_mov_b32 v252, 0xff800000
    v_accvgpr_write_b32 a216, 0
    v_accvgpr_write_b32 a217, 0
    v_accvgpr_write_b32 a218, 0
    v_accvgpr_write_b32 a219, 0
    v_mov_b32 v253, 0xff800000
    v_accvgpr_write_b32 a220, 0
    v_accvgpr_write_b32 a221, 0
    v_accvgpr_write_b32 a222, 0
    v_accvgpr_write_b32 a223, 0
    v_mov_b32 v254, 0xff800000
    v_accvgpr_write_b32 a224, 0
    v_accvgpr_write_b32 a225, 0
    v_accvgpr_write_b32 a226, 0
    v_accvgpr_write_b32 a227, 0
L_sloop:
    s_barrier
    s_add_u32 m0, s33, 0
    s_nop 0
    buffer_load_dwordx4 v234, s[8:11], s35 offen offset:0 nt lds
    s_add_u32 m0, s33, 784
    s_nop 0
    buffer_load_dwordx4 v234, s[8:11], s35 offen offset:256 nt lds
    s_add_u32 m0, s33, 1568
    s_nop 0
    buffer_load_dwordx4 v234, s[8:11], s35 offen offset:512 nt lds
    s_add_u32 m0, s33, 2352
    s_nop 0
    buffer_load_dwordx4 v234, s[8:11], s35 offen offset:768 nt lds
    s_add_u32 m0, s34, 0
    s_nop 0
    buffer_load_dwordx4 v235, s[12:15], s35 offen offset:0 nt lds
    s_add_u32 m0, s34, 800
    s_nop 0
    buffer_load_dwordx4 v235, s[12:15], s35 offen offset:256 nt lds
    s_add_u32 m0, s34, 1600
    s_nop 0
    buffer_load_dwordx4 v235, s[12:15], s35 offen offset:512 nt lds
    s_add_u32 m0, s34, 2400
    s_nop 0
    buffer_load_dwordx4 v235, s[12:15], s35 offen offset:768 nt lds
    s_waitcnt vmcnt(0)
    s_barrier
    ds_read_b128 a[80:83], v228 offset:0
    ds_read_b128 a[84:87], v228 offset:64
    ds_read_b128 a[88:91], v229 offset:0
    ds_read_b128 a[92:95], v229 offset:64
    ds_read_b128 a[96:99], v228 offset:256
    ds_read_b128 a[100:103], v228 offset:320
    ds_read_b128 a[104:107], v229 offset:256
    ds_read_b128 a[108:111], v229 offset:320
    ds_read_b64_tr_b16 a[144:145], v232 offset:0
    ds_read_b64_tr_b16 a[146:147], v232 offset:512
    ds_read_b64_tr_b16 a[148:149], v232 offset:32
    ds_read_b64_tr_b16 a[150:151], v232 offset:544
    ds_read_b64_tr_b16 a[152:153], v232 offset:64
    ds_read_b64_tr_b16 a[154:155], v232 offset:576
    ds_read_b64_tr_b16 a[156:157], v232 offset:96
    ds_read_b64_tr_b16 a[158:159], v232 offset:608
    ds_read_b64_tr_b16 a[160:161], v232 offset:128
    ds_read_b64_tr_b16 a[162:163], v232 offset:640
    ds_read_b64_tr_b16 a[164:165], v232 offset:160
    ds_read_b64_tr_b16 a[166:167], v232 offset:672
    ds_read_b64_tr_b16 a[168:169], v232 offset:192
    ds_read_b64_tr_b16 a[170:171], v232 offset:704
    ds_read_b64_tr_b16 a[172:173], v232 offset:224
    ds_read_b64_tr_b16 a[174:175], v232 offset:736
    s_waitcnt lgkmcnt(0)
    v_mfma_f32_16x16x32_bf16 v[176:179], a[80:83], a[0:3], 0
    v_mfma_f32_16x16x32_bf16 v[176:179], a[84:87], a[4:7], v[176:179]
    v_mfma_f32_16x16x32_bf16 v[176:179], a[88:91], a[8:11], v[176:179]
    v_mfma_f32_16x16x32_bf16 v[176:179], a[92:95], a[12:15], v[176:179]
    v_mfma_f32_16x16x32_bf16 v[180:183], a[96:99], a[0:3], 0
    v_mfma_f32_16x16x32_bf16 v[180:183], a[100:103], a[4:7], v[180:183]
    v_mfma_f32_16x16x32_bf16 v[180:183], a[104:107], a[8:11], v[180:183]
    v_mfma_f32_16x16x32_bf16 v[180:183], a[108:111], a[12:15], v[180:183]
    s_nop 3
    v_max3_f32 v4, v176, v177, v178
    s_nop 2
    v_max3_f32 v4, v4, v179, v180
    v_max3_f32 v4, v4, v181, v182
    v_max3_f32 v4, v4, v183, v250
    v_mov_b32 v5, v4
    s_nop 1
    v_permlane16_swap_b32 v4, v5
    v_max_f32 v4, v4, v5
    v_mov_b32 v5, v4
    s_nop 1
    v_permlane32_swap_b32 v4, v5
    v_max_f32 v4, v4, v5
    v_sub_f32 v5, v250, v4
    v_mov_b32 v250, v4
    v_exp_f32 v5, v5
    v_sub_f32 v176, v176, v4
    v_sub_f32 v177, v177, v4
    v_sub_f32 v178, v178, v4
    v_sub_f32 v179, v179, v4
    v_sub_f32 v180, v180, v4
    v_sub_f32 v181, v181, v4
    v_sub_f32 v182, v182, v4
    v_sub_f32 v183, v183, v4
    v_exp_f32 v176, v176
    v_exp_f32 v177, v177
    v_exp_f32 v178, v178
    v_exp_f32 v179, v179
    v_exp_f32 v180, v180
    v_exp_f32 v181, v181
    v_exp_f32 v182, v182
    v_exp_f32 v183, v183
    v_mul_f32 v16, v16, v5
    v_mul_f32 v17, v17, v5
    v_mul_f32 v18, v18, v5
    v_mul_f32 v19, v19, v5
    v_mul_f32 v20, v20, v5
    v_mul_f32 v21, v21, v5
    v_mul_f32 v22, v22, v5
    v_mul_f32 v23, v23, v5
    v_mul_f32 v24, v24, v5
    v_mul_f32 v25, v25, v5
    v_mul_f32 v26, v26, v5
    v_mul_f32 v27, v27, v5
    v_mul_f32 v28, v28, v5
    v_mul_f32 v29, v29, v5
    v_mul_f32 v30, v30, v5
    v_mul_f32 v31, v31, v5
    v_mul_f32 v32, v32, v5
    v_mul_f32 v33, v33, v5
    v_mul_f32 v34, v34, v5
    v_mul_f32 v35, v35, v5
    v_mul_f32 v36, v36, v5
    v_mul_f32 v37, v37, v5
    v_mul_f32 v38, v38, v5
    v_mul_f32 v39, v39, v5
    v_mul_f32 v40, v40, v5
    v_mul_f32 v41, v41, v5
    v_mul_f32 v42, v42, v5
    v_mul_f32 v43, v43, v5
    v_mul_f32 v44, v44, v5
    v_mul_f32 v45, v45, v5
    v_mul_f32 v46, v46, v5
    v_mul_f32 v47, v47, v5
    v_accvgpr_read_b32 v6, a208
    v_mul_f32 v6, v6, v5
    v_accvgpr_write_b32 a208, v6
    v_accvgpr_write_b32 a209, v6
    v_accvgpr_write_b32 a210, v6
    v_accvgpr_write_b32 a211, v6
    v_cvt_pk_bf16_f32 v192, v176, v177
    v_cvt_pk_bf16_f32 v193, v178, v179
    v_cvt_pk_bf16_f32 v194, v180, v181
    v_cvt_pk_bf16_f32 v195, v182, v183
    s_nop 1
    v_mfma_f32_16x16x32_bf16 v[16:19], a[144:147], v[192:195], v[16:19]
    v_mfma_f32_16x16x32_bf16 v[20:23], a[148:151], v[192:195], v[20:23]
    v_mfma_f32_16x16x32_bf16 v[24:27], a[152:155], v[192:195], v[24:27]
    v_mfma_f32_16x16x32_bf16 v[28:31], a[156:159], v[192:195], v[28:31]
    v_mfma_f32_16x16x32_bf16 v[32:35], a[160:163], v[192:195], v[32:35]
    v_mfma_f32_16x16x32_bf16 v[36:39], a[164:167], v[192:195], v[36:39]
    v_mfma_f32_16x16x32_bf16 v[40:43], a[168:171], v[192:195], v[40:43]
    v_mfma_f32_16x16x32_bf16 v[44:47], a[172:175], v[192:195], v[44:47]
    v_mfma_f32_16x16x32_bf16 a[208:211], a[228:231], v[192:195], a[208:211]
    v_mfma_f32_16x16x32_bf16 v[176:179], a[80:83], a[16:19], 0
    v_mfma_f32_16x16x32_bf16 v[176:179], a[84:87], a[20:23], v[176:179]
    v_mfma_f32_16x16x32_bf16 v[176:179], a[88:91], a[24:27], v[176:179]
    v_mfma_f32_16x16x32_bf16 v[176:179], a[92:95], a[28:31], v[176:179]
    v_mfma_f32_16x16x32_bf16 v[180:183], a[96:99], a[16:19], 0
    v_mfma_f32_16x16x32_bf16 v[180:183], a[100:103], a[20:23], v[180:183]
    v_mfma_f32_16x16x32_bf16 v[180:183], a[104:107], a[24:27], v[180:183]
    v_mfma_f32_16x16x32_bf16 v[180:183], a[108:111], a[28:31], v[180:183]
    s_nop 3
    v_max3_f32 v4, v176, v177, v178
    s_nop 2
    v_max3_f32 v4, v4, v179, v180
    v_max3_f32 v4, v4, v181, v182
    v_max3_f32 v4, v4, v183, v251
    v_mov_b32 v5, v4
    s_nop 1
    v_permlane16_swap_b32 v4, v5
    v_max_f32 v4, v4, v5
    v_mov_b32 v5, v4
    s_nop 1
    v_permlane32_swap_b32 v4, v5
    v_max_f32 v4, v4, v5
    v_sub_f32 v5, v251, v4
    v_mov_b32 v251, v4
    v_exp_f32 v5, v5
    v_sub_f32 v176, v176, v4
    v_sub_f32 v177, v177, v4
    v_sub_f32 v178, v178, v4
    v_sub_f32 v179, v179, v4
    v_sub_f32 v180, v180, v4
    v_sub_f32 v181, v181, v4
    v_sub_f32 v182, v182, v4
    v_sub_f32 v183, v183, v4
    v_exp_f32 v176, v176
    v_exp_f32 v177, v177
    v_exp_f32 v178, v178
    v_exp_f32 v179, v179
    v_exp_f32 v180, v180
    v_exp_f32 v181, v181
    v_exp_f32 v182, v182
    v_exp_f32 v183, v183
    v_mul_f32 v48, v48, v5
    v_mul_f32 v49, v49, v5
    v_mul_f32 v50, v50, v5
    v_mul_f32 v51, v51, v5
    v_mul_f32 v52, v52, v5
    v_mul_f32 v53, v53, v5
    v_mul_f32 v54, v54, v5
    v_mul_f32 v55, v55, v5
    v_mul_f32 v56, v56, v5
    v_mul_f32 v57, v57, v5
    v_mul_f32 v58, v58, v5
    v_mul_f32 v59, v59, v5
    v_mul_f32 v60, v60, v5
    v_mul_f32 v61, v61, v5
    v_mul_f32 v62, v62, v5
    v_mul_f32 v63, v63, v5
    v_mul_f32 v64, v64, v5
    v_mul_f32 v65, v65, v5
    v_mul_f32 v66, v66, v5
    v_mul_f32 v67, v67, v5
    v_mul_f32 v68, v68, v5
    v_mul_f32 v69, v69, v5
    v_mul_f32 v70, v70, v5
    v_mul_f32 v71, v71, v5
    v_mul_f32 v72, v72, v5
    v_mul_f32 v73, v73, v5
    v_mul_f32 v74, v74, v5
    v_mul_f32 v75, v75, v5
    v_mul_f32 v76, v76, v5
    v_mul_f32 v77, v77, v5
    v_mul_f32 v78, v78, v5
    v_mul_f32 v79, v79, v5
    v_accvgpr_read_b32 v6, a212
    v_mul_f32 v6, v6, v5
    v_accvgpr_write_b32 a212, v6
    v_accvgpr_write_b32 a213, v6
    v_accvgpr_write_b32 a214, v6
    v_accvgpr_write_b32 a215, v6
    v_cvt_pk_bf16_f32 v192, v176, v177
    v_cvt_pk_bf16_f32 v193, v178, v179
    v_cvt_pk_bf16_f32 v194, v180, v181
    v_cvt_pk_bf16_f32 v195, v182, v183
    s_nop 1
    v_mfma_f32_16x16x32_bf16 v[48:51], a[144:147], v[192:195], v[48:51]
    v_mfma_f32_16x16x32_bf16 v[52:55], a[148:151], v[192:195], v[52:55]
    v_mfma_f32_16x16x32_bf16 v[56:59], a[152:155], v[192:195], v[56:59]
    v_mfma_f32_16x16x32_bf16 v[60:63], a[156:159], v[192:195], v[60:63]
    v_mfma_f32_16x16x32_bf16 v[64:67], a[160:163], v[192:195], v[64:67]
    v_mfma_f32_16x16x32_bf16 v[68:71], a[164:167], v[192:195], v[68:71]
    v_mfma_f32_16x16x32_bf16 v[72:75], a[168:171], v[192:195], v[72:75]
    v_mfma_f32_16x16x32_bf16 v[76:79], a[172:175], v[192:195], v[76:79]
    v_mfma_f32_16x16x32_bf16 a[212:215], a[228:231], v[192:195], a[212:215]
    v_mfma_f32_16x16x32_bf16 v[176:179], a[80:83], a[32:35], 0
    v_mfma_f32_16x16x32_bf16 v[176:179], a[84:87], a[36:39], v[176:179]
    v_mfma_f32_16x16x32_bf16 v[176:179], a[88:91], a[40:43], v[176:179]
    v_mfma_f32_16x16x32_bf16 v[176:179], a[92:95], a[44:47], v[176:179]
    v_mfma_f32_16x16x32_bf16 v[180:183], a[96:99], a[32:35], 0
    v_mfma_f32_16x16x32_bf16 v[180:183], a[100:103], a[36:39], v[180:183]
    v_mfma_f32_16x16x32_bf16 v[180:183], a[104:107], a[40:43], v[180:183]
    v_mfma_f32_16x16x32_bf16 v[180:183], a[108:111], a[44:47], v[180:183]
    s_nop 3
    v_max3_f32 v4, v176, v177, v178
    s_nop 2
    v_max3_f32 v4, v4, v179, v180
    v_max3_f32 v4, v4, v181, v182
    v_max3_f32 v4, v4, v183, v252
    v_mov_b32 v5, v4
    s_nop 1
    v_permlane16_swap_b32 v4, v5
    v_max_f32 v4, v4, v5
    v_mov_b32 v5, v4
    s_nop 1
    v_permlane32_swap_b32 v4, v5
    v_max_f32 v4, v4, v5
    v_sub_f32 v5, v252, v4
    v_mov_b32 v252, v4
    v_exp_f32 v5, v5
    v_sub_f32 v176, v176, v4
    v_sub_f32 v177, v177, v4
    v_sub_f32 v178, v178, v4
    v_sub_f32 v179, v179, v4
    v_sub_f32 v180, v180, v4
    v_sub_f32 v181, v181, v4
    v_sub_f32 v182, v182, v4
    v_sub_f32 v183, v183, v4
    v_exp_f32 v176, v176
    v_exp_f32 v177, v177
    v_exp_f32 v178, v178
    v_exp_f32 v179, v179
    v_exp_f32 v180, v180
    v_exp_f32 v181, v181
    v_exp_f32 v182, v182
    v_exp_f32 v183, v183
    v_mul_f32 v80, v80, v5
    v_mul_f32 v81, v81, v5
    v_mul_f32 v82, v82, v5
    v_mul_f32 v83, v83, v5
    v_mul_f32 v84, v84, v5
    v_mul_f32 v85, v85, v5
    v_mul_f32 v86, v86, v5
    v_mul_f32 v87, v87, v5
    v_mul_f32 v88, v88, v5
    v_mul_f32 v89, v89, v5
    v_mul_f32 v90, v90, v5
    v_mul_f32 v91, v91, v5
    v_mul_f32 v92, v92, v5
    v_mul_f32 v93, v93, v5
    v_mul_f32 v94, v94, v5
    v_mul_f32 v95, v95, v5
    v_mul_f32 v96, v96, v5
    v_mul_f32 v97, v97, v5
    v_mul_f32 v98, v98, v5
    v_mul_f32 v99, v99, v5
    v_mul_f32 v100, v100, v5
    v_mul_f32 v101, v101, v5
    v_mul_f32 v102, v102, v5
    v_mul_f32 v103, v103, v5
    v_mul_f32 v104, v104, v5
    v_mul_f32 v105, v105, v5
    v_mul_f32 v106, v106, v5
    v_mul_f32 v107, v107, v5
    v_mul_f32 v108, v108, v5
    v_mul_f32 v109, v109, v5
    v_mul_f32 v110, v110, v5
    v_mul_f32 v111, v111, v5
    v_accvgpr_read_b32 v6, a216
    v_mul_f32 v6, v6, v5
    v_accvgpr_write_b32 a216, v6
    v_accvgpr_write_b32 a217, v6
    v_accvgpr_write_b32 a218, v6
    v_accvgpr_write_b32 a219, v6
    v_cvt_pk_bf16_f32 v192, v176, v177
    v_cvt_pk_bf16_f32 v193, v178, v179
    v_cvt_pk_bf16_f32 v194, v180, v181
    v_cvt_pk_bf16_f32 v195, v182, v183
    s_nop 1
    v_mfma_f32_16x16x32_bf16 v[80:83], a[144:147], v[192:195], v[80:83]
    v_mfma_f32_16x16x32_bf16 v[84:87], a[148:151], v[192:195], v[84:87]
    v_mfma_f32_16x16x32_bf16 v[88:91], a[152:155], v[192:195], v[88:91]
    v_mfma_f32_16x16x32_bf16 v[92:95], a[156:159], v[192:195], v[92:95]
    v_mfma_f32_16x16x32_bf16 v[96:99], a[160:163], v[192:195], v[96:99]
    v_mfma_f32_16x16x32_bf16 v[100:103], a[164:167], v[192:195], v[100:103]
    v_mfma_f32_16x16x32_bf16 v[104:107], a[168:171], v[192:195], v[104:107]
    v_mfma_f32_16x16x32_bf16 v[108:111], a[172:175], v[192:195], v[108:111]
    v_mfma_f32_16x16x32_bf16 a[216:219], a[228:231], v[192:195], a[216:219]
    v_mfma_f32_16x16x32_bf16 v[176:179], a[80:83], a[48:51], 0
    v_mfma_f32_16x16x32_bf16 v[176:179], a[84:87], a[52:55], v[176:179]
    v_mfma_f32_16x16x32_bf16 v[176:179], a[88:91], a[56:59], v[176:179]
    v_mfma_f32_16x16x32_bf16 v[176:179], a[92:95], a[60:63], v[176:179]
    v_mfma_f32_16x16x32_bf16 v[180:183], a[96:99], a[48:51], 0
    v_mfma_f32_16x16x32_bf16 v[180:183], a[100:103], a[52:55], v[180:183]
    v_mfma_f32_16x16x32_bf16 v[180:183], a[104:107], a[56:59], v[180:183]
    v_mfma_f32_16x16x32_bf16 v[180:183], a[108:111], a[60:63], v[180:183]
    s_nop 3
    v_max3_f32 v4, v176, v177, v178
    s_nop 2
    v_max3_f32 v4, v4, v179, v180
    v_max3_f32 v4, v4, v181, v182
    v_max3_f32 v4, v4, v183, v253
    v_mov_b32 v5, v4
    s_nop 1
    v_permlane16_swap_b32 v4, v5
    v_max_f32 v4, v4, v5
    v_mov_b32 v5, v4
    s_nop 1
    v_permlane32_swap_b32 v4, v5
    v_max_f32 v4, v4, v5
    v_sub_f32 v5, v253, v4
    v_mov_b32 v253, v4
    v_exp_f32 v5, v5
    v_sub_f32 v176, v176, v4
    v_sub_f32 v177, v177, v4
    v_sub_f32 v178, v178, v4
    v_sub_f32 v179, v179, v4
    v_sub_f32 v180, v180, v4
    v_sub_f32 v181, v181, v4
    v_sub_f32 v182, v182, v4
    v_sub_f32 v183, v183, v4
    v_exp_f32 v176, v176
    v_exp_f32 v177, v177
    v_exp_f32 v178, v178
    v_exp_f32 v179, v179
    v_exp_f32 v180, v180
    v_exp_f32 v181, v181
    v_exp_f32 v182, v182
    v_exp_f32 v183, v183
    v_mul_f32 v112, v112, v5
    v_mul_f32 v113, v113, v5
    v_mul_f32 v114, v114, v5
    v_mul_f32 v115, v115, v5
    v_mul_f32 v116, v116, v5
    v_mul_f32 v117, v117, v5
    v_mul_f32 v118, v118, v5
    v_mul_f32 v119, v119, v5
    v_mul_f32 v120, v120, v5
    v_mul_f32 v121, v121, v5
    v_mul_f32 v122, v122, v5
    v_mul_f32 v123, v123, v5
    v_mul_f32 v124, v124, v5
    v_mul_f32 v125, v125, v5
    v_mul_f32 v126, v126, v5
    v_mul_f32 v127, v127, v5
    v_mul_f32 v128, v128, v5
    v_mul_f32 v129, v129, v5
    v_mul_f32 v130, v130, v5
    v_mul_f32 v131, v131, v5
    v_mul_f32 v132, v132, v5
    v_mul_f32 v133, v133, v5
    v_mul_f32 v134, v134, v5
    v_mul_f32 v135, v135, v5
    v_mul_f32 v136, v136, v5
    v_mul_f32 v137, v137, v5
    v_mul_f32 v138, v138, v5
    v_mul_f32 v139, v139, v5
    v_mul_f32 v140, v140, v5
    v_mul_f32 v141, v141, v5
    v_mul_f32 v142, v142, v5
    v_mul_f32 v143, v143, v5
    v_accvgpr_read_b32 v6, a220
    v_mul_f32 v6, v6, v5
    v_accvgpr_write_b32 a220, v6
    v_accvgpr_write_b32 a221, v6
    v_accvgpr_write_b32 a222, v6
    v_accvgpr_write_b32 a223, v6
    v_cvt_pk_bf16_f32 v192, v176, v177
    v_cvt_pk_bf16_f32 v193, v178, v179
    v_cvt_pk_bf16_f32 v194, v180, v181
    v_cvt_pk_bf16_f32 v195, v182, v183
    s_nop 1
    v_mfma_f32_16x16x32_bf16 v[112:115], a[144:147], v[192:195], v[112:115]
    v_mfma_f32_16x16x32_bf16 v[116:119], a[148:151], v[192:195], v[116:119]
    v_mfma_f32_16x16x32_bf16 v[120:123], a[152:155], v[192:195], v[120:123]
    v_mfma_f32_16x16x32_bf16 v[124:127], a[156:159], v[192:195], v[124:127]
    v_mfma_f32_16x16x32_bf16 v[128:131], a[160:163], v[192:195], v[128:131]
    v_mfma_f32_16x16x32_bf16 v[132:135], a[164:167], v[192:195], v[132:135]
    v_mfma_f32_16x16x32_bf16 v[136:139], a[168:171], v[192:195], v[136:139]
    v_mfma_f32_16x16x32_bf16 v[140:143], a[172:175], v[192:195], v[140:143]
    v_mfma_f32_16x16x32_bf16 a[220:223], a[228:231], v[192:195], a[220:223]
    v_mfma_f32_16x16x32_bf16 v[176:179], a[80:83], a[64:67], 0
    v_mfma_f32_16x16x32_bf16 v[176:179], a[84:87], a[68:71], v[176:179]
    v_mfma_f32_16x16x32_bf16 v[176:179], a[88:91], a[72:75], v[176:179]
    v_mfma_f32_16x16x32_bf16 v[176:179], a[92:95], a[76:79], v[176:179]
    v_mfma_f32_16x16x32_bf16 v[180:183], a[96:99], a[64:67], 0
    v_mfma_f32_16x16x32_bf16 v[180:183], a[100:103], a[68:71], v[180:183]
    v_mfma_f32_16x16x32_bf16 v[180:183], a[104:107], a[72:75], v[180:183]
    v_mfma_f32_16x16x32_bf16 v[180:183], a[108:111], a[76:79], v[180:183]
    s_nop 3
    v_max3_f32 v4, v176, v177, v178
    s_nop 2
    v_max3_f32 v4, v4, v179, v180
    v_max3_f32 v4, v4, v181, v182
    v_max3_f32 v4, v4, v183, v254
    v_mov_b32 v5, v4
    s_nop 1
    v_permlane16_swap_b32 v4, v5
    v_max_f32 v4, v4, v5
    v_mov_b32 v5, v4
    s_nop 1
    v_permlane32_swap_b32 v4, v5
    v_max_f32 v4, v4, v5
    v_sub_f32 v5, v254, v4
    v_mov_b32 v254, v4
    v_exp_f32 v5, v5
    v_sub_f32 v176, v176, v4
    v_sub_f32 v177, v177, v4
    v_sub_f32 v178, v178, v4
    v_sub_f32 v179, v179, v4
    v_sub_f32 v180, v180, v4
    v_sub_f32 v181, v181, v4
    v_sub_f32 v182, v182, v4
    v_sub_f32 v183, v183, v4
    v_exp_f32 v176, v176
    v_exp_f32 v177, v177
    v_exp_f32 v178, v178
    v_exp_f32 v179, v179
    v_exp_f32 v180, v180
    v_exp_f32 v181, v181
    v_exp_f32 v182, v182
    v_exp_f32 v183, v183
    v_mul_f32 v144, v144, v5
    v_mul_f32 v145, v145, v5
    v_mul_f32 v146, v146, v5
    v_mul_f32 v147, v147, v5
    v_mul_f32 v148, v148, v5
    v_mul_f32 v149, v149, v5
    v_mul_f32 v150, v150, v5
    v_mul_f32 v151, v151, v5
    v_mul_f32 v152, v152, v5
    v_mul_f32 v153, v153, v5
    v_mul_f32 v154, v154, v5
    v_mul_f32 v155, v155, v5
    v_mul_f32 v156, v156, v5
    v_mul_f32 v157, v157, v5
    v_mul_f32 v158, v158, v5
    v_mul_f32 v159, v159, v5
    v_mul_f32 v160, v160, v5
    v_mul_f32 v161, v161, v5
    v_mul_f32 v162, v162, v5
    v_mul_f32 v163, v163, v5
    v_mul_f32 v164, v164, v5
    v_mul_f32 v165, v165, v5
    v_mul_f32 v166, v166, v5
    v_mul_f32 v167, v167, v5
    v_mul_f32 v168, v168, v5
    v_mul_f32 v169, v169, v5
    v_mul_f32 v170, v170, v5
    v_mul_f32 v171, v171, v5
    v_mul_f32 v172, v172, v5
    v_mul_f32 v173, v173, v5
    v_mul_f32 v174, v174, v5
    v_mul_f32 v175, v175, v5
    v_accvgpr_read_b32 v6, a224
    v_mul_f32 v6, v6, v5
    v_accvgpr_write_b32 a224, v6
    v_accvgpr_write_b32 a225, v6
    v_accvgpr_write_b32 a226, v6
    v_accvgpr_write_b32 a227, v6
    v_cvt_pk_bf16_f32 v192, v176, v177
    v_cvt_pk_bf16_f32 v193, v178, v179
    v_cvt_pk_bf16_f32 v194, v180, v181
    v_cvt_pk_bf16_f32 v195, v182, v183
    s_nop 1
    v_mfma_f32_16x16x32_bf16 v[144:147], a[144:147], v[192:195], v[144:147]
    v_mfma_f32_16x16x32_bf16 v[148:151], a[148:151], v[192:195], v[148:151]
    v_mfma_f32_16x16x32_bf16 v[152:155], a[152:155], v[192:195], v[152:155]
    v_mfma_f32_16x16x32_bf16 v[156:159], a[156:159], v[192:195], v[156:159]
    v_mfma_f32_16x16x32_bf16 v[160:163], a[160:163], v[192:195], v[160:163]
    v_mfma_f32_16x16x32_bf16 v[164:167], a[164:167], v[192:195], v[164:167]
    v_mfma_f32_16x16x32_bf16 v[168:171], a[168:171], v[192:195], v[168:171]
    v_mfma_f32_16x16x32_bf16 v[172:175], a[172:175], v[192:195], v[172:175]
    v_mfma_f32_16x16x32_bf16 a[224:227], a[228:231], v[192:195], a[224:227]
    ds_read_b128 a[80:83], v230 offset:0
    ds_read_b128 a[84:87], v230 offset:64
    ds_read_b128 a[88:91], v231 offset:0
    ds_read_b128 a[92:95], v231 offset:64
    ds_read_b128 a[96:99], v230 offset:256
    ds_read_b128 a[100:103], v230 offset:320
    ds_read_b128 a[104:107], v231 offset:256
    ds_read_b128 a[108:111], v231 offset:320
    ds_read_b64_tr_b16 a[144:145], v233 offset:0
    ds_read_b64_tr_b16 a[146:147], v233 offset:512
    ds_read_b64_tr_b16 a[148:149], v233 offset:32
    ds_read_b64_tr_b16 a[150:151], v233 offset:544
    ds_read_b64_tr_b16 a[152:153], v233 offset:64
    ds_read_b64_tr_b16 a[154:155], v233 offset:576
    ds_read_b64_tr_b16 a[156:157], v233 offset:96
    ds_read_b64_tr_b16 a[158:159], v233 offset:608
    ds_read_b64_tr_b16 a[160:161], v233 offset:128
    ds_read_b64_tr_b16 a[162:163], v233 offset:640
    ds_read_b64_tr_b16 a[164:165], v233 offset:160
    ds_read_b64_tr_b16 a[166:167], v233 offset:672
    ds_read_b64_tr_b16 a[168:169], v233 offset:192
    ds_read_b64_tr_b16 a[170:171], v233 offset:704
    ds_read_b64_tr_b16 a[172:173], v233 offset:224
    ds_read_b64_tr_b16 a[174:175], v233 offset:736
    s_waitcnt lgkmcnt(0)
    v_mfma_f32_16x16x32_bf16 v[176:179], a[80:83], a[0:3], 0
    v_mfma_f32_16x16x32_bf16 v[176:179], a[84:87], a[4:7], v[176:179]
    v_mfma_f32_16x16x32_bf16 v[176:179], a[88:91], a[8:11], v[176:179]
    v_mfma_f32_16x16x32_bf16 v[176:179], a[92:95], a[12:15], v[176:179]
    v_mfma_f32_16x16x32_bf16 v[180:183], a[96:99], a[0:3], 0
    v_mfma_f32_16x16x32_bf16 v[180:183], a[100:103], a[4:7], v[180:183]
    v_mfma_f32_16x16x32_bf16 v[180:183], a[104:107], a[8:11], v[180:183]
    v_mfma_f32_16x16x32_bf16 v[180:183], a[108:111], a[12:15], v[180:183]
    s_nop 3
    v_max3_f32 v4, v176, v177, v178
    s_nop 2
    v_max3_f32 v4, v4, v179, v180
    v_max3_f32 v4, v4, v181, v182
    v_max3_f32 v4, v4, v183, v250
    v_mov_b32 v5, v4
    s_nop 1
    v_permlane16_swap_b32 v4, v5
    v_max_f32 v4, v4, v5
    v_mov_b32 v5, v4
    s_nop 1
    v_permlane32_swap_b32 v4, v5
    v_max_f32 v4, v4, v5
    v_sub_f32 v5, v250, v4
    v_mov_b32 v250, v4
    v_exp_f32 v5, v5
    v_sub_f32 v176, v176, v4
    v_sub_f32 v177, v177, v4
    v_sub_f32 v178, v178, v4
    v_sub_f32 v179, v179, v4
    v_sub_f32 v180, v180, v4
    v_sub_f32 v181, v181, v4
    v_sub_f32 v182, v182, v4
    v_sub_f32 v183, v183, v4
    v_exp_f32 v176, v176
    v_exp_f32 v177, v177
    v_exp_f32 v178, v178
    v_exp_f32 v179, v179
    v_exp_f32 v180, v180
    v_exp_f32 v181, v181
    v_exp_f32 v182, v182
    v_exp_f32 v183, v183
    v_mul_f32 v16, v16, v5
    v_mul_f32 v17, v17, v5
    v_mul_f32 v18, v18, v5
    v_mul_f32 v19, v19, v5
    v_mul_f32 v20, v20, v5
    v_mul_f32 v21, v21, v5
    v_mul_f32 v22, v22, v5
    v_mul_f32 v23, v23, v5
    v_mul_f32 v24, v24, v5
    v_mul_f32 v25, v25, v5
    v_mul_f32 v26, v26, v5
    v_mul_f32 v27, v27, v5
    v_mul_f32 v28, v28, v5
    v_mul_f32 v29, v29, v5
    v_mul_f32 v30, v30, v5
    v_mul_f32 v31, v31, v5
    v_mul_f32 v32, v32, v5
    v_mul_f32 v33, v33, v5
    v_mul_f32 v34, v34, v5
    v_mul_f32 v35, v35, v5
    v_mul_f32 v36, v36, v5
    v_mul_f32 v37, v37, v5
    v_mul_f32 v38, v38, v5
    v_mul_f32 v39, v39, v5
    v_mul_f32 v40, v40, v5
    v_mul_f32 v41, v41, v5
    v_mul_f32 v42, v42, v5
    v_mul_f32 v43, v43, v5
    v_mul_f32 v44, v44, v5
    v_mul_f32 v45, v45, v5
    v_mul_f32 v46, v46, v5
    v_mul_f32 v47, v47, v5
    v_accvgpr_read_b32 v6, a208
    v_mul_f32 v6, v6, v5
    v_accvgpr_write_b32 a208, v6
    v_accvgpr_write_b32 a209, v6
    v_accvgpr_write_b32 a210, v6
    v_accvgpr_write_b32 a211, v6
    v_cvt_pk_bf16_f32 v192, v176, v177
    v_cvt_pk_bf16_f32 v193, v178, v179
    v_cvt_pk_bf16_f32 v194, v180, v181
    v_cvt_pk_bf16_f32 v195, v182, v183
    s_nop 1
    v_mfma_f32_16x16x32_bf16 v[16:19], a[144:147], v[192:195], v[16:19]
    v_mfma_f32_16x16x32_bf16 v[20:23], a[148:151], v[192:195], v[20:23]
    v_mfma_f32_16x16x32_bf16 v[24:27], a[152:155], v[192:195], v[24:27]
    v_mfma_f32_16x16x32_bf16 v[28:31], a[156:159], v[192:195], v[28:31]
    v_mfma_f32_16x16x32_bf16 v[32:35], a[160:163], v[192:195], v[32:35]
    v_mfma_f32_16x16x32_bf16 v[36:39], a[164:167], v[192:195], v[36:39]
    v_mfma_f32_16x16x32_bf16 v[40:43], a[168:171], v[192:195], v[40:43]
    v_mfma_f32_16x16x32_bf16 v[44:47], a[172:175], v[192:195], v[44:47]
    v_mfma_f32_16x16x32_bf16 a[208:211], a[228:231], v[192:195], a[208:211]
    v_mfma_f32_16x16x32_bf16 v[176:179], a[80:83], a[16:19], 0
    v_mfma_f32_16x16x32_bf16 v[176:179], a[84:87], a[20:23], v[176:179]
    v_mfma_f32_16x16x32_bf16 v[176:179], a[88:91], a[24:27], v[176:179]
    v_mfma_f32_16x16x32_bf16 v[176:179], a[92:95], a[28:31], v[176:179]
    v_mfma_f32_16x16x32_bf16 v[180:183], a[96:99], a[16:19], 0
    v_mfma_f32_16x16x32_bf16 v[180:183], a[100:103], a[20:23], v[180:183]
    v_mfma_f32_16x16x32_bf16 v[180:183], a[104:107], a[24:27], v[180:183]
    v_mfma_f32_16x16x32_bf16 v[180:183], a[108:111], a[28:31], v[180:183]
    s_nop 3
    v_max3_f32 v4, v176, v177, v178
    s_nop 2
    v_max3_f32 v4, v4, v179, v180
    v_max3_f32 v4, v4, v181, v182
    v_max3_f32 v4, v4, v183, v251
    v_mov_b32 v5, v4
    s_nop 1
    v_permlane16_swap_b32 v4, v5
    v_max_f32 v4, v4, v5
    v_mov_b32 v5, v4
    s_nop 1
    v_permlane32_swap_b32 v4, v5
    v_max_f32 v4, v4, v5
    v_sub_f32 v5, v251, v4
    v_mov_b32 v251, v4
    v_exp_f32 v5, v5
    v_sub_f32 v176, v176, v4
    v_sub_f32 v177, v177, v4
    v_sub_f32 v178, v178, v4
    v_sub_f32 v179, v179, v4
    v_sub_f32 v180, v180, v4
    v_sub_f32 v181, v181, v4
    v_sub_f32 v182, v182, v4
    v_sub_f32 v183, v183, v4
    v_exp_f32 v176, v176
    v_exp_f32 v177, v177
    v_exp_f32 v178, v178
    v_exp_f32 v179, v179
    v_exp_f32 v180, v180
    v_exp_f32 v181, v181
    v_exp_f32 v182, v182
    v_exp_f32 v183, v183
    v_mul_f32 v48, v48, v5
    v_mul_f32 v49, v49, v5
    v_mul_f32 v50, v50, v5
    v_mul_f32 v51, v51, v5
    v_mul_f32 v52, v52, v5
    v_mul_f32 v53, v53, v5
    v_mul_f32 v54, v54, v5
    v_mul_f32 v55, v55, v5
    v_mul_f32 v56, v56, v5
    v_mul_f32 v57, v57, v5
    v_mul_f32 v58, v58, v5
    v_mul_f32 v59, v59, v5
    v_mul_f32 v60, v60, v5
    v_mul_f32 v61, v61, v5
    v_mul_f32 v62, v62, v5
    v_mul_f32 v63, v63, v5
    v_mul_f32 v64, v64, v5
    v_mul_f32 v65, v65, v5
    v_mul_f32 v66, v66, v5
    v_mul_f32 v67, v67, v5
    v_mul_f32 v68, v68, v5
    v_mul_f32 v69, v69, v5
    v_mul_f32 v70, v70, v5
    v_mul_f32 v71, v71, v5
    v_mul_f32 v72, v72, v5
    v_mul_f32 v73, v73, v5
    v_mul_f32 v74, v74, v5
    v_mul_f32 v75, v75, v5
    v_mul_f32 v76, v76, v5
    v_mul_f32 v77, v77, v5
    v_mul_f32 v78, v78, v5
    v_mul_f32 v79, v79, v5
    v_accvgpr_read_b32 v6, a212
    v_mul_f32 v6, v6, v5
    v_accvgpr_write_b32 a212, v6
    v_accvgpr_write_b32 a213, v6
    v_accvgpr_write_b32 a214, v6
    v_accvgpr_write_b32 a215, v6
    v_cvt_pk_bf16_f32 v192, v176, v177
    v_cvt_pk_bf16_f32 v193, v178, v179
    v_cvt_pk_bf16_f32 v194, v180, v181
    v_cvt_pk_bf16_f32 v195, v182, v183
    s_nop 1
    v_mfma_f32_16x16x32_bf16 v[48:51], a[144:147], v[192:195], v[48:51]
    v_mfma_f32_16x16x32_bf16 v[52:55], a[148:151], v[192:195], v[52:55]
    v_mfma_f32_16x16x32_bf16 v[56:59], a[152:155], v[192:195], v[56:59]
    v_mfma_f32_16x16x32_bf16 v[60:63], a[156:159], v[192:195], v[60:63]
    v_mfma_f32_16x16x32_bf16 v[64:67], a[160:163], v[192:195], v[64:67]
    v_mfma_f32_16x16x32_bf16 v[68:71], a[164:167], v[192:195], v[68:71]
    v_mfma_f32_16x16x32_bf16 v[72:75], a[168:171], v[192:195], v[72:75]
    v_mfma_f32_16x16x32_bf16 v[76:79], a[172:175], v[192:195], v[76:79]
    v_mfma_f32_16x16x32_bf16 a[212:215], a[228:231], v[192:195], a[212:215]
    v_mfma_f32_16x16x32_bf16 v[176:179], a[80:83], a[32:35], 0
    v_mfma_f32_16x16x32_bf16 v[176:179], a[84:87], a[36:39], v[176:179]
    v_mfma_f32_16x16x32_bf16 v[176:179], a[88:91], a[40:43], v[176:179]
    v_mfma_f32_16x16x32_bf16 v[176:179], a[92:95], a[44:47], v[176:179]
    v_mfma_f32_16x16x32_bf16 v[180:183], a[96:99], a[32:35], 0
    v_mfma_f32_16x16x32_bf16 v[180:183], a[100:103], a[36:39], v[180:183]
    v_mfma_f32_16x16x32_bf16 v[180:183], a[104:107], a[40:43], v[180:183]
    v_mfma_f32_16x16x32_bf16 v[180:183], a[108:111], a[44:47], v[180:183]
    s_nop 3
    v_max3_f32 v4, v176, v177, v178
    s_nop 2
    v_max3_f32 v4, v4, v179, v180
    v_max3_f32 v4, v4, v181, v182
    v_max3_f32 v4, v4, v183, v252
    v_mov_b32 v5, v4
    s_nop 1
    v_permlane16_swap_b32 v4, v5
    v_max_f32 v4, v4, v5
    v_mov_b32 v5, v4
    s_nop 1
    v_permlane32_swap_b32 v4, v5
    v_max_f32 v4, v4, v5
    v_sub_f32 v5, v252, v4
    v_mov_b32 v252, v4
    v_exp_f32 v5, v5
    v_sub_f32 v176, v176, v4
    v_sub_f32 v177, v177, v4
    v_sub_f32 v178, v178, v4
    v_sub_f32 v179, v179, v4
    v_sub_f32 v180, v180, v4
    v_sub_f32 v181, v181, v4
    v_sub_f32 v182, v182, v4
    v_sub_f32 v183, v183, v4
    v_exp_f32 v176, v176
    v_exp_f32 v177, v177
    v_exp_f32 v178, v178
    v_exp_f32 v179, v179
    v_exp_f32 v180, v180
    v_exp_f32 v181, v181
    v_exp_f32 v182, v182
    v_exp_f32 v183, v183
    v_mul_f32 v80, v80, v5
    v_mul_f32 v81, v81, v5
    v_mul_f32 v82, v82, v5
    v_mul_f32 v83, v83, v5
    v_mul_f32 v84, v84, v5
    v_mul_f32 v85, v85, v5
    v_mul_f32 v86, v86, v5
    v_mul_f32 v87, v87, v5
    v_mul_f32 v88, v88, v5
    v_mul_f32 v89, v89, v5
    v_mul_f32 v90, v90, v5
    v_mul_f32 v91, v91, v5
    v_mul_f32 v92, v92, v5
    v_mul_f32 v93, v93, v5
    v_mul_f32 v94, v94, v5
    v_mul_f32 v95, v95, v5
    v_mul_f32 v96, v96, v5
    v_mul_f32 v97, v97, v5
    v_mul_f32 v98, v98, v5
    v_mul_f32 v99, v99, v5
    v_mul_f32 v100, v100, v5
    v_mul_f32 v101, v101, v5
    v_mul_f32 v102, v102, v5
    v_mul_f32 v103, v103, v5
    v_mul_f32 v104, v104, v5
    v_mul_f32 v105, v105, v5
    v_mul_f32 v106, v106, v5
    v_mul_f32 v107, v107, v5
    v_mul_f32 v108, v108, v5
    v_mul_f32 v109, v109, v5
    v_mul_f32 v110, v110, v5
    v_mul_f32 v111, v111, v5
    v_accvgpr_read_b32 v6, a216
    v_mul_f32 v6, v6, v5
    v_accvgpr_write_b32 a216, v6
    v_accvgpr_write_b32 a217, v6
    v_accvgpr_write_b32 a218, v6
    v_accvgpr_write_b32 a219, v6
    v_cvt_pk_bf16_f32 v192, v176, v177
    v_cvt_pk_bf16_f32 v193, v178, v179
    v_cvt_pk_bf16_f32 v194, v180, v181
    v_cvt_pk_bf16_f32 v195, v182, v183
    s_nop 1
    v_mfma_f32_16x16x32_bf16 v[80:83], a[144:147], v[192:195], v[80:83]
    v_mfma_f32_16x16x32_bf16 v[84:87], a[148:151], v[192:195], v[84:87]
    v_mfma_f32_16x16x32_bf16 v[88:91], a[152:155], v[192:195], v[88:91]
    v_mfma_f32_16x16x32_bf16 v[92:95], a[156:159], v[192:195], v[92:95]
    v_mfma_f32_16x16x32_bf16 v[96:99], a[160:163], v[192:195], v[96:99]
    v_mfma_f32_16x16x32_bf16 v[100:103], a[164:167], v[192:195], v[100:103]
    v_mfma_f32_16x16x32_bf16 v[104:107], a[168:171], v[192:195], v[104:107]
    v_mfma_f32_16x16x32_bf16 v[108:111], a[172:175], v[192:195], v[108:111]
    v_mfma_f32_16x16x32_bf16 a[216:219], a[228:231], v[192:195], a[216:219]
    v_mfma_f32_16x16x32_bf16 v[176:179], a[80:83], a[48:51], 0
    v_mfma_f32_16x16x32_bf16 v[176:179], a[84:87], a[52:55], v[176:179]
    v_mfma_f32_16x16x32_bf16 v[176:179], a[88:91], a[56:59], v[176:179]
    v_mfma_f32_16x16x32_bf16 v[176:179], a[92:95], a[60:63], v[176:179]
    v_mfma_f32_16x16x32_bf16 v[180:183], a[96:99], a[48:51], 0
    v_mfma_f32_16x16x32_bf16 v[180:183], a[100:103], a[52:55], v[180:183]
    v_mfma_f32_16x16x32_bf16 v[180:183], a[104:107], a[56:59], v[180:183]
    v_mfma_f32_16x16x32_bf16 v[180:183], a[108:111], a[60:63], v[180:183]
    s_nop 3
    v_max3_f32 v4, v176, v177, v178
    s_nop 2
    v_max3_f32 v4, v4, v179, v180
    v_max3_f32 v4, v4, v181, v182
    v_max3_f32 v4, v4, v183, v253
    v_mov_b32 v5, v4
    s_nop 1
    v_permlane16_swap_b32 v4, v5
    v_max_f32 v4, v4, v5
    v_mov_b32 v5, v4
    s_nop 1
    v_permlane32_swap_b32 v4, v5
    v_max_f32 v4, v4, v5
    v_sub_f32 v5, v253, v4
    v_mov_b32 v253, v4
    v_exp_f32 v5, v5
    v_sub_f32 v176, v176, v4
    v_sub_f32 v177, v177, v4
    v_sub_f32 v178, v178, v4
    v_sub_f32 v179, v179, v4
    v_sub_f32 v180, v180, v4
    v_sub_f32 v181, v181, v4
    v_sub_f32 v182, v182, v4
    v_sub_f32 v183, v183, v4
    v_exp_f32 v176, v176
    v_exp_f32 v177, v177
    v_exp_f32 v178, v178
    v_exp_f32 v179, v179
    v_exp_f32 v180, v180
    v_exp_f32 v181, v181
    v_exp_f32 v182, v182
    v_exp_f32 v183, v183
    v_mul_f32 v112, v112, v5
    v_mul_f32 v113, v113, v5
    v_mul_f32 v114, v114, v5
    v_mul_f32 v115, v115, v5
    v_mul_f32 v116, v116, v5
    v_mul_f32 v117, v117, v5
    v_mul_f32 v118, v118, v5
    v_mul_f32 v119, v119, v5
    v_mul_f32 v120, v120, v5
    v_mul_f32 v121, v121, v5
    v_mul_f32 v122, v122, v5
    v_mul_f32 v123, v123, v5
    v_mul_f32 v124, v124, v5
    v_mul_f32 v125, v125, v5
    v_mul_f32 v126, v126, v5
    v_mul_f32 v127, v127, v5
    v_mul_f32 v128, v128, v5
    v_mul_f32 v129, v129, v5
    v_mul_f32 v130, v130, v5
    v_mul_f32 v131, v131, v5
    v_mul_f32 v132, v132, v5
    v_mul_f32 v133, v133, v5
    v_mul_f32 v134, v134, v5
    v_mul_f32 v135, v135, v5
    v_mul_f32 v136, v136, v5
    v_mul_f32 v137, v137, v5
    v_mul_f32 v138, v138, v5
    v_mul_f32 v139, v139, v5
    v_mul_f32 v140, v140, v5
    v_mul_f32 v141, v141, v5
    v_mul_f32 v142, v142, v5
    v_mul_f32 v143, v143, v5
    v_accvgpr_read_b32 v6, a220
    v_mul_f32 v6, v6, v5
    v_accvgpr_write_b32 a220, v6
    v_accvgpr_write_b32 a221, v6
    v_accvgpr_write_b32 a222, v6
    v_accvgpr_write_b32 a223, v6
    v_cvt_pk_bf16_f32 v192, v176, v177
    v_cvt_pk_bf16_f32 v193, v178, v179
    v_cvt_pk_bf16_f32 v194, v180, v181
    v_cvt_pk_bf16_f32 v195, v182, v183
    s_nop 1
    v_mfma_f32_16x16x32_bf16 v[112:115], a[144:147], v[192:195], v[112:115]
    v_mfma_f32_16x16x32_bf16 v[116:119], a[148:151], v[192:195], v[116:119]
    v_mfma_f32_16x16x32_bf16 v[120:123], a[152:155], v[192:195], v[120:123]
    v_mfma_f32_16x16x32_bf16 v[124:127], a[156:159], v[192:195], v[124:127]
    v_mfma_f32_16x16x32_bf16 v[128:131], a[160:163], v[192:195], v[128:131]
    v_mfma_f32_16x16x32_bf16 v[132:135], a[164:167], v[192:195], v[132:135]
    v_mfma_f32_16x16x32_bf16 v[136:139], a[168:171], v[192:195], v[136:139]
    v_mfma_f32_16x16x32_bf16 v[140:143], a[172:175], v[192:195], v[140:143]
    v_mfma_f32_16x16x32_bf16 a[220:223], a[228:231], v[192:195], a[220:223]
    s_add_u32 s35, s35, 16384
    s_cmp_lt_u32 s35, 262144
    s_cbranch_scc1 L_sloop
    s_nop 7
    v_accvgpr_write_b32 a209, 0
    v_accvgpr_write_b32 a213, 0
    v_accvgpr_write_b32 a217, 0
    v_accvgpr_write_b32 a221, 0
    s_lshl_b32 s40, s24, 8
    s_add_u32 s41, s40, 157440
    v_lshlrev_b32 v4, 2, v0
    v_add_u32 v5, s41, v4
    s_xor_b32 s40, s40, 256
    s_add_u32 s41, s40, 157440
    v_add_u32 v4, s41, v4
    ds_write_b32 v5, v254
    s_waitcnt lgkmcnt(0)
    s_barrier
    ds_read_b32 v5, v4
    s_waitcnt lgkmcnt(0)
    v_max_f32 v5, v5, v254
    v_sub_f32 v5, v254, v5
    v_exp_f32 v5, v5
    s_nop 7
    v_mul_f32 v144, v144, v5
    v_mul_f32 v145, v145, v5
    v_mul_f32 v146, v146, v5
    v_mul_f32 v147, v147, v5
    v_mul_f32 v148, v148, v5
    v_mul_f32 v149, v149, v5
    v_mul_f32 v150, v150, v5
    v_mul_f32 v151, v151, v5
    v_mul_f32 v152, v152, v5
    v_mul_f32 v153, v153, v5
    v_mul_f32 v154, v154, v5
    v_mul_f32 v155, v155, v5
    v_mul_f32 v156, v156, v5
    v_mul_f32 v157, v157, v5
    v_mul_f32 v158, v158, v5
    v_mul_f32 v159, v159, v5
    v_mul_f32 v160, v160, v5
    v_mul_f32 v161, v161, v5
    v_mul_f32 v162, v162, v5
    v_mul_f32 v163, v163, v5
    v_mul_f32 v164, v164, v5
    v_mul_f32 v165, v165, v5
    v_mul_f32 v166, v166, v5
    v_mul_f32 v167, v167, v5
    v_mul_f32 v168, v168, v5
    v_mul_f32 v169, v169, v5
    v_mul_f32 v170, v170, v5
    v_mul_f32 v171, v171, v5
    v_mul_f32 v172, v172, v5
    v_mul_f32 v173, v173, v5
    v_mul_f32 v174, v174, v5
    v_mul_f32 v175, v175, v5
    v_accvgpr_read_b32 v6, a224
    v_mul_f32 v6, v6, v5
    v_accvgpr_write_b32 a224, v6
    s_lshl_b32 s40, s24, 13
    s_add_u32 s40, s40, 67072
    v_add_u32 v9, s40, v248
    v_lshlrev_b32 v10, 2, v0
    s_lshl_b32 s40, s24, 8
    s_add_u32 s40, s40, 158720
    v_add_u32 v11, s40, v10
    s_xor_b32 s40, s40, 256
    v_add_u32 v10, s40, v10
    s_lshl_b32 s40, s25, 12
    v_add_u32 v12, s40, v9
    s_xor_b32 s42, s24, 1
    s_lshl_b32 s42, s42, 13
    s_add_u32 s40, s40, s42
    s_add_u32 s40, s40, 67072
    v_add_u32 v13, s40, v248
    s_barrier
    v_accvgpr_read_b32 v236, a224
    ds_write_b128 v9, v[144:147] offset:0
    ds_write_b128 v9, v[148:151] offset:1024
    ds_write_b128 v9, v[152:155] offset:2048
    ds_write_b128 v9, v[156:159] offset:3072
    ds_write_b128 v9, v[160:163] offset:4096
    ds_write_b128 v9, v[164:167] offset:5120
    ds_write_b128 v9, v[168:171] offset:6144
    ds_write_b128 v9, v[172:175] offset:7168
    ds_write_b32 v11, v236
    v_min_f32 v238, v238, v236
    v_max_f32 v241, v241, v236
    v_add_f32 v8, v8, v236
    s_waitcnt lgkmcnt(0)
    s_barrier
    ds_read_b128 v[144:147], v12 offset:0
    ds_read_b128 v[148:151], v12 offset:1024
    ds_read_b128 v[152:155], v12 offset:2048
    ds_read_b128 v[156:159], v12 offset:3072
    ds_read_b128 v[160:163], v13 offset:0
    ds_read_b128 v[164:167], v13 offset:1024
    ds_read_b128 v[168:171], v13 offset:2048
    ds_read_b128 v[172:175], v13 offset:3072
    ds_read_b32 v237, v10
    s_lshl_b32 s41, s24, 19
    s_add_u32 s41, s41, 0
    v_accvgpr_read_b32 v250, a208
    v_accvgpr_read_b32 v251, a209
    v_add_f32 v250, v250, v251
    v_min_f32 v238, v238, v250
    v_max_f32 v241, v241, v250
    v_add_f32 v8, v8, v250
    v_rcp_f32 v250, v250
    s_nop 0
    v_pk_mul_f32 v[16:17], v[16:17], v[250:251] op_sel_hi:[1,0]
    v_pk_mul_f32 v[18:19], v[18:19], v[250:251] op_sel_hi:[1,0]
    v_pk_mul_f32 v[20:21], v[20:21], v[250:251] op_sel_hi:[1,0]
    v_pk_mul_f32 v[22:23], v[22:23], v[250:251] op_sel_hi:[1,0]
    v_cvt_pk_bf16_f32 v16, v16, v17
    v_cvt_pk_bf16_f32 v17, v18, v19
    v_cvt_pk_bf16_f32 v18, v20, v21
    v_cvt_pk_bf16_f32 v19, v22, v23
    buffer_store_dwordx4 v[16:19], v248, s[20:23], s41 offen offset:0 sc1
    v_pk_mul_f32 v[24:25], v[24:25], v[250:251] op_sel_hi:[1,0]
    v_pk_mul_f32 v[26:27], v[26:27], v[250:251] op_sel_hi:[1,0]
    v_pk_mul_f32 v[28:29], v[28:29], v[250:251] op_sel_hi:[1,0]
    v_pk_mul_f32 v[30:31], v[30:31], v[250:251] op_sel_hi:[1,0]
    v_cvt_pk_bf16_f32 v24, v24, v25
    v_cvt_pk_bf16_f32 v25, v26, v27
    v_cvt_pk_bf16_f32 v26, v28, v29
    v_cvt_pk_bf16_f32 v27, v30, v31
    buffer_store_dwordx4 v[24:27], v248, s[20:23], s41 offen offset:1024 sc1
    v_pk_mul_f32 v[32:33], v[32:33], v[250:251] op_sel_hi:[1,0]
    v_pk_mul_f32 v[34:35], v[34:35], v[250:251] op_sel_hi:[1,0]
    v_pk_mul_f32 v[36:37], v[36:37], v[250:251] op_sel_hi:[1,0]
    v_pk_mul_f32 v[38:39], v[38:39], v[250:251] op_sel_hi:[1,0]
    v_cvt_pk_bf16_f32 v32, v32, v33
    v_cvt_pk_bf16_f32 v33, v34, v35
    v_cvt_pk_bf16_f32 v34, v36, v37
    v_cvt_pk_bf16_f32 v35, v38, v39
    buffer_store_dwordx4 v[32:35], v248, s[20:23], s41 offen offset:2048 sc1
    v_pk_mul_f32 v[40:41], v[40:41], v[250:251] op_sel_hi:[1,0]
    v_pk_mul_f32 v[42:43], v[42:43], v[250:251] op_sel_hi:[1,0]
    v_pk_mul_f32 v[44:45], v[44:45], v[250:251] op_sel_hi:[1,0]
    v_pk_mul_f32 v[46:47], v[46:47], v[250:251] op_sel_hi:[1,0]
    v_cvt_pk_bf16_f32 v40, v40, v41
    v_cvt_pk_bf16_f32 v41, v42, v43
    v_cvt_pk_bf16_f32 v42, v44, v45
    v_cvt_pk_bf16_f32 v43, v46, v47
    buffer_store_dwordx4 v[40:43], v248, s[20:23], s41 offen offset:3072 sc1
    s_lshl_b32 s41, s24, 19
    s_add_u32 s41, s41, 131072
    v_accvgpr_read_b32 v252, a212
    v_accvgpr_read_b32 v253, a213
    v_add_f32 v252, v252, v253
    v_min_f32 v238, v238, v252
    v_max_f32 v241, v241, v252
    v_add_f32 v8, v8, v252
    v_rcp_f32 v252, v252
    s_nop 0
    v_pk_mul_f32 v[48:49], v[48:49], v[252:253] op_sel_hi:[1,0]
    v_pk_mul_f32 v[50:51], v[50:51], v[252:253] op_sel_hi:[1,0]
    v_pk_mul_f32 v[52:53], v[52:53], v[252:253] op_sel_hi:[1,0]
    v_pk_mul_f32 v[54:55], v[54:55], v[252:253] op_sel_hi:[1,0]
    v_cvt_pk_bf16_f32 v48, v48, v49
    v_cvt_pk_bf16_f32 v49, v50, v51
    v_cvt_pk_bf16_f32 v50, v52, v53
    v_cvt_pk_bf16_f32 v51, v54, v55
    buffer_store_dwordx4 v[48:51], v248, s[20:23], s41 offen offset:0 sc1
    v_pk_mul_f32 v[56:57], v[56:57], v[252:253] op_sel_hi:[1,0]
    v_pk_mul_f32 v[58:59], v[58:59], v[252:253] op_sel_hi:[1,0]
    v_pk_mul_f32 v[60:61], v[60:61], v[252:253] op_sel_hi:[1,0]
    v_pk_mul_f32 v[62:63], v[62:63], v[252:253] op_sel_hi:[1,0]
    v_cvt_pk_bf16_f32 v56, v56, v57
    v_cvt_pk_bf16_f32 v57, v58, v59
    v_cvt_pk_bf16_f32 v58, v60, v61
    v_cvt_pk_bf16_f32 v59, v62, v63
    buffer_store_dwordx4 v[56:59], v248, s[20:23], s41 offen offset:1024 sc1
    v_pk_mul_f32 v[64:65], v[64:65], v[252:253] op_sel_hi:[1,0]
    v_pk_mul_f32 v[66:67], v[66:67], v[252:253] op_sel_hi:[1,0]
    v_pk_mul_f32 v[68:69], v[68:69], v[252:253] op_sel_hi:[1,0]
    v_pk_mul_f32 v[70:71], v[70:71], v[252:253] op_sel_hi:[1,0]
    v_cvt_pk_bf16_f32 v64, v64, v65
    v_cvt_pk_bf16_f32 v65, v66, v67
    v_cvt_pk_bf16_f32 v66, v68, v69
    v_cvt_pk_bf16_f32 v67, v70, v71
    buffer_store_dwordx4 v[64:67], v248, s[20:23], s41 offen offset:2048 sc1
    v_pk_mul_f32 v[72:73], v[72:73], v[252:253] op_sel_hi:[1,0]
    v_pk_mul_f32 v[74:75], v[74:75], v[252:253] op_sel_hi:[1,0]
    v_pk_mul_f32 v[76:77], v[76:77], v[252:253] op_sel_hi:[1,0]
    v_pk_mul_f32 v[78:79], v[78:79], v[252:253] op_sel_hi:[1,0]
    v_cvt_pk_bf16_f32 v72, v72, v73
    v_cvt_pk_bf16_f32 v73, v74, v75
    v_cvt_pk_bf16_f32 v74, v76, v77
    v_cvt_pk_bf16_f32 v75, v78, v79
    buffer_store_dwordx4 v[72:75], v248, s[20:23], s41 offen offset:3072 sc1
    s_lshl_b32 s41, s24, 19
    s_add_u32 s41, s41, 262144
    v_accvgpr_read_b32 v254, a216
    v_accvgpr_read_b32 v255, a217
    v_add_f32 v254, v254, v255
    v_min_f32 v238, v238, v254
    v_max_f32 v241, v241, v254
    v_add_f32 v8, v8, v254
    v_rcp_f32 v254, v254
    s_nop 0
    v_pk_mul_f32 v[80:81], v[80:81], v[254:255] op_sel_hi:[1,0]
    v_pk_mul_f32 v[82:83], v[82:83], v[254:255] op_sel_hi:[1,0]
    v_pk_mul_f32 v[84:85], v[84:85], v[254:255] op_sel_hi:[1,0]
    v_pk_mul_f32 v[86:87], v[86:87], v[254:255] op_sel_hi:[1,0]
    v_cvt_pk_bf16_f32 v80, v80, v81
    v_cvt_pk_bf16_f32 v81, v82, v83
    v_cvt_pk_bf16_f32 v82, v84, v85
    v_cvt_pk_bf16_f32 v83, v86, v87
    buffer_store_dwordx4 v[80:83], v248, s[20:23], s41 offen offset:0 sc1
    v_pk_mul_f32 v[88:89], v[88:89], v[254:255] op_sel_hi:[1,0]
    v_pk_mul_f32 v[90:91], v[90:91], v[254:255] op_sel_hi:[1,0]
    v_pk_mul_f32 v[92:93], v[92:93], v[254:255] op_sel_hi:[1,0]
    v_pk_mul_f32 v[94:95], v[94:95], v[254:255] op_sel_hi:[1,0]
    v_cvt_pk_bf16_f32 v88, v88, v89
    v_cvt_pk_bf16_f32 v89, v90, v91
    v_cvt_pk_bf16_f32 v90, v92, v93
    v_cvt_pk_bf16_f32 v91, v94, v95
    buffer_store_dwordx4 v[88:91], v248, s[20:23], s41 offen offset:1024 sc1
    v_pk_mul_f32 v[96:97], v[96:97], v[254:255] op_sel_hi:[1,0]
    v_pk_mul_f32 v[98:99], v[98:99], v[254:255] op_sel_hi:[1,0]
    v_pk_mul_f32 v[100:101], v[100:101], v[254:255] op_sel_hi:[1,0]
    v_pk_mul_f32 v[102:103], v[102:103], v[254:255] op_sel_hi:[1,0]
    v_cvt_pk_bf16_f32 v96, v96, v97
    v_cvt_pk_bf16_f32 v97, v98, v99
    v_cvt_pk_bf16_f32 v98, v100, v101
    v_cvt_pk_bf16_f32 v99, v102, v103
    buffer_store_dwordx4 v[96:99], v248, s[20:23], s41 offen offset:2048 sc1
    v_pk_mul_f32 v[104:105], v[104:105], v[254:255] op_sel_hi:[1,0]
    v_pk_mul_f32 v[106:107], v[106:107], v[254:255] op_sel_hi:[1,0]
    v_pk_mul_f32 v[108:109], v[108:109], v[254:255] op_sel_hi:[1,0]
    v_pk_mul_f32 v[110:111], v[110:111], v[254:255] op_sel_hi:[1,0]
    v_cvt_pk_bf16_f32 v104, v104, v105
    v_cvt_pk_bf16_f32 v105, v106, v107
    v_cvt_pk_bf16_f32 v106, v108, v109
    v_cvt_pk_bf16_f32 v107, v110, v111
    buffer_store_dwordx4 v[104:107], v248, s[20:23], s41 offen offset:3072 sc1
    s_lshl_b32 s41, s24, 19
    s_add_u32 s41, s41, 393216
    v_accvgpr_read_b32 v242, a220
    v_accvgpr_read_b32 v243, a221
    v_add_f32 v242, v242, v243
    v_min_f32 v238, v238, v242
    v_max_f32 v241, v241, v242
    v_add_f32 v8, v8, v242
    v_rcp_f32 v242, v242
    s_nop 0
    v_pk_mul_f32 v[112:113], v[112:113], v[242:243] op_sel_hi:[1,0]
    v_pk_mul_f32 v[114:115], v[114:115], v[242:243] op_sel_hi:[1,0]
    v_pk_mul_f32 v[116:117], v[116:117], v[242:243] op_sel_hi:[1,0]
    v_pk_mul_f32 v[118:119], v[118:119], v[242:243] op_sel_hi:[1,0]
    v_cvt_pk_bf16_f32 v112, v112, v113
    v_cvt_pk_bf16_f32 v113, v114, v115
    v_cvt_pk_bf16_f32 v114, v116, v117
    v_cvt_pk_bf16_f32 v115, v118, v119
    buffer_store_dwordx4 v[112:115], v248, s[20:23], s41 offen offset:0 sc1
    v_pk_mul_f32 v[120:121], v[120:121], v[242:243] op_sel_hi:[1,0]
    v_pk_mul_f32 v[122:123], v[122:123], v[242:243] op_sel_hi:[1,0]
    v_pk_mul_f32 v[124:125], v[124:125], v[242:243] op_sel_hi:[1,0]
    v_pk_mul_f32 v[126:127], v[126:127], v[242:243] op_sel_hi:[1,0]
    v_cvt_pk_bf16_f32 v120, v120, v121
    v_cvt_pk_bf16_f32 v121, v122, v123
    v_cvt_pk_bf16_f32 v122, v124, v125
    v_cvt_pk_bf16_f32 v123, v126, v127
    buffer_store_dwordx4 v[120:123], v248, s[20:23], s41 offen offset:1024 sc1
    v_pk_mul_f32 v[128:129], v[128:129], v[242:243] op_sel_hi:[1,0]
    v_pk_mul_f32 v[130:131], v[130:131], v[242:243] op_sel_hi:[1,0]
    v_pk_mul_f32 v[132:133], v[132:133], v[242:243] op_sel_hi:[1,0]
    v_pk_mul_f32 v[134:135], v[134:135], v[242:243] op_sel_hi:[1,0]
    v_cvt_pk_bf16_f32 v128, v128, v129
    v_cvt_pk_bf16_f32 v129, v130, v131
    v_cvt_pk_bf16_f32 v130, v132, v133
    v_cvt_pk_bf16_f32 v131, v134, v135
    buffer_store_dwordx4 v[128:131], v248, s[20:23], s41 offen offset:2048 sc1
    v_pk_mul_f32 v[136:137], v[136:137], v[242:243] op_sel_hi:[1,0]
    v_pk_mul_f32 v[138:139], v[138:139], v[242:243] op_sel_hi:[1,0]
    v_pk_mul_f32 v[140:141], v[140:141], v[242:243] op_sel_hi:[1,0]
    v_pk_mul_f32 v[142:143], v[142:143], v[242:243] op_sel_hi:[1,0]
    v_cvt_pk_bf16_f32 v136, v136, v137
    v_cvt_pk_bf16_f32 v137, v138, v139
    v_cvt_pk_bf16_f32 v138, v140, v141
    v_cvt_pk_bf16_f32 v139, v142, v143
    buffer_store_dwordx4 v[136:139], v248, s[20:23], s41 offen offset:3072 sc1
    s_waitcnt lgkmcnt(0)
    s_lshr_b32 s42, s24, 1
    s_add_u32 s42, s42, 16
    s_lshl_b32 s42, s42, 17
    s_lshl_b32 s40, s25, 11
    s_add_u32 s42, s42, s40
    v_add_f32 v236, v236, v237
    v_rcp_f32 v236, v236
    v_add_f32 v144, v144, v160
    v_add_f32 v145, v145, v161
    v_add_f32 v146, v146, v162
    v_add_f32 v147, v147, v163
    v_add_f32 v148, v148, v164
    v_add_f32 v149, v149, v165
    v_add_f32 v150, v150, v166
    v_add_f32 v151, v151, v167
    v_add_f32 v152, v152, v168
    v_add_f32 v153, v153, v169
    v_add_f32 v154, v154, v170
    v_add_f32 v155, v155, v171
    v_add_f32 v156, v156, v172
    v_add_f32 v157, v157, v173
    v_add_f32 v158, v158, v174
    v_add_f32 v159, v159, v175
    v_mul_f32 v144, v144, v236
    v_mul_f32 v145, v145, v236
    v_mul_f32 v146, v146, v236
    v_mul_f32 v147, v147, v236
    v_mul_f32 v148, v148, v236
    v_mul_f32 v149, v149, v236
    v_mul_f32 v150, v150, v236
    v_mul_f32 v151, v151, v236
    v_cvt_pk_bf16_f32 v144, v144, v145
    v_cvt_pk_bf16_f32 v145, v146, v147
    v_cvt_pk_bf16_f32 v146, v148, v149
    v_cvt_pk_bf16_f32 v147, v150, v151
    buffer_store_dwordx4 v[144:147], v248, s[20:23], s42 offen offset:0 sc1
    v_mul_f32 v152, v152, v236
    v_mul_f32 v153, v153, v236
    v_mul_f32 v154, v154, v236
    v_mul_f32 v155, v155, v236
    v_mul_f32 v156, v156, v236
    v_mul_f32 v157, v157, v236
    v_mul_f32 v158, v158, v236
    v_mul_f32 v159, v159, v236
    v_cvt_pk_bf16_f32 v152, v152, v153
    v_cvt_pk_bf16_f32 v153, v154, v155
    v_cvt_pk_bf16_f32 v154, v156, v157
    v_cvt_pk_bf16_f32 v155, v158, v159
    buffer_store_dwordx4 v[152:155], v248, s[20:23], s42 offen offset:1024 sc1
    s_lshl_b32 s40, s88, 5
    s_lshl_b32 s41, s84, 4
    s_add_u32 s40, s40, s41
    s_lshl_b32 s41, s24, 2
    s_add_u32 s40, s40, s41
    s_lshl_b32 s40, s40, 7
    s_add_u32 s40, s40, 41943040
    v_and_b32 v1, 3, v0
    v_lshlrev_b32 v1, 7, v1
    v_add_u32 v1, s40, v1
    s_lshl_b32 s40, s26, 5
    s_add_u32 s40, s40, s27
    s_lshl_b32 s40, s40, 7
    s_add_u32 s40, s40, 41943040
    v_cmp_eq_u32 vcc, 0, v14
    v_mov_b32 v8, s40
    v_mov_b32 v7, 0x7ffffff0
    v_cndmask_b32 v8, v7, v8, vcc
    s_mul_i32 s40, s88, 2359296
    s_add_u32 s44, s58, s40
    s_addc_u32 s45, s59, 0
    s_mov_b32 s46, 2359296
    s_mov_b32 s47, 0x20000
    s_add_u32 s40, s89, 0
    s_lshl_b32 s28, s40, 17
    s_add_u32 s40, s90, 0
    s_lshl_b32 s16, s40, 17
    s_add_u32 s40, s89, 1
    s_lshl_b32 s29, s40, 17
    s_add_u32 s40, s90, 1
    s_lshl_b32 s17, s40, 17
    s_add_u32 s40, s89, 2
    s_lshl_b32 s30, s40, 17
    s_add_u32 s40, s90, 2
    s_lshl_b32 s18, s40, 17
    s_add_u32 s40, s89, 3
    s_lshl_b32 s31, s40, 17
    s_add_u32 s40, s90, 3
    s_lshl_b32 s19, s40, 17
    s_min_u32 s40, s89, s90
    s_add_u32 s40, s40, 4
    s_lshl_b32 s32, s40, 17
    s_waitcnt vmcnt(0)
    s_barrier
    buffer_store_dword v15, v8, s[96:99], 0 offen sc1
    s_add_u32 s43, s86, 0
    s_and_b32 s43, s43, 15
    s_lshl_b32 s43, s43, 15
    s_add_u32 m0, s87, 0
    s_nop 0
    buffer_load_dwordx4 v244, s[92:95], s43 offen offset:0 lds
    s_add_u32 m0, s87, 32
    s_nop 0
    buffer_load_dwordx4 v244, s[92:95], s43 offen offset:1024 lds
    s_add_u32 m0, s87, 64
    s_nop 0
    buffer_load_dwordx4 v244, s[92:95], s43 offen offset:2048 lds
    s_add_u32 m0, s87, 96
    s_nop 0
    buffer_load_dwordx4 v244, s[92:95], s43 offen offset:3072 lds
    s_add_u32 s43, s86, 1
    s_and_b32 s43, s43, 15
    s_lshl_b32 s43, s43, 15
    s_add_u32 m0, s87, 16768
    s_nop 0
    buffer_load_dwordx4 v244, s[92:95], s43 offen offset:0 lds
    s_add_u32 m0, s87, 16800
    s_nop 0
    buffer_load_dwordx4 v244, s[92:95], s43 offen offset:1024 lds
    s_add_u32 m0, s87, 16832
    s_nop 0
    buffer_load_dwordx4 v244, s[92:95], s43 offen offset:2048 lds
    s_add_u32 m0, s87, 16864
    s_nop 0
    buffer_load_dwordx4 v244, s[92:95], s43 offen offset:3072 lds
    s_add_u32 s43, s86, 2
    s_and_b32 s43, s43, 15
    s_lshl_b32 s43, s43, 15
    s_add_u32 m0, s87, 33536
    s_nop 0
    buffer_load_dwordx4 v244, s[92:95], s43 offen offset:0 lds
    s_add_u32 m0, s87, 33568
    s_nop 0
    buffer_load_dwordx4 v244, s[92:95], s43 offen offset:1024 lds
    s_add_u32 m0, s87, 33600
    s_nop 0
    buffer_load_dwordx4 v244, s[92:95], s43 offen offset:2048 lds
    s_add_u32 m0, s87, 33632
    s_nop 0
    buffer_load_dwordx4 v244, s[92:95], s43 offen offset:3072 lds
    s_add_u32 s43, s86, 3
    s_and_b32 s43, s43, 15
    s_lshl_b32 s43, s43, 15
    s_add_u32 m0, s87, 50304
    s_nop 0
    buffer_load_dwordx4 v244, s[92:95], s43 offen offset:0 lds
    s_add_u32 m0, s87, 50336
    s_nop 0
    buffer_load_dwordx4 v244, s[92:95], s43 offen offset:1024 lds
    s_add_u32 m0, s87, 50368
    s_nop 0
    buffer_load_dwordx4 v244, s[92:95], s43 offen offset:2048 lds
    s_add_u32 m0, s87, 50400
    s_nop 0
    buffer_load_dwordx4 v244, s[92:95], s43 offen offset:3072 lds
    s_add_u32 s43, s86, 4
    s_and_b32 s43, s43, 15
    s_lshl_b32 s43, s43, 15
    s_add_u32 m0, s87, 67072
    s_nop 0
    buffer_load_dwordx4 v244, s[92:95], s43 offen offset:0 lds
    s_add_u32 m0, s87, 67104
    s_nop 0
    buffer_load_dwordx4 v244, s[92:95], s43 offen offset:1024 lds
    s_add_u32 m0, s87, 67136
    s_nop 0
    buffer_load_dwordx4 v244, s[92:95], s43 offen offset:2048 lds
    s_add_u32 m0, s87, 67168
    s_nop 0
    buffer_load_dwordx4 v244, s[92:95], s43 offen offset:3072 lds
    s_add_u32 s43, s86, 5
    s_and_b32 s43, s43, 15
    s_lshl_b32 s43, s43, 15
    s_add_u32 m0, s87, 83840
    s_nop 0
    buffer_load_dwordx4 v244, s[92:95], s43 offen offset:0 lds
    s_add_u32 m0, s87, 83872
    s_nop 0
    buffer_load_dwordx4 v244, s[92:95], s43 offen offset:1024 lds
    s_add_u32 m0, s87, 83904
    s_nop 0
    buffer_load_dwordx4 v244, s[92:95], s43 offen offset:2048 lds
    s_add_u32 m0, s87, 83936
    s_nop 0
    buffer_load_dwordx4 v244, s[92:95], s43 offen offset:3072 lds
    s_add_u32 s43, s86, 6
    s_and_b32 s43, s43, 15
    s_lshl_b32 s43, s43, 15
    s_add_u32 m0, s87, 100608
    s_nop 0
    buffer_load_dwordx4 v244, s[92:95], s43 offen offset:0 lds
    s_add_u32 m0, s87, 100640
    s_nop 0
    buffer_load_dwordx4 v244, s[92:95], s43 offen offset:1024 lds
    s_add_u32 m0, s87, 100672
    s_nop 0
    buffer_load_dwordx4 v244, s[92:95], s43 offen offset:2048 lds
    s_add_u32 m0, s87, 100704
    s_nop 0
    buffer_load_dwordx4 v244, s[92:95], s43 offen offset:3072 lds
    s_add_u32 s43, s86, 7
    s_and_b32 s43, s43, 15
    s_lshl_b32 s43, s43, 15
    s_add_u32 m0, s87, 117376
    s_nop 0
    buffer_load_dwordx4 v244, s[92:95], s43 offen offset:0 lds
    s_add_u32 m0, s87, 117408
    s_nop 0
    buffer_load_dwordx4 v244, s[92:95], s43 offen offset:1024 lds
    s_add_u32 m0, s87, 117440
    s_nop 0
    buffer_load_dwordx4 v244, s[92:95], s43 offen offset:2048 lds
    s_add_u32 m0, s87, 117472
    s_nop 0
    buffer_load_dwordx4 v244, s[92:95], s43 offen offset:3072 lds
    s_waitcnt vmcnt(0)
    ds_read_b64_tr_b16 a[240:241], v245 offset:0
    ds_read_b64_tr_b16 a[242:243], v245 offset:512
    ds_read_b64_tr_b16 a[244:245], v245 offset:32
    ds_read_b64_tr_b16 a[246:247], v245 offset:544
    ds_read_b64_tr_b16 a[248:249], v245 offset:64
    ds_read_b64_tr_b16 a[250:251], v245 offset:576
    ds_read_b64_tr_b16 a[252:253], v245 offset:96
    ds_read_b64_tr_b16 a[254:255], v245 offset:608
    ds_read_b64_tr_b16 a[64:65], v245 offset:16768
    ds_read_b64_tr_b16 a[66:67], v245 offset:17280
    ds_read_b64_tr_b16 a[68:69], v245 offset:16800
    ds_read_b64_tr_b16 a[70:71], v245 offset:17312
    ds_read_b64_tr_b16 a[72:73], v245 offset:16832
    ds_read_b64_tr_b16 a[74:75], v245 offset:17344
    ds_read_b64_tr_b16 a[76:77], v245 offset:16864
    ds_read_b64_tr_b16 a[78:79], v245 offset:17376
    ds_read_b64_tr_b16 a[0:1], v245 offset:33536
    ds_read_b64_tr_b16 a[2:3], v245 offset:34048
    ds_read_b64_tr_b16 a[4:5], v245 offset:33568
    ds_read_b64_tr_b16 a[6:7], v245 offset:34080
    ds_read_b64_tr_b16 a[8:9], v245 offset:33600
    ds_read_b64_tr_b16 a[10:11], v245 offset:34112
    ds_read_b64_tr_b16 a[12:13], v245 offset:33632
    ds_read_b64_tr_b16 a[14:15], v245 offset:34144
    ds_read_b64_tr_b16 a[16:17], v245 offset:50304
    ds_read_b64_tr_b16 a[18:19], v245 offset:50816
    ds_read_b64_tr_b16 a[20:21], v245 offset:50336
    ds_read_b64_tr_b16 a[22:23], v245 offset:50848
    ds_read_b64_tr_b16 a[24:25], v245 offset:50368
    ds_read_b64_tr_b16 a[26:27], v245 offset:50880
    ds_read_b64_tr_b16 a[28:29], v245 offset:50400
    ds_read_b64_tr_b16 a[30:31], v245 offset:50912
    ds_read_b64_tr_b16 a[32:33], v246 offset:0
    ds_read_b64_tr_b16 a[34:35], v246 offset:512
    ds_read_b64_tr_b16 a[36:37], v246 offset:32
    ds_read_b64_tr_b16 a[38:39], v246 offset:544
    ds_read_b64_tr_b16 a[40:41], v246 offset:64
    ds_read_b64_tr_b16 a[42:43], v246 offset:576
    ds_read_b64_tr_b16 a[44:45], v246 offset:96
    ds_read_b64_tr_b16 a[46:47], v246 offset:608
    ds_read_b64_tr_b16 a[80:81], v246 offset:16768
    ds_read_b64_tr_b16 a[82:83], v246 offset:17280
    ds_read_b64_tr_b16 a[84:85], v246 offset:16800
    ds_read_b64_tr_b16 a[86:87], v246 offset:17312
    ds_read_b64_tr_b16 a[88:89], v246 offset:16832
    ds_read_b64_tr_b16 a[90:91], v246 offset:17344
    ds_read_b64_tr_b16 a[92:93], v246 offset:16864
    ds_read_b64_tr_b16 a[94:95], v246 offset:17376
    ds_read_b64_tr_b16 a[96:97], v246 offset:33536
    ds_read_b64_tr_b16 a[98:99], v246 offset:34048
    ds_read_b64_tr_b16 a[100:101], v246 offset:33568
    ds_read_b64_tr_b16 a[102:103], v246 offset:34080
    ds_read_b64_tr_b16 a[104:105], v246 offset:33600
    ds_read_b64_tr_b16 a[106:107], v246 offset:34112
    ds_read_b64_tr_b16 a[108:109], v246 offset:33632
    ds_read_b64_tr_b16 a[110:111], v246 offset:34144
    ds_read_b64_tr_b16 a[48:49], v246 offset:50304
    ds_read_b64_tr_b16 a[50:51], v246 offset:50816
    ds_read_b64_tr_b16 a[52:53], v246 offset:50336
    ds_read_b64_tr_b16 a[54:55], v246 offset:50848
    ds_read_b64_tr_b16 a[56:57], v246 offset:50368
    ds_read_b64_tr_b16 a[58:59], v246 offset:50880
    ds_read_b64_tr_b16 a[60:61], v246 offset:50400
    ds_read_b64_tr_b16 a[62:63], v246 offset:50912
    s_waitcnt lgkmcnt(0)
    s_add_u32 s43, s86, 8
    s_and_b32 s43, s43, 15
    s_lshl_b32 s43, s43, 15
    s_add_u32 m0, s87, 100608
    s_nop 0
    buffer_load_dwordx4 v244, s[92:95], s43 offen offset:0 lds
    s_add_u32 m0, s87, 100640
    s_nop 0
    buffer_load_dwordx4 v244, s[92:95], s43 offen offset:1024 lds
    s_add_u32 m0, s87, 100672
    s_nop 0
    buffer_load_dwordx4 v244, s[92:95], s43 offen offset:2048 lds
    s_add_u32 m0, s87, 100704
    s_nop 0
    buffer_load_dwordx4 v244, s[92:95], s43 offen offset:3072 lds
    s_add_u32 s43, s86, 9
    s_and_b32 s43, s43, 15
    s_lshl_b32 s43, s43, 15
    s_add_u32 m0, s87, 117376
    s_nop 0
    buffer_load_dwordx4 v244, s[92:95], s43 offen offset:0 lds
    s_add_u32 m0, s87, 117408
    s_nop 0
    buffer_load_dwordx4 v244, s[92:95], s43 offen offset:1024 lds
    s_add_u32 m0, s87, 117440
    s_nop 0
    buffer_load_dwordx4 v244, s[92:95], s43 offen offset:2048 lds
    s_add_u32 m0, s87, 117472
    s_nop 0
    buffer_load_dwordx4 v244, s[92:95], s43 offen offset:3072 lds
    s_add_u32 s43, s86, 10
    s_and_b32 s43, s43, 15
    s_lshl_b32 s43, s43, 15
    s_add_u32 m0, s87, 33536
    s_nop 0
    buffer_load_dwordx4 v244, s[92:95], s43 offen offset:0 lds
    s_add_u32 m0, s87, 33568
    s_nop 0
    buffer_load_dwordx4 v244, s[92:95], s43 offen offset:1024 lds
    s_add_u32 m0, s87, 33600
    s_nop 0
    buffer_load_dwordx4 v244, s[92:95], s43 offen offset:2048 lds
    s_add_u32 m0, s87, 33632
    s_nop 0
    buffer_load_dwordx4 v244, s[92:95], s43 offen offset:3072 lds
    s_add_u32 s43, s86, 11
    s_and_b32 s43, s43, 15
    s_lshl_b32 s43, s43, 15
    s_add_u32 m0, s87, 50304
    s_nop 0
    buffer_load_dwordx4 v244, s[92:95], s43 offen offset:0 lds
    s_add_u32 m0, s87, 50336
    s_nop 0
    buffer_load_dwordx4 v244, s[92:95], s43 offen offset:1024 lds
    s_add_u32 m0, s87, 50368
    s_nop 0
    buffer_load_dwordx4 v244, s[92:95], s43 offen offset:2048 lds
    s_add_u32 m0, s87, 50400
    s_nop 0
    buffer_load_dwordx4 v244, s[92:95], s43 offen offset:3072 lds
    s_add_u32 s43, s86, 12
    s_and_b32 s43, s43, 15
    s_lshl_b32 s43, s43, 15
    s_add_u32 m0, s87, 134400
    s_nop 0
    buffer_load_dwordx4 v244, s[92:95], s43 offen offset:0 lds
    s_add_u32 m0, s87, 134432
    s_nop 0
    buffer_load_dwordx4 v244, s[92:95], s43 offen offset:1024 lds
    s_add_u32 m0, s87, 134464
    s_nop 0
    buffer_load_dwordx4 v244, s[92:95], s43 offen offset:2048 lds
    s_add_u32 m0, s87, 134496
    s_nop 0
    buffer_load_dwordx4 v244, s[92:95], s43 offen offset:3072 lds
    s_add_u32 s43, s86, 13
    s_and_b32 s43, s43, 15
    s_lshl_b32 s43, s43, 15
    s_add_u32 m0, s87, 0
    s_nop 0
    buffer_load_dwordx4 v244, s[92:95], s43 offen offset:0 lds
    s_add_u32 m0, s87, 32
    s_nop 0
    buffer_load_dwordx4 v244, s[92:95], s43 offen offset:1024 lds
    s_add_u32 m0, s87, 64
    s_nop 0
    buffer_load_dwordx4 v244, s[92:95], s43 offen offset:2048 lds
    s_add_u32 m0, s87, 96
    s_nop 0
    buffer_load_dwordx4 v244, s[92:95], s43 offen offset:3072 lds
    s_add_u32 s43, s86, 14
    s_and_b32 s43, s43, 15
    s_lshl_b32 s43, s43, 15
    s_add_u32 m0, s87, 16768
    s_nop 0
    buffer_load_dwordx4 v244, s[92:95], s43 offen offset:0 lds
    s_add_u32 m0, s87, 16800
    s_nop 0
    buffer_load_dwordx4 v244, s[92:95], s43 offen offset:1024 lds
    s_add_u32 m0, s87, 16832
    s_nop 0
    buffer_load_dwordx4 v244, s[92:95], s43 offen offset:2048 lds
    s_add_u32 m0, s87, 16864
    s_nop 0
    buffer_load_dwordx4 v244, s[92:95], s43 offen offset:3072 lds
    s_waitcnt vmcnt(0)
    ds_read_b64_tr_b16 a[112:113], v246 offset:33536
    ds_read_b64_tr_b16 a[114:115], v246 offset:34048
    ds_read_b64_tr_b16 a[116:117], v246 offset:33568
    ds_read_b64_tr_b16 a[118:119], v246 offset:34080
    ds_read_b64_tr_b16 a[120:121], v246 offset:33600
    ds_read_b64_tr_b16 a[122:123], v246 offset:34112
    ds_read_b64_tr_b16 a[124:125], v246 offset:33632
    ds_read_b64_tr_b16 a[126:127], v246 offset:34144
    ds_read_b64_tr_b16 a[128:129], v246 offset:50304
    ds_read_b64_tr_b16 a[130:131], v246 offset:50816
    ds_read_b64_tr_b16 a[132:133], v246 offset:50336
    ds_read_b64_tr_b16 a[134:135], v246 offset:50848
    ds_read_b64_tr_b16 a[136:137], v246 offset:50368
    ds_read_b64_tr_b16 a[138:139], v246 offset:50880
    ds_read_b64_tr_b16 a[140:141], v246 offset:50400
    ds_read_b64_tr_b16 a[142:143], v246 offset:50912
    s_waitcnt lgkmcnt(0)
    s_add_u32 s43, s86, 15
    s_and_b32 s43, s43, 15
    s_lshl_b32 s43, s43, 15
    s_add_u32 m0, s87, 100608
    s_nop 0
    buffer_load_dwordx4 v244, s[92:95], s43 offen offset:0 lds
    s_add_u32 m0, s87, 100640
    s_nop 0
    buffer_load_dwordx4 v244, s[92:95], s43 offen offset:1024 lds
    s_add_u32 m0, s87, 100672
    s_nop 0
    buffer_load_dwordx4 v244, s[92:95], s43 offen offset:2048 lds
    s_add_u32 m0, s87, 100704
    s_nop 0
    buffer_load_dwordx4 v244, s[92:95], s43 offen offset:3072 lds
    s_add_u32 s40, s86, 0
    s_and_b32 s40, s40, 15
    s_lshl_b32 s40, s40, 10
    v_add_u32 v241, s40, v240
    s_add_u32 s40, s86, 2
    s_and_b32 s40, s40, 15
    s_lshl_b32 s40, s40, 10
    v_add_u32 v242, s40, v240
    s_xor_b32 s40, s24, 1
    s_mul_i32 s42, s40, 15360
    s_add_u32 s42, s42, 0
    v_add_u32 v4, s42, v248
    s_mul_i32 s42, s40, 12288
    s_add_u32 s42, s42, 61440
    v_add_u32 v7, s42, v248
    s_xor_b32 s40, s24, 2
    s_mul_i32 s42, s40, 15360
    s_add_u32 s42, s42, 5120
    v_add_u32 v5, s42, v248
    s_mul_i32 s42, s40, 12288
    s_add_u32 s42, s42, 65536
    v_add_u32 v8, s42, v248
    s_xor_b32 s40, s24, 3
    s_mul_i32 s42, s40, 15360
    s_add_u32 s42, s42, 10240
    v_add_u32 v6, s42, v248
    s_mul_i32 s42, s40, 12288
    s_add_u32 s42, s42, 69632
    v_add_u32 v9, s42, v248
    s_mul_i32 s42, s24, 15360
    v_add_u32 v10, s42, v248
    s_mul_i32 s42, s24, 12288
    s_add_u32 s42, s42, 61440
    v_add_u32 v11, s42, v248
    v_mov_b32 v249, 0
    s_waitcnt vmcnt(0)
    s_branch L_poll
.section .rodata,"a"
.p2align 6
.amdhsa_kernel standalone__gqa_block_cached__near_ridge_kernel
  .amdhsa_next_free_vgpr 512
  .amdhsa_next_free_sgpr 102
  .amdhsa_accum_offset 256
  .amdhsa_group_segment_fixed_size 0
  .amdhsa_kernarg_size 64
  .amdhsa_user_sgpr_count 2
  .amdhsa_user_sgpr_kernarg_segment_ptr 1
  .amdhsa_system_sgpr_workgroup_id_x 1
.end_amdhsa_kernel
```
